```python
import torch

def _softmax(x, axis=-1):
    return torch.softmax(x, dim=axis)
def _gelu(x):
    return torch.nn.functional.gelu(x, approximate="tanh")
def _silu(x):
    return torch.nn.functional.silu(x)
def _sigmoid(x):
    return torch.sigmoid(x)
def _layernorm(x, axis=-1, eps=1e-5):
    m = x.mean(dim=axis, keepdim=True)
    v = x.var(dim=axis, keepdim=True, unbiased=False)
    return (x - m) / torch.sqrt(v + eps)
def _scatter_add(tgt, idx, src, axis=0):
    return tgt.clone().index_add_(axis, idx, src)
def _segment_sum(src, seg, n):
    out = torch.zeros((n,) + src.shape[1:], dtype=src.dtype)
    return out.index_add_(0, seg, src)
def _pad(x, pw):
    flat = tuple(v for pair in reversed(pw) for v in pair)
    return torch.nn.functional.pad(x, flat)

kernel_name = 'sequential_preLN__linear_attn_block__geglu_ffn__prompt'

def setup_inputs():

    _w = (lambda a: (lambda t: t.to(torch.bfloat16) if t.is_floating_point() else t)(torch.as_tensor(a)))
    def _A_setup():
        B, S, D = 1, 2048, 576
        return {
            "x": _w((lambda *s: torch.randn(*s, dtype=torch.bfloat16) * 0.05)(B, S, D)),
            "wqkv": _w((lambda *s: torch.randn(*s, dtype=torch.bfloat16) * 0.05)(D, 3 * D)),
            "wo": _w((lambda *s: torch.randn(*s, dtype=torch.bfloat16) * 0.05)(D, D)),
        }
    _A_in = _A_setup()

    def _B_setup():
        B, S, D, F = 1, 2048, 576, 4608
        return {
            "x": _w((lambda *s: torch.randn(*s, dtype=torch.bfloat16) * 0.05)(B, S, D)),
            "w_gate": _w((lambda *s: torch.randn(*s, dtype=torch.bfloat16) * 0.05)(D, F)),
            "w_up": _w((lambda *s: torch.randn(*s, dtype=torch.bfloat16) * 0.05)(D, F)),
            "w_down": _w((lambda *s: torch.randn(*s, dtype=torch.bfloat16) * 0.05)(F, D)),
        }
    _B_in = _B_setup()

    return {
        "A_x": _A_in["x"],
        "A_wqkv": _A_in["wqkv"],
        "A_wo": _A_in["wo"],
        "B_x": _B_in["x"],
        "B_w_gate": _B_in["w_gate"],
        "B_w_up": _B_in["w_up"],
        "B_w_down": _B_in["w_down"],
    }

def reference(A_x, A_wqkv, A_wo, B_x, B_w_gate, B_w_up, B_w_down):
    def _A_ref(x, wqkv, wo):
        B, S, D = x.shape
        H = 32; Dh = D // H
        qkv = (lambda x, *d: x.permute(*d))((x @ wqkv).reshape(B, S, 3, H, Dh), 2, 0, 3, 1, 4)
        q, k, v = qkv[0], qkv[1], qkv[2]
        phi = lambda t: torch.where(t > 0, t + 1, torch.exp(t)) + 1e-6
        pq, pk = phi(q), phi(k)
        kv = torch.einsum("bhsd,bhse->bhde", pk, v)
        z = torch.einsum("bhsd->bhd", pk)
        num = torch.einsum("bhqd,bhde->bhqe", pq, kv)
        den = torch.einsum("bhqd,bhd->bhq", pq, z)[..., None] + 1e-6
        o = num / den
        return (lambda x, *d: x.permute(*d))(o, 0, 2, 1, 3).reshape(B, S, D) @ wo

    def _B_ref(x, w_gate, w_up, w_down):
        return (_gelu(x @ w_gate) * (x @ w_up)) @ w_down

    x = A_x
    h = x + _A_ref(_layernorm(x, axis=-1), A_wqkv, A_wo)
    h2 = h + _B_ref(_layernorm(h, axis=-1), B_w_gate, B_w_up, B_w_down)
    return h2
```

```asm
; @launch grid=(256,1,1) block=(256,1,1) lds=163840
.amdgcn_target "amdgcn-amd-amdhsa--gfx950"
.text
.p2align 12
.fill 832, 4, 0xBF810000
.globl sequential_preLN__linear_attn_block__geglu_ffn__prompt_kernel
.p2align 8
.type sequential_preLN__linear_attn_block__geglu_ffn__prompt_kernel,@function
sequential_preLN__linear_attn_block__geglu_ffn__prompt_kernel:
  s_cmp_ge_u32 s2, 256
  s_cbranch_scc1 L_end
  s_mov_b32 s100, 1000000
  s_load_dwordx4 s[68:71], s[0:1], 0
  s_and_b32 s25, s2, 7
  s_lshr_b32 s26, s2, 3
  s_getpc_b64 s[44:45]
L_pcbase:
  s_mul_i32 s3, s26, 17
  v_min_u32 v3, 16, v0
  v_add_u32 v3, s3, v3
  v_lshlrev_b32 v3, 7, v3
  v_min_u32 v3, L_end-L_pcbase, v3
  global_load_dword v128, v3, s[44:45]
  s_load_dwordx2 s[76:77], s[0:1], 16
  s_load_dwordx4 s[4:7], s[0:1], 32
  s_load_dwordx4 s[12:15], s[0:1], 48
  s_load_dwordx4 s[16:19], s[0:1], 64
  v_lshrrev_b32 v2, 6, v0
  v_and_b32 v1, 63, v0
  v_readfirstlane_b32 s24, v2
  s_lshr_b32 s27, s25, 1
  s_lshl_b32 s27, s27, 3
  s_lshr_b32 s28, s26, 2
  s_add_u32 s27, s27, s28
  s_and_b32 s28, s25, 1
  s_lshl_b32 s28, s28, 2
  s_and_b32 s29, s26, 3
  s_add_u32 s28, s28, s29
  s_lshl_b32 s29, s27, 2
  s_add_u32 s29, s29, s24
  s_mul_i32 s30, s29, 18432
  s_lshr_b32 s101, s26, 2
  s_and_b32 s3, s26, 3
  s_lshl_b32 s3, s3, 1
  s_add_u32 s101, s101, s3
  s_sub_u32 s3, s101, 9
  s_cselect_b32 s101, s101, s3
  v_lshrrev_b32 v22, 3, v1
  v_mul_u32_u24 v34, 1152, v22
  v_lshrrev_b32 v36, 4, v1
  v_and_b32 v37, 7, v1
  v_xor_b32 v38, v36, v37
  v_lshl_add_u32 v6, v38, 4, v34
  v_xor_b32 v7, 64, v6
  v_add_u32 v7, 9216, v7
  s_mul_i32 s58, s24, 18432
  s_add_u32 s58, s58, 86016
  s_lshl_b32 s46, s101, 7
  s_add_u32 s46, s46, s30
  v_lshlrev_b32 v36, 1, v36
  v_xor_b32 v5, v36, v37
  s_lshl_b32 s33, s24, 3
  v_add_u32 v22, s33, v22
  s_add_u32 s33, s30, 1152
  s_waitcnt lgkmcnt(0)
  s_mov_b32 s72, s70
  s_mov_b32 s73, s71
  s_mov_b32 s74, 1990656
  s_mov_b32 s75, 0x20000
  s_mov_b32 s68, s68
  s_mov_b32 s69, s69
  s_mov_b32 s70, 2359296
  s_mov_b32 s71, 0x20000
  s_mov_b64 s[0:1], s[44:45]
  s_add_u32 m0, s58, 0
  s_nop 0
  buffer_load_dwordx4 v6, s[68:71], s46 offen lds
  s_add_u32 m0, s58, 1024
  s_nop 0
  buffer_load_dwordx4 v7, s[68:71], s46 offen lds
  s_mul_i32 s34, s28, 144
  s_and_b32 s32, s34, 0xffc0
  s_add_u32 s35, s32, 64
  s_and_b32 s35, s35, 0xff80
  s_add_u32 s39, s32, 128
  s_cmp_eq_u32 s35, s32
  s_cselect_b32 s32, s39, s32
  v_bfe_u32 v136, v22, 2, 2
  v_lshlrev_b32 v136, 3, v136
  v_and_b32 v137, 3, v22
  v_add_u32 v136, v136, v137
  v_lshrrev_b32 v137, 4, v22
  v_lshl_add_u32 v136, v137, 2, v136
  v_mul_u32_u24 v136, 3456, v136
  v_lshl_add_u32 v136, v5, 4, v136
  v_add_u32 v2, s35, v136
  v_add_u32 v3, 1152, v2
  v_lshrrev_b32 v137, 2, v5
  v_mul_u32_u24 v137, 1088, v137
  v_add3_u32 v4, v136, v137, s32
  s_mul_i32 s36, s24, 3072
  s_mov_b32 s76, s76
  s_mov_b32 s77, s77
  s_mov_b32 s78, 663552
  s_mov_b32 s79, 0x20000
  s_mul_i32 s37, s101, 221184
  s_add_u32 s37, s37, 1152
  s_add_u32 m0, s36, 0
  s_nop 0
  buffer_load_dwordx4 v2, s[72:75], s37 offen lds
  s_add_u32 m0, s36, 1024
  s_nop 0
  buffer_load_dwordx4 v3, s[72:75], s37 offen lds
  s_add_u32 m0, s36, 2048
  s_nop 0
  buffer_load_dwordx4 v4, s[72:75], s37 offen lds
  s_mov_b32 s80, s16
  s_mov_b32 s81, s17
  s_mov_b32 s16, s18
  s_mov_b32 s17, s19
  s_mov_b32 s18, 46137344
  s_lshl_b32 s31, s2, 2
  s_add_u32 s31, s31, s24
  s_mul_i32 s44, s31, 1152
  s_cmp_lt_u32 s31, 576
  s_cselect_b32 s44, s44, 0
  s_cselect_b32 s45, 0, 0x7f000000
  v_lshl_add_u32 v174, v1, 4, s45
  v_cmp_gt_u32 vcc, 8, v1
  v_add_u32 v175, 1024, v174
  v_mov_b32 v173, 0x7f000000
  v_cndmask_b32 v175, v173, v175, vcc
  s_nop 0
  buffer_load_dwordx4 v[160:163], v174, s[76:79], s44 offen
  s_mov_b32 s19, 0x20000
  s_mov_b32 s8, s6
  s_mov_b32 s9, s7
  s_mov_b32 s10, 5308416
  s_mov_b32 s11, 0x20000
  s_nop 0
  s_nop 0
  buffer_load_dwordx4 v[164:167], v175, s[76:79], s44 offen
  s_mov_b32 s4, s4
  s_mov_b32 s5, s5
  s_mov_b32 s6, 5308416
  s_mov_b32 s7, 0x20000
  s_mov_b32 s20, s14
  s_add_u32 s46, s46, 128
  s_cmp_eq_u32 s46, s33
  s_cselect_b32 s46, s30, s46
  s_add_u32 m0, s58, 2048
  s_nop 0
  buffer_load_dwordx4 v6, s[68:71], s46 offen lds
  s_mov_b32 s21, s15
  s_mov_b32 s22, 2359296
  s_mov_b32 s23, 0x20000
  s_mov_b32 s12, s12
  s_mov_b32 s13, s13
  s_add_u32 m0, s58, 3072
  s_nop 0
  buffer_load_dwordx4 v7, s[68:71], s46 offen lds
  s_mov_b32 s14, 5308416
  s_mov_b32 s15, 0x20000
  s_lshl_b32 s40, s25, 3
  s_lshr_b32 s41, s26, 2
  s_add_u32 s40, s40, s41
  s_add_u32 s46, s46, 128
  s_cmp_eq_u32 s46, s33
  s_cselect_b32 s46, s30, s46
  s_add_u32 m0, s58, 4096
  s_nop 0
  buffer_load_dwordx4 v6, s[68:71], s46 offen lds
  s_and_b32 s41, s26, 3
  s_mul_i32 s42, s41, 288
  s_and_b32 s43, s42, 127
  s_and_b32 s42, s42, 0xff80
  s_and_b32 s48, s24, 1
  s_add_u32 m0, s58, 5120
  s_nop 0
  buffer_load_dwordx4 v7, s[68:71], s46 offen lds
  s_mul_i32 s49, s24, 36
  s_lshl_b32 s50, s48, 2
  s_sub_u32 s49, s49, s50
  s_add_u32 s49, s49, s34
  s_mov_b32 s51, 0x3f803f80
  s_add_u32 s37, s37, 110592
  s_add_u32 m0, s36, 12288
  s_nop 0
  buffer_load_dwordx4 v2, s[72:75], s37 offen lds
  s_mov_b64 exec, 0
  s_cmp_eq_u32 s24, 0
  s_cbranch_scc1 L_wu_p1_0
  s_cmp_eq_u32 s24, 1
  s_cbranch_scc1 L_wu_p1_1
  s_cmp_eq_u32 s24, 2
  s_cbranch_scc1 L_wu_p1_2
  s_cmp_eq_u32 s24, 3
  s_cbranch_scc1 L_wu_p1_3
L_wuret_p1:
  s_mov_b64 exec, -1
  s_mov_b32 s54, 0x3fb8aa3b
  s_mov_b32 s55, s54
  s_mov_b32 s56, 0x358637bd
  s_mov_b32 s57, s56
  v_lshrrev_b32 v20, 5, v1
  s_add_u32 m0, s36, 13312
  s_nop 0
  buffer_load_dwordx4 v3, s[72:75], s37 offen lds
  v_mul_u32_u24 v20, 3072, v20
  v_bfe_u32 v36, v1, 2, 3
  v_lshl_add_u32 v20, v36, 7, v20
  v_bfe_u32 v21, v1, 3, 2
  v_lshlrev_b32 v21, 5, v21
  s_add_u32 m0, s36, 14336
  s_nop 0
  buffer_load_dwordx4 v4, s[72:75], s37 offen lds
  v_and_b32 v36, 3, v1
  v_lshl_add_u32 v35, v36, 3, s49
  v_subrev_u32 v37, s35, v35
  v_cmp_gt_u32 vcc, 128, v37
  v_subrev_u32 v39, s32, v35
  v_add_u32 v39, 2048, v39
  v_cndmask_b32 v37, v39, v37, vcc
  v_mov_b32 v39, 1024
  v_cndmask_b32 v39, 64, v39, vcc
  v_add_u32 v38, v37, v39
  s_add_u32 s37, s37, 110592
  s_cmp_ge_u32 s37, 1990656
  s_cselect_b32 s37, 1152, s37
  s_add_u32 m0, s36, 24576
  s_nop 0
  buffer_load_dwordx4 v2, s[72:75], s37 offen lds
  v_xor_b32 v37, v37, v21
  v_add_u32 v8, v37, v20
  v_add_u32 v12, 61440, v8
  v_add_u32 v16, 122880, v8
  v_xor_b32 v38, v38, v21
  s_add_u32 m0, s36, 25600
  s_nop 0
  buffer_load_dwordx4 v3, s[72:75], s37 offen lds
  v_add_u32 v9, v38, v20
  v_add_u32 v13, 61440, v9
  v_add_u32 v17, 122880, v9
  s_add_u32 s50, s49, 32
  v_mov_b32 v35, s50
  s_add_u32 m0, s36, 26624
  s_nop 0
  buffer_load_dwordx4 v4, s[72:75], s37 offen lds
  v_subrev_u32 v37, s35, v35
  v_cmp_gt_u32 vcc, 128, v37
  v_subrev_u32 v39, s32, v35
  v_add_u32 v39, 2048, v39
  v_cndmask_b32 v37, v39, v37, vcc
  v_mov_b32 v39, 1024
  v_cndmask_b32 v39, 64, v39, vcc
  v_add_u32 v38, v37, v39
  v_cmp_eq_u32 vcc, 1, v36
  s_nop 1
  v_cndmask_b32 v37, v37, v38, vcc
  v_xor_b32 v37, v37, v21
  s_add_u32 s46, s46, 128
  s_cmp_eq_u32 s46, s33
  s_cselect_b32 s46, s30, s46
  s_add_u32 m0, s58, 6144
  s_nop 0
  buffer_load_dwordx4 v6, s[68:71], s46 offen lds
  v_add_u32 v10, v37, v20
  v_add_u32 v14, 61440, v10
  v_add_u32 v18, 122880, v10
  v_accvgpr_write_b32 a248, s51
  v_accvgpr_write_b32 a249, s51
  s_add_u32 m0, s58, 7168
  s_nop 0
  buffer_load_dwordx4 v7, s[68:71], s46 offen lds
  v_accvgpr_write_b32 a250, s51
  v_accvgpr_write_b32 a251, s51
  v_and_b32 v34, 15, v1
  v_lshrrev_b32 v36, 4, v1
  v_lshrrev_b32 v37, 1, v34
  s_sub_u32 s44, s2, 192
  s_cselect_b32 s45, 0x7f000000, 0
  s_and_b32 s44, s44, 63
  s_lshl_b32 s44, s44, 12
  s_add_u32 s44, s44, 7864320
  v_mov_b32 v168, 0
  v_mov_b32 v169, 0
  v_mov_b32 v170, 0
  v_mov_b32 v171, 0
  v_lshl_add_u32 v172, v0, 4, s45
  s_nop 0
  buffer_store_dwordx4 v[168:171], v172, s[16:19], s44 offen sc1
  v_xor_b32 v36, v36, v37
  v_lshlrev_b32 v34, 7, v34
  v_lshl_add_u32 v34, v36, 4, v34
  v_xor_b32 v35, 64, v34
  s_add_u32 s38, s24, 0
  s_add_u32 s37, s37, 110592
  s_add_u32 m0, s36, 36864
  s_nop 0
  buffer_load_dwordx4 v2, s[72:75], s37 offen lds
  s_and_b32 s38, s38, 3
  s_mul_i32 s38, s38, 18432
  s_add_u32 s38, s38, 86016
  v_add_u32 v23, s38, v34
  v_add_u32 v24, s38, v35
  s_add_u32 m0, s36, 37888
  s_nop 0
  buffer_load_dwordx4 v3, s[72:75], s37 offen lds
  s_add_u32 s38, s24, 1
  s_and_b32 s38, s38, 3
  s_mul_i32 s38, s38, 18432
  s_add_u32 s38, s38, 86016
  v_add_u32 v25, s38, v34
  s_add_u32 m0, s36, 38912
  s_nop 0
  buffer_load_dwordx4 v4, s[72:75], s37 offen lds
  v_add_u32 v26, s38, v35
  s_add_u32 s38, s24, 2
  s_and_b32 s38, s38, 3
  s_mul_i32 s38, s38, 18432
  s_add_u32 s38, s38, 86016
  s_add_u32 s46, s46, 128
  s_cmp_eq_u32 s46, s33
  s_cselect_b32 s46, s30, s46
  s_add_u32 m0, s58, 8192
  s_nop 0
  buffer_load_dwordx4 v6, s[68:71], s46 offen lds
  v_add_u32 v27, s38, v34
  v_add_u32 v29, s38, v35
  s_add_u32 s38, s24, 3
  s_and_b32 s38, s38, 3
  s_add_u32 m0, s58, 9216
  s_nop 0
  buffer_load_dwordx4 v7, s[68:71], s46 offen lds
  s_mul_i32 s38, s38, 18432
  s_add_u32 s38, s38, 86016
  v_add_u32 v30, s38, v34
  v_add_u32 v31, s38, v35
  s_waitcnt vmcnt(11)
  s_barrier
  ds_read_b64_tr_b16 a[216:217], v8 offset:0
  ds_read_b64_tr_b16 a[218:219], v8 offset:6144
  ds_read_b64_tr_b16 a[220:221], v9 offset:0
  ds_read_b64_tr_b16 a[222:223], v9 offset:6144
  ds_read_b64_tr_b16 a[224:225], v10 offset:0
  ds_read_b64_tr_b16 a[226:227], v10 offset:6144
  ds_read_b128 v[184:187], v23 offset:0
  ds_read_b128 a[0:3], v25 offset:0
  ds_read_b128 a[4:7], v27 offset:0
  ds_read_b128 a[8:11], v30 offset:0
  ds_read_b128 v[188:191], v24 offset:0
  ds_read_b128 a[12:15], v26 offset:0
  ds_read_b128 a[16:19], v29 offset:0
  ds_read_b128 a[20:23], v31 offset:0
  s_waitcnt lgkmcnt(4)
  v_mfma_f32_16x16x32_bf16 v[40:43], v[184:187], a[216:219], 0
  ds_read_b64_tr_b16 a[232:233], v8 offset:12288
  v_and_b32 v134, 3, v1
  v_mfma_f32_16x16x32_bf16 v[44:47], a[0:3], a[216:219], 0
  s_add_u32 s37, s37, 110592
  s_cmp_ge_u32 s37, 1990656
  s_cselect_b32 s37, 1152, s37
  s_add_u32 m0, s36, 49152
  ds_read_b64_tr_b16 a[234:235], v8 offset:18432
  s_lshl_b32 s50, s24, 5
  v_mfma_f32_16x16x32_bf16 v[48:51], a[4:7], a[216:219], 0
  buffer_load_dwordx4 v2, s[72:75], s37 offen lds
  ds_read_b64_tr_b16 a[236:237], v9 offset:12288
  v_mfma_f32_16x16x32_bf16 v[52:55], a[8:11], a[216:219], 0
  s_add_u32 m0, s36, 50176
  ds_read_b64_tr_b16 a[238:239], v9 offset:18432
  s_add_u32 s50, s50, s34
  v_mfma_f32_16x16x32_bf16 v[108:111], a[248:251], a[216:219], 0
  buffer_load_dwordx4 v3, s[72:75], s37 offen lds
  ds_read_b64_tr_b16 a[240:241], v10 offset:12288
  v_mfma_f32_16x16x32_bf16 v[56:59], v[184:187], a[220:223], 0
  ds_read_b64_tr_b16 a[242:243], v10 offset:18432
  v_lshl_add_u32 v133, v134, 3, s50
  v_mfma_f32_16x16x32_bf16 v[60:63], a[0:3], a[220:223], 0
  s_add_u32 m0, s36, 51200
  v_subrev_u32 v132, s35, v133
  v_cmp_gt_u32 vcc, 128, v132
  v_subrev_u32 v146, s32, v133
  v_add_u32 v146, 2048, v146
  v_cndmask_b32 v132, v146, v132, vcc
  v_mov_b32 v146, 1024
  v_cndmask_b32 v146, 64, v146, vcc
  v_mfma_f32_16x16x32_bf16 v[64:67], a[4:7], a[220:223], 0
  buffer_load_dwordx4 v4, s[72:75], s37 offen lds
  v_add_u32 v135, v132, v146
  v_mfma_f32_16x16x32_bf16 v[68:71], a[8:11], a[220:223], 0
  s_add_u32 s46, s46, 128
  s_cmp_eq_u32 s46, s33
  s_cselect_b32 s46, s30, s46
  s_add_u32 m0, s58, 10240
  v_xor_b32 v132, v132, v21
  v_add_u32 v132, v132, v20
  v_mfma_f32_16x16x32_bf16 v[112:115], a[248:251], a[220:223], 0
  buffer_load_dwordx4 v6, s[68:71], s46 offen lds
  v_accvgpr_write_b32 a252, v132
  v_mfma_f32_16x16x32_bf16 v[72:75], v[184:187], a[224:227], 0
  v_xor_b32 v135, v135, v21
  v_add_u32 v135, v135, v20
  v_mfma_f32_16x16x32_bf16 v[76:79], a[0:3], a[224:227], 0
  s_add_u32 m0, s58, 11264
  v_accvgpr_write_b32 a253, v135
  v_and_b32 v134, 1, v1
  v_mfma_f32_16x16x32_bf16 v[80:83], a[4:7], a[224:227], 0
  buffer_load_dwordx4 v7, s[68:71], s46 offen lds
  s_add_u32 s50, s34, 128
  v_mfma_f32_16x16x32_bf16 v[84:87], a[8:11], a[224:227], 0
  s_waitcnt vmcnt(13) lgkmcnt(0)
  v_mfma_f32_16x16x32_bf16 v[116:119], a[248:251], a[224:227], 0
  s_barrier
  v_mfma_f32_16x16x32_bf16 v[40:43], v[188:191], a[232:235], v[40:43]
  ds_read_b64_tr_b16 a[216:217], v8 offset:24576
  v_lshl_add_u32 v133, v134, 3, s50
  v_mfma_f32_16x16x32_bf16 v[44:47], a[12:15], a[232:235], v[44:47]
  s_add_u32 s37, s37, 110592
  s_add_u32 m0, s36, 61440
  ds_read_b64_tr_b16 a[218:219], v8 offset:30720
  v_subrev_u32 v132, s35, v133
  v_mfma_f32_16x16x32_bf16 v[48:51], a[16:19], a[232:235], v[48:51]
  buffer_load_dwordx4 v2, s[72:75], s37 offen lds
  ds_read_b64_tr_b16 a[220:221], v9 offset:24576
  v_mfma_f32_16x16x32_bf16 v[52:55], a[20:23], a[232:235], v[52:55]
  s_add_u32 m0, s36, 62464
  ds_read_b64_tr_b16 a[222:223], v9 offset:30720
  v_cmp_gt_u32 vcc, 128, v132
  v_subrev_u32 v146, s32, v133
  v_add_u32 v146, 2048, v146
  v_cndmask_b32 v132, v146, v132, vcc
  v_mov_b32 v146, 1024
  v_cndmask_b32 v146, 64, v146, vcc
  v_mfma_f32_16x16x32_bf16 v[108:111], a[248:251], a[232:235], v[108:111]
  buffer_load_dwordx4 v3, s[72:75], s37 offen lds
  ds_read_b64_tr_b16 a[224:225], v10 offset:24576
  v_mfma_f32_16x16x32_bf16 v[56:59], v[188:191], a[236:239], v[56:59]
  ds_read_b64_tr_b16 a[226:227], v10 offset:30720
  ds_read_b128 v[192:195], v23 offset:2048
  v_mfma_f32_16x16x32_bf16 v[60:63], a[12:15], a[236:239], v[60:63]
  s_add_u32 m0, s36, 63488
  ds_read_b128 a[24:27], v25 offset:2048
  v_add_u32 v135, v132, v146
  v_mfma_f32_16x16x32_bf16 v[64:67], a[16:19], a[236:239], v[64:67]
  buffer_load_dwordx4 v4, s[72:75], s37 offen lds
  ds_read_b128 a[28:31], v27 offset:2048
  v_mfma_f32_16x16x32_bf16 v[68:71], a[20:23], a[236:239], v[68:71]
  s_add_u32 s46, s46, 128
  s_cmp_eq_u32 s46, s33
  s_cselect_b32 s46, s30, s46
  s_add_u32 m0, s58, 12288
  ds_read_b128 a[32:35], v30 offset:2048
  v_xor_b32 v132, v132, v21
  v_mfma_f32_16x16x32_bf16 v[112:115], a[248:251], a[236:239], v[112:115]
  buffer_load_dwordx4 v6, s[68:71], s46 offen lds
  ds_read_b128 v[196:199], v24 offset:2048
  v_mfma_f32_16x16x32_bf16 v[72:75], v[188:191], a[240:243], v[72:75]
  ds_read_b128 a[36:39], v26 offset:2048
  v_add_u32 v132, v132, v20
  v_mfma_f32_16x16x32_bf16 v[76:79], a[12:15], a[240:243], v[76:79]
  s_add_u32 m0, s58, 13312
  ds_read_b128 a[40:43], v29 offset:2048
  v_accvgpr_write_b32 a254, v132
  v_mfma_f32_16x16x32_bf16 v[80:83], a[16:19], a[240:243], v[80:83]
  buffer_load_dwordx4 v7, s[68:71], s46 offen lds
  ds_read_b128 a[44:47], v31 offset:2048
  v_mfma_f32_16x16x32_bf16 v[84:87], a[20:23], a[240:243], v[84:87]
  s_waitcnt vmcnt(12) lgkmcnt(4)
  v_mfma_f32_16x16x32_bf16 v[116:119], a[248:251], a[240:243], v[116:119]
  s_barrier
  v_mfma_f32_16x16x32_bf16 v[40:43], v[192:195], a[216:219], v[40:43]
  ds_read_b64_tr_b16 a[232:233], v8 offset:36864
  v_xor_b32 v135, v135, v21
  v_mfma_f32_16x16x32_bf16 v[44:47], a[24:27], a[216:219], v[44:47]
  s_add_u32 s37, s37, 110592
  s_cmp_ge_u32 s37, 1990656
  s_cselect_b32 s37, 1152, s37
  s_add_u32 m0, s36, 73728
  ds_read_b64_tr_b16 a[234:235], v8 offset:43008
  v_add_u32 v135, v135, v20
  v_mfma_f32_16x16x32_bf16 v[48:51], a[28:31], a[216:219], v[48:51]
  buffer_load_dwordx4 v2, s[72:75], s37 offen lds
  ds_read_b64_tr_b16 a[236:237], v9 offset:36864
  v_mfma_f32_16x16x32_bf16 v[52:55], a[32:35], a[216:219], v[52:55]
  s_add_u32 m0, s36, 74752
  ds_read_b64_tr_b16 a[238:239], v9 offset:43008
  v_accvgpr_write_b32 a255, v135
  v_mfma_f32_16x16x32_bf16 v[148:151], a[248:251], v[184:187], 0
  buffer_load_dwordx4 v3, s[72:75], s37 offen lds
  ds_read_b64_tr_b16 a[240:241], v10 offset:36864
  v_mfma_f32_16x16x32_bf16 v[152:155], v[184:187], v[184:187], 0
  ds_read_b64_tr_b16 a[242:243], v10 offset:43008
  ds_read_b128 v[200:203], v23 offset:4096
  v_mfma_f32_16x16x32_bf16 v[108:111], a[248:251], a[216:219], v[108:111]
  s_add_u32 m0, s36, 75776
  ds_read_b128 a[48:51], v25 offset:4096
  s_mul_i32 s39, s24, 1536
  v_mfma_f32_16x16x32_bf16 v[56:59], v[192:195], a[220:223], v[56:59]
  buffer_load_dwordx4 v4, s[72:75], s37 offen lds
  ds_read_b128 a[52:55], v27 offset:4096
  v_mfma_f32_16x16x32_bf16 v[60:63], a[24:27], a[220:223], v[60:63]
  s_add_u32 s46, s46, 128
  s_cmp_eq_u32 s46, s33
  s_cselect_b32 s46, s30, s46
  s_add_u32 m0, s58, 14336
  ds_read_b128 a[56:59], v30 offset:4096
  s_add_u32 s39, s39, 147456
  v_mfma_f32_16x16x32_bf16 v[64:67], a[28:31], a[220:223], v[64:67]
  buffer_load_dwordx4 v6, s[68:71], s46 offen lds
  ds_read_b128 v[204:207], v24 offset:4096
  v_mfma_f32_16x16x32_bf16 v[68:71], a[32:35], a[220:223], v[68:71]
  ds_read_b128 a[60:63], v26 offset:4096
  v_and_b32 v34, 15, v1
  v_mfma_f32_16x16x32_bf16 v[148:151], a[248:251], v[188:191], v[148:151]
  s_add_u32 m0, s58, 15360
  ds_read_b128 a[64:67], v29 offset:4096
  v_lshrrev_b32 v36, 4, v1
  v_mfma_f32_16x16x32_bf16 v[152:155], v[188:191], v[188:191], v[152:155]
  buffer_load_dwordx4 v7, s[68:71], s46 offen lds
  ds_read_b128 a[68:71], v31 offset:4096
  v_mfma_f32_16x16x32_bf16 v[112:115], a[248:251], a[220:223], v[112:115]
  s_add_u32 s38, s24, 0
  s_and_b32 s38, s38, 3
  v_mfma_f32_16x16x32_bf16 v[72:75], v[192:195], a[224:227], v[72:75]
  s_lshl_b32 s38, s38, 6
  s_add_u32 s38, s38, 161280
  v_mfma_f32_16x16x32_bf16 v[76:79], a[24:27], a[224:227], v[76:79]
  v_lshl_add_u32 v104, v36, 4, s38
  v_lshl_add_u32 v131, v34, 2, s38
  v_mfma_f32_16x16x32_bf16 v[80:83], a[28:31], a[224:227], v[80:83]
  s_add_u32 s38, s24, 1
  s_and_b32 s38, s38, 3
  v_mfma_f32_16x16x32_bf16 v[84:87], a[32:35], a[224:227], v[84:87]
  s_waitcnt vmcnt(12) lgkmcnt(8)
  v_mfma_f32_16x16x32_bf16 v[116:119], a[248:251], a[224:227], v[116:119]
  s_barrier
  s_lshl_b32 s3, s24, 8
  s_sub_u32 s3, s2, s3
  s_cmp_lt_i32 s3, 192
  s_cbranch_scc1 L_k1_nocnt
  s_lshl_b32 s47, s25, 5
  v_mov_b32 v172, s47
  v_mov_b32 v173, 1
  s_mov_b64 exec, 1
  global_atomic_add v172, v173, s[80:81]
  s_mov_b64 exec, -1
L_k1_nocnt:
  v_mfma_f32_16x16x32_bf16 v[40:43], v[196:199], a[232:235], v[40:43]
  ds_read_b64_tr_b16 a[216:217], v8 offset:49152
  s_lshl_b32 s38, s38, 6
  v_mfma_f32_16x16x32_bf16 v[44:47], a[36:39], a[232:235], v[44:47]
  s_add_u32 s37, s37, 110592
  s_add_u32 m0, s36, 0
  ds_read_b64_tr_b16 a[218:219], v8 offset:55296
  s_add_u32 s38, s38, 161280
  v_mfma_f32_16x16x32_bf16 v[48:51], a[40:43], a[232:235], v[48:51]
  buffer_load_dwordx4 v2, s[72:75], s37 offen lds
  ds_read_b64_tr_b16 a[220:221], v9 offset:49152
  v_mfma_f32_16x16x32_bf16 v[52:55], a[44:47], a[232:235], v[52:55]
  s_add_u32 m0, s36, 1024
  ds_read_b64_tr_b16 a[222:223], v9 offset:55296
  v_lshl_add_u32 v105, v36, 4, s38
  v_mfma_f32_16x16x32_bf16 v[148:151], a[248:251], v[192:195], v[148:151]
  buffer_load_dwordx4 v3, s[72:75], s37 offen lds
  ds_read_b64_tr_b16 a[224:225], v10 offset:49152
  v_mfma_f32_16x16x32_bf16 v[152:155], v[192:195], v[192:195], v[152:155]
  ds_read_b64_tr_b16 a[226:227], v10 offset:55296
  ds_read_b128 v[208:211], v23 offset:6144
  v_mfma_f32_16x16x32_bf16 v[108:111], a[248:251], a[232:235], v[108:111]
  s_add_u32 m0, s36, 2048
  ds_read_b128 a[72:75], v25 offset:6144
  v_lshl_add_u32 v138, v34, 2, s38
  v_mfma_f32_16x16x32_bf16 v[56:59], v[196:199], a[236:239], v[56:59]
  buffer_load_dwordx4 v4, s[72:75], s37 offen lds
  ds_read_b128 a[76:79], v27 offset:6144
  v_mfma_f32_16x16x32_bf16 v[60:63], a[36:39], a[236:239], v[60:63]
  s_add_u32 s46, s46, 128
  s_cmp_eq_u32 s46, s33
  s_cselect_b32 s46, s30, s46
  s_add_u32 m0, s58, 16384
  ds_read_b128 a[80:83], v30 offset:6144
  s_add_u32 s38, s24, 2
  v_mfma_f32_16x16x32_bf16 v[64:67], a[40:43], a[236:239], v[64:67]
  buffer_load_dwordx4 v6, s[68:71], s46 offen lds
  ds_read_b128 v[212:215], v24 offset:6144
  v_mfma_f32_16x16x32_bf16 v[68:71], a[44:47], a[236:239], v[68:71]
  ds_read_b128 a[84:87], v26 offset:6144
  s_and_b32 s38, s38, 3
  v_mfma_f32_16x16x32_bf16 v[148:151], a[248:251], v[196:199], v[148:151]
  s_add_u32 m0, s58, 17408
  ds_read_b128 a[88:91], v29 offset:6144
  s_lshl_b32 s38, s38, 6
  v_mfma_f32_16x16x32_bf16 v[152:155], v[196:199], v[196:199], v[152:155]
  buffer_load_dwordx4 v7, s[68:71], s46 offen lds
  ds_read_b128 a[92:95], v31 offset:6144
  v_mfma_f32_16x16x32_bf16 v[112:115], a[248:251], a[236:239], v[112:115]
  s_add_u32 s38, s38, 161280
  v_lshl_add_u32 v106, v36, 4, s38
  v_mfma_f32_16x16x32_bf16 v[72:75], v[196:199], a[240:243], v[72:75]
  v_lshl_add_u32 v139, v34, 2, s38
  s_add_u32 s38, s24, 3
  v_mfma_f32_16x16x32_bf16 v[76:79], a[36:39], a[240:243], v[76:79]
  s_and_b32 s38, s38, 3
  s_lshl_b32 s38, s38, 6
  v_mfma_f32_16x16x32_bf16 v[80:83], a[40:43], a[240:243], v[80:83]
  s_add_u32 s38, s38, 161280
  v_lshl_add_u32 v107, v36, 4, s38
  v_mfma_f32_16x16x32_bf16 v[84:87], a[44:47], a[240:243], v[84:87]
  s_waitcnt vmcnt(12) lgkmcnt(8)
  v_mfma_f32_16x16x32_bf16 v[116:119], a[248:251], a[240:243], v[116:119]
  s_barrier
  v_mfma_f32_16x16x32_bf16 v[40:43], v[200:203], a[216:219], v[40:43]
  ds_read_b64_tr_b16 a[232:233], v12 offset:0
  v_lshl_add_u32 v28, v34, 2, s38
  v_mfma_f32_16x16x32_bf16 v[44:47], a[48:51], a[216:219], v[44:47]
  ds_read_b64_tr_b16 a[234:235], v12 offset:6144
  s_lshl_b32 s59, s48, 1
  v_mfma_f32_16x16x32_bf16 v[48:51], a[52:55], a[216:219], v[48:51]
  ds_read_b64_tr_b16 a[236:237], v13 offset:0
  v_mul_u32_u24 v37, 304, v36
  v_mfma_f32_16x16x32_bf16 v[52:55], a[56:59], a[216:219], v[52:55]
  s_add_u32 s37, s37, 110592
  s_cmp_ge_u32 s37, 1990656
  s_cselect_b32 s37, 1152, s37
  s_add_u32 m0, s36, 12288
  ds_read_b64_tr_b16 a[238:239], v13 offset:6144
  v_add_u32 v37, s39, v37
  v_mfma_f32_16x16x32_bf16 v[148:151], a[248:251], v[200:203], v[148:151]
  buffer_load_dwordx4 v2, s[72:75], s37 offen lds
  ds_read_b64_tr_b16 a[240:241], v14 offset:0
  v_mfma_f32_16x16x32_bf16 v[152:155], v[200:203], v[200:203], v[152:155]
  ds_read_b64_tr_b16 a[242:243], v14 offset:6144
  ds_read_b128 v[216:219], v23 offset:8192
  v_mfma_f32_16x16x32_bf16 v[108:111], a[248:251], a[216:219], v[108:111]
  ds_read_b128 a[96:99], v25 offset:8192
  v_lshlrev_b32 v35, 4, v1
  v_mfma_f32_16x16x32_bf16 v[56:59], v[200:203], a[220:223], v[56:59]
  s_add_u32 m0, s36, 13312
  ds_read_b128 a[100:103], v27 offset:8192
  v_add_u32 v35, 159744, v35
  v_mfma_f32_16x16x32_bf16 v[60:63], a[48:51], a[220:223], v[60:63]
  buffer_load_dwordx4 v3, s[72:75], s37 offen lds
  ds_read_b128 a[104:107], v30 offset:8192
  v_mfma_f32_16x16x32_bf16 v[64:67], a[52:55], a[220:223], v[64:67]
  ds_read_b128 v[220:223], v24 offset:8192
  v_cmp_le_u32 s[60:61], s59, v34
  v_mfma_f32_16x16x32_bf16 v[68:71], a[56:59], a[220:223], v[68:71]
L_wu_p1_0:
L_st_4000:
  s_cbranch_execz L_wuret_p1
  ds_read_b128 a[108:111], v26 offset:8192
  v_subrev_u32 v39, s59, v34
  v_mfma_f32_16x16x32_bf16 v[148:151], a[248:251], v[204:207], v[148:151]
  s_add_u32 m0, s36, 14336
  ds_read_b128 a[112:115], v29 offset:8192
  v_lshl_add_u32 v38, v39, 4, v37
  v_mfma_f32_16x16x32_bf16 v[152:155], v[204:207], v[204:207], v[152:155]
  buffer_load_dwordx4 v4, s[72:75], s37 offen lds
  ds_read_b128 a[116:119], v31 offset:8192
  v_mfma_f32_16x16x32_bf16 v[112:115], a[248:251], a[220:223], v[112:115]
  v_cmp_eq_u32 s[66:67], 0, v36
  v_cndmask_b32 v140, v35, v38, s[60:61]
  v_mfma_f32_16x16x32_bf16 v[72:75], v[200:203], a[224:227], v[72:75]
  s_and_b64 s[60:61], s[60:61], s[66:67]
  v_add_u32 v38, 1216, v38
  v_mfma_f32_16x16x32_bf16 v[76:79], a[48:51], a[224:227], v[76:79]
  v_cndmask_b32 v142, v35, v38, s[60:61]
  v_cmp_gt_u32 s[60:61], 6, v39
  v_mfma_f32_16x16x32_bf16 v[80:83], a[52:55], a[224:227], v[80:83]
  v_cmp_lt_u32 s[62:63], 3, v34
  v_cmp_eq_u32 s[52:53], 8, v34
  v_mfma_f32_16x16x32_bf16 v[84:87], a[56:59], a[224:227], v[84:87]
  s_waitcnt vmcnt(10) lgkmcnt(8)
  v_mfma_f32_16x16x32_bf16 v[116:119], a[248:251], a[224:227], v[116:119]
  s_barrier
  v_mfma_f32_16x16x32_bf16 v[40:43], v[204:207], a[232:235], v[40:43]
  ds_read_b64_tr_b16 a[216:217], v12 offset:12288
  v_add_u32 v39, 12, v39
  v_mfma_f32_16x16x32_bf16 v[44:47], a[60:63], a[232:235], v[44:47]
  ds_read_b64_tr_b16 a[218:219], v12 offset:18432
  s_and_b64 s[60:61], s[60:61], s[62:63]
  v_mfma_f32_16x16x32_bf16 v[48:51], a[64:67], a[232:235], v[48:51]
  s_add_u32 s37, s37, 110592
  s_add_u32 m0, s36, 24576
  ds_read_b64_tr_b16 a[220:221], v13 offset:12288
  s_or_b64 s[60:61], s[60:61], s[52:53]
  v_mfma_f32_16x16x32_bf16 v[52:55], a[68:71], a[232:235], v[52:55]
  buffer_load_dwordx4 v2, s[72:75], s37 offen lds
  ds_read_b64_tr_b16 a[222:223], v13 offset:18432
  v_mfma_f32_16x16x32_bf16 v[148:151], a[248:251], v[208:211], v[148:151]
  ds_read_b64_tr_b16 a[224:225], v14 offset:12288
  v_cndmask_b32 v39, v39, 18, s[52:53]
  v_mfma_f32_16x16x32_bf16 v[152:155], v[208:211], v[208:211], v[152:155]
  s_add_u32 m0, s36, 25600
  ds_read_b64_tr_b16 a[226:227], v14 offset:18432
  ds_read_b128 v[224:227], v23 offset:10240
  v_mfma_f32_16x16x32_bf16 v[108:111], a[248:251], a[232:235], v[108:111]
  buffer_load_dwordx4 v3, s[72:75], s37 offen lds
  ds_read_b128 a[120:123], v25 offset:10240
  v_mfma_f32_16x16x32_bf16 v[56:59], v[204:207], a[236:239], v[56:59]
  ds_read_b128 a[124:127], v27 offset:10240
  v_lshl_add_u32 v38, v39, 4, v37
  v_mfma_f32_16x16x32_bf16 v[60:63], a[60:63], a[236:239], v[60:63]
  s_add_u32 m0, s36, 26624
  ds_read_b128 a[128:131], v30 offset:10240
  v_cndmask_b32 v141, v35, v38, s[60:61]
  v_mfma_f32_16x16x32_bf16 v[64:67], a[64:67], a[236:239], v[64:67]
  buffer_load_dwordx4 v4, s[72:75], s37 offen lds
  ds_read_b128 v[228:231], v24 offset:10240
  v_mfma_f32_16x16x32_bf16 v[68:71], a[68:71], a[236:239], v[68:71]
  ds_read_b128 a[132:135], v26 offset:10240
  s_and_b64 s[60:61], s[60:61], s[66:67]
  v_mfma_f32_16x16x32_bf16 v[148:151], a[248:251], v[212:215], v[148:151]
  s_add_u32 s37, s37, 110592
  s_cmp_ge_u32 s37, 1990656
  s_cselect_b32 s37, 1152, s37
  s_add_u32 m0, s36, 36864
  ds_read_b128 a[136:139], v29 offset:10240
  v_add_u32 v38, 1216, v38
  v_mfma_f32_16x16x32_bf16 v[152:155], v[212:215], v[212:215], v[152:155]
  buffer_load_dwordx4 v2, s[72:75], s37 offen lds
  ds_read_b128 a[140:143], v31 offset:10240
  v_mfma_f32_16x16x32_bf16 v[112:115], a[248:251], a[236:239], v[112:115]
  v_cndmask_b32 v143, v35, v38, s[60:61]
  s_cmp_eq_u32 s48, 1
  s_cselect_b64 s[66:67], s[66:67], 0
  s_cselect_b64 s[52:53], 0, -1
  v_mfma_f32_16x16x32_bf16 v[72:75], v[204:207], a[240:243], v[72:75]
  v_lshrrev_b32 v39, 2, v34
  v_cmp_eq_u32 s[60:61], v39, v36
  v_mfma_f32_16x16x32_bf16 v[76:79], a[60:63], a[240:243], v[76:79]
  v_and_b32 v145, 3, v34
  s_nop 0
  v_mfma_f32_16x16x32_bf16 v[80:83], a[64:67], a[240:243], v[80:83]
  v_cndmask_b32 v144, v35, v131, s[60:61]
  v_cmp_lt_u32 s[60:61], 7, v34
  v_mfma_f32_16x16x32_bf16 v[84:87], a[68:71], a[240:243], v[84:87]
  s_waitcnt vmcnt(9) lgkmcnt(8)
  v_mfma_f32_16x16x32_bf16 v[116:119], a[248:251], a[240:243], v[116:119]
  s_barrier
  v_mfma_f32_16x16x32_bf16 v[40:43], v[208:211], a[216:219], v[40:43]
  ds_read_b64_tr_b16 a[232:233], v8 offset:0
  v_lshrrev_b32 v39, 2, v34
  v_mfma_f32_16x16x32_bf16 v[44:47], a[72:75], a[216:219], v[44:47]
  ds_read_b64_tr_b16 a[234:235], v8 offset:6144
  v_cmp_eq_u32 s[62:63], 1, v39
  v_mfma_f32_16x16x32_bf16 v[48:51], a[76:79], a[216:219], v[48:51]
  s_add_u32 m0, s36, 37888
  ds_read_b64_tr_b16 a[236:237], v9 offset:0
  v_mov_b32 v156, s54
  v_mfma_f32_16x16x32_bf16 v[52:55], a[80:83], a[216:219], v[52:55]
  buffer_load_dwordx4 v3, s[72:75], s37 offen lds
  ds_read_b64_tr_b16 a[238:239], v9 offset:6144
  v_mfma_f32_16x16x32_bf16 v[148:151], a[248:251], v[216:219], v[148:151]
  ds_read_b64_tr_b16 a[240:241], v10 offset:0
  v_mov_b32 v157, 0xff800000
  v_mfma_f32_16x16x32_bf16 v[152:155], v[216:219], v[216:219], v[152:155]
  s_add_u32 m0, s36, 38912
  ds_read_b64_tr_b16 a[242:243], v10 offset:6144
  ds_read_b128 v[232:235], v23 offset:12288
  v_mfma_f32_16x16x32_bf16 v[108:111], a[248:251], a[216:219], v[108:111]
  buffer_load_dwordx4 v4, s[72:75], s37 offen lds
  ds_read_b128 a[144:147], v25 offset:12288
  v_mfma_f32_16x16x32_bf16 v[56:59], v[208:211], a[220:223], v[56:59]
  ds_read_b128 a[148:151], v27 offset:12288
  v_mov_b32 v158, 0x7f800000
  v_mfma_f32_16x16x32_bf16 v[60:63], a[72:75], a[220:223], v[60:63]
  s_add_u32 s37, s37, 110592
  s_add_u32 m0, s36, 49152
  ds_read_b128 a[152:155], v30 offset:12288
  v_mov_b32 v32, s56
  v_mfma_f32_16x16x32_bf16 v[64:67], a[76:79], a[220:223], v[64:67]
  buffer_load_dwordx4 v2, s[72:75], s37 offen lds
  ds_read_b128 v[236:239], v24 offset:12288
  v_mfma_f32_16x16x32_bf16 v[68:71], a[80:83], a[220:223], v[68:71]
  ds_read_b128 a[156:159], v26 offset:12288
  v_cndmask_b32 v156, v156, 0, s[60:61]
  v_mfma_f32_16x16x32_bf16 v[148:151], a[248:251], v[220:223], v[148:151]
  s_add_u32 m0, s36, 50176
  ds_read_b128 a[160:163], v29 offset:12288
  v_cndmask_b32 v157, 0, v157, s[62:63]
  v_mfma_f32_16x16x32_bf16 v[152:155], v[220:223], v[220:223], v[152:155]
  buffer_load_dwordx4 v3, s[72:75], s37 offen lds
  ds_read_b128 a[164:167], v31 offset:12288
  v_mfma_f32_16x16x32_bf16 v[112:115], a[248:251], a[220:223], v[112:115]
  v_cndmask_b32 v158, v158, 0, s[60:61]
  v_cndmask_b32 v159, 1.0, 0, s[62:63]
  v_mfma_f32_16x16x32_bf16 v[72:75], v[208:211], a[224:227], v[72:75]
  v_cndmask_b32 v32, v32, 0, s[62:63]
  v_mov_b32 v35, s39
  v_mfma_f32_16x16x32_bf16 v[76:79], a[72:75], a[224:227], v[76:79]
  v_lshl_add_u32 v33, v1, 2, s39
  s_lshl_b32 s64, s28, 2
  v_mfma_f32_16x16x32_bf16 v[80:83], a[76:79], a[224:227], v[80:83]
  s_add_u32 s64, s64, s24
  s_mul_i32 s64, s64, 1536
  v_mfma_f32_16x16x32_bf16 v[84:87], a[80:83], a[224:227], v[84:87]
  s_waitcnt vmcnt(8) lgkmcnt(8)
  v_mfma_f32_16x16x32_bf16 v[116:119], a[248:251], a[224:227], v[116:119]
  s_barrier
  v_mfma_f32_16x16x32_bf16 v[40:43], v[212:215], a[232:235], v[40:43]
  ds_read_b64_tr_b16 a[216:217], v8 offset:12288
  s_add_u32 s65, s64, 7864320
  v_mfma_f32_16x16x32_bf16 v[44:47], a[84:87], a[232:235], v[44:47]
  ds_read_b64_tr_b16 a[218:219], v8 offset:18432
  v_lshlrev_b32 v37, 2, v1
  v_mfma_f32_16x16x32_bf16 v[48:51], a[88:91], a[232:235], v[48:51]
  s_add_u32 m0, s36, 51200
  ds_read_b64_tr_b16 a[220:221], v9 offset:12288
  v_mfma_f32_16x16x32_bf16 v[52:55], a[92:95], a[232:235], v[52:55]
  buffer_load_dwordx4 v4, s[72:75], s37 offen lds
  ds_read_b64_tr_b16 a[222:223], v9 offset:18432
  v_mfma_f32_16x16x32_bf16 v[148:151], a[248:251], v[224:227], v[148:151]
  ds_read_b64_tr_b16 a[224:225], v10 offset:12288
  v_mfma_f32_16x16x32_bf16 v[152:155], v[224:227], v[224:227], v[152:155]
  s_add_u32 s37, s37, 110592
  s_cmp_ge_u32 s37, 1990656
  s_cselect_b32 s37, 1152, s37
  s_add_u32 m0, s36, 61440
  ds_read_b64_tr_b16 a[226:227], v10 offset:18432
  ds_read_b128 v[240:243], v23 offset:14336
  v_mfma_f32_16x16x32_bf16 v[108:111], a[248:251], a[232:235], v[108:111]
  buffer_load_dwordx4 v2, s[72:75], s37 offen lds
  ds_read_b128 a[168:171], v25 offset:14336
  v_mfma_f32_16x16x32_bf16 v[56:59], v[212:215], a[236:239], v[56:59]
  ds_read_b128 a[172:175], v27 offset:14336
  v_mfma_f32_16x16x32_bf16 v[60:63], a[84:87], a[236:239], v[60:63]
  s_add_u32 m0, s36, 62464
  ds_read_b128 a[176:179], v30 offset:14336
  v_mfma_f32_16x16x32_bf16 v[64:67], a[88:91], a[236:239], v[64:67]
  buffer_load_dwordx4 v3, s[72:75], s37 offen lds
  ds_read_b128 v[244:247], v24 offset:14336
  v_mfma_f32_16x16x32_bf16 v[68:71], a[92:95], a[236:239], v[68:71]
  ds_read_b128 a[180:183], v26 offset:14336
  v_mfma_f32_16x16x32_bf16 v[148:151], a[248:251], v[228:231], v[148:151]
  s_add_u32 m0, s36, 63488
  ds_read_b128 a[184:187], v29 offset:14336
  v_mfma_f32_16x16x32_bf16 v[152:155], v[228:231], v[228:231], v[152:155]
  buffer_load_dwordx4 v4, s[72:75], s37 offen lds
  ds_read_b128 a[188:191], v31 offset:14336
  v_mfma_f32_16x16x32_bf16 v[112:115], a[248:251], a[236:239], v[112:115]
  v_mfma_f32_16x16x32_bf16 v[72:75], v[212:215], a[240:243], v[72:75]
  v_mfma_f32_16x16x32_bf16 v[76:79], a[84:87], a[240:243], v[76:79]
  v_mfma_f32_16x16x32_bf16 v[80:83], a[88:91], a[240:243], v[80:83]
  v_mfma_f32_16x16x32_bf16 v[84:87], a[92:95], a[240:243], v[84:87]
  s_waitcnt vmcnt(9) lgkmcnt(8)
  v_mfma_f32_16x16x32_bf16 v[116:119], a[248:251], a[240:243], v[116:119]
  s_barrier
  v_mfma_f32_16x16x32_bf16 v[40:43], v[216:219], a[216:219], v[40:43]
  ds_read_b64_tr_b16 a[232:233], v8 offset:24576
  v_mfma_f32_16x16x32_bf16 v[44:47], a[96:99], a[216:219], v[44:47]
  ds_read_b64_tr_b16 a[234:235], v8 offset:30720
  v_mfma_f32_16x16x32_bf16 v[48:51], a[100:103], a[216:219], v[48:51]
  s_add_u32 s37, s37, 110592
  s_add_u32 m0, s36, 73728
  ds_read_b64_tr_b16 a[236:237], v9 offset:24576
  v_mfma_f32_16x16x32_bf16 v[52:55], a[104:107], a[216:219], v[52:55]
  buffer_load_dwordx4 v2, s[72:75], s37 offen lds
  ds_read_b64_tr_b16 a[238:239], v9 offset:30720
  v_mfma_f32_16x16x32_bf16 v[148:151], a[248:251], v[232:235], v[148:151]
  ds_read_b64_tr_b16 a[240:241], v10 offset:24576
  v_mfma_f32_16x16x32_bf16 v[152:155], v[232:235], v[232:235], v[152:155]
  s_add_u32 m0, s36, 74752
  ds_read_b64_tr_b16 a[242:243], v10 offset:30720
  ds_read_b128 v[248:251], v23 offset:16384
  v_mfma_f32_16x16x32_bf16 v[108:111], a[248:251], a[216:219], v[108:111]
  buffer_load_dwordx4 v3, s[72:75], s37 offen lds
  ds_read_b128 a[192:195], v25 offset:16384
  v_mfma_f32_16x16x32_bf16 v[56:59], v[216:219], a[220:223], v[56:59]
  ds_read_b128 a[196:199], v27 offset:16384
  v_mfma_f32_16x16x32_bf16 v[60:63], a[96:99], a[220:223], v[60:63]
  s_add_u32 m0, s36, 75776
  ds_read_b128 a[200:203], v30 offset:16384
  v_mfma_f32_16x16x32_bf16 v[64:67], a[100:103], a[220:223], v[64:67]
  buffer_load_dwordx4 v4, s[72:75], s37 offen lds
  ds_read_b128 v[252:255], v24 offset:16384
  v_mfma_f32_16x16x32_bf16 v[68:71], a[104:107], a[220:223], v[68:71]
  ds_read_b128 a[204:207], v26 offset:16384
  v_mfma_f32_16x16x32_bf16 v[148:151], a[248:251], v[236:239], v[148:151]
  s_add_u32 s37, s37, 110592
  s_cmp_ge_u32 s37, 1990656
  s_cselect_b32 s37, 1152, s37
  s_add_u32 m0, s36, 0
  ds_read_b128 a[208:211], v29 offset:16384
  v_mfma_f32_16x16x32_bf16 v[152:155], v[236:239], v[236:239], v[152:155]
  buffer_load_dwordx4 v2, s[72:75], s37 offen lds
  ds_read_b128 a[212:215], v31 offset:16384
  v_mfma_f32_16x16x32_bf16 v[112:115], a[248:251], a[220:223], v[112:115]
  v_mfma_f32_16x16x32_bf16 v[72:75], v[216:219], a[224:227], v[72:75]
  v_mfma_f32_16x16x32_bf16 v[76:79], a[96:99], a[224:227], v[76:79]
  v_mfma_f32_16x16x32_bf16 v[80:83], a[100:103], a[224:227], v[80:83]
  v_mfma_f32_16x16x32_bf16 v[84:87], a[104:107], a[224:227], v[84:87]
  s_waitcnt vmcnt(10) lgkmcnt(8)
  v_mfma_f32_16x16x32_bf16 v[116:119], a[248:251], a[224:227], v[116:119]
  s_barrier
  v_mfma_f32_16x16x32_bf16 v[40:43], v[220:223], a[232:235], v[40:43]
  ds_read_b64_tr_b16 a[216:217], v8 offset:36864
  v_mfma_f32_16x16x32_bf16 v[44:47], a[108:111], a[232:235], v[44:47]
  ds_read_b64_tr_b16 a[218:219], v8 offset:43008
  v_mfma_f32_16x16x32_bf16 v[48:51], a[112:115], a[232:235], v[48:51]
  s_add_u32 m0, s36, 1024
  ds_read_b64_tr_b16 a[220:221], v9 offset:36864
  v_mfma_f32_16x16x32_bf16 v[52:55], a[116:119], a[232:235], v[52:55]
  buffer_load_dwordx4 v3, s[72:75], s37 offen lds
  ds_read_b64_tr_b16 a[222:223], v9 offset:43008
  v_mfma_f32_16x16x32_bf16 v[148:151], a[248:251], v[240:243], v[148:151]
  ds_read_b64_tr_b16 a[224:225], v10 offset:36864
  v_mfma_f32_16x16x32_bf16 v[152:155], v[240:243], v[240:243], v[152:155]
  s_add_u32 m0, s36, 2048
  ds_read_b64_tr_b16 a[226:227], v10 offset:43008
  v_mfma_f32_16x16x32_bf16 v[108:111], a[248:251], a[232:235], v[108:111]
  buffer_load_dwordx4 v4, s[72:75], s37 offen lds
  v_mfma_f32_16x16x32_bf16 v[56:59], v[220:223], a[236:239], v[56:59]
  v_mfma_f32_16x16x32_bf16 v[60:63], a[108:111], a[236:239], v[60:63]
  s_add_u32 s37, s37, 110592
  s_add_u32 m0, s36, 12288
  v_mfma_f32_16x16x32_bf16 v[64:67], a[112:115], a[236:239], v[64:67]
  buffer_load_dwordx4 v2, s[72:75], s37 offen lds
  v_mfma_f32_16x16x32_bf16 v[68:71], a[116:119], a[236:239], v[68:71]
  v_mfma_f32_16x16x32_bf16 v[148:151], a[248:251], v[244:247], v[148:151]
  s_add_u32 m0, s36, 13312
  v_mfma_f32_16x16x32_bf16 v[152:155], v[244:247], v[244:247], v[152:155]
  buffer_load_dwordx4 v3, s[72:75], s37 offen lds
  v_mfma_f32_16x16x32_bf16 v[112:115], a[248:251], a[236:239], v[112:115]
  v_mfma_f32_16x16x32_bf16 v[72:75], v[220:223], a[240:243], v[72:75]
  v_mfma_f32_16x16x32_bf16 v[76:79], a[108:111], a[240:243], v[76:79]
  v_mfma_f32_16x16x32_bf16 v[80:83], a[112:115], a[240:243], v[80:83]
  v_mfma_f32_16x16x32_bf16 v[84:87], a[116:119], a[240:243], v[84:87]
  s_waitcnt vmcnt(11) lgkmcnt(0)
  v_mfma_f32_16x16x32_bf16 v[116:119], a[248:251], a[240:243], v[116:119]
  s_barrier
  v_mfma_f32_16x16x32_bf16 v[40:43], v[224:227], a[216:219], v[40:43]
  ds_read_b64_tr_b16 a[232:233], v8 offset:49152
  v_mfma_f32_16x16x32_bf16 v[44:47], a[120:123], a[216:219], v[44:47]
  ds_read_b64_tr_b16 a[234:235], v8 offset:55296
  v_mfma_f32_16x16x32_bf16 v[48:51], a[124:127], a[216:219], v[48:51]
  s_add_u32 m0, s36, 14336
  ds_read_b64_tr_b16 a[236:237], v9 offset:49152
  v_mfma_f32_16x16x32_bf16 v[52:55], a[128:131], a[216:219], v[52:55]
  buffer_load_dwordx4 v4, s[72:75], s37 offen lds
  ds_read_b64_tr_b16 a[238:239], v9 offset:55296
  v_mfma_f32_16x16x32_bf16 v[148:151], a[248:251], v[248:251], v[148:151]
  ds_read_b64_tr_b16 a[240:241], v10 offset:49152
  v_mfma_f32_16x16x32_bf16 v[152:155], v[248:251], v[248:251], v[152:155]
  s_add_u32 s37, s37, 110592
  s_cmp_ge_u32 s37, 1990656
  s_cselect_b32 s37, 1152, s37
  s_add_u32 m0, s36, 24576
  ds_read_b64_tr_b16 a[242:243], v10 offset:55296
  v_mfma_f32_16x16x32_bf16 v[108:111], a[248:251], a[216:219], v[108:111]
  buffer_load_dwordx4 v2, s[72:75], s37 offen lds
  v_mfma_f32_16x16x32_bf16 v[56:59], v[224:227], a[220:223], v[56:59]
  v_mfma_f32_16x16x32_bf16 v[60:63], a[120:123], a[220:223], v[60:63]
  s_add_u32 m0, s36, 25600
  v_mfma_f32_16x16x32_bf16 v[64:67], a[124:127], a[220:223], v[64:67]
  buffer_load_dwordx4 v3, s[72:75], s37 offen lds
  v_mfma_f32_16x16x32_bf16 v[68:71], a[128:131], a[220:223], v[68:71]
  v_mfma_f32_16x16x32_bf16 v[148:151], a[248:251], v[252:255], v[148:151]
  s_add_u32 m0, s36, 26624
  v_mfma_f32_16x16x32_bf16 v[152:155], v[252:255], v[252:255], v[152:155]
  buffer_load_dwordx4 v4, s[72:75], s37 offen lds
  v_mfma_f32_16x16x32_bf16 v[112:115], a[248:251], a[220:223], v[112:115]
  v_mfma_f32_16x16x32_bf16 v[72:75], v[224:227], a[224:227], v[72:75]
  v_mfma_f32_16x16x32_bf16 v[76:79], a[120:123], a[224:227], v[76:79]
  v_mfma_f32_16x16x32_bf16 v[80:83], a[124:127], a[224:227], v[80:83]
  v_mfma_f32_16x16x32_bf16 v[84:87], a[128:131], a[224:227], v[84:87]
  s_waitcnt vmcnt(12) lgkmcnt(0)
  v_mfma_f32_16x16x32_bf16 v[116:119], a[248:251], a[224:227], v[116:119]
  s_barrier
  s_waitcnt vmcnt(63)
  v_mov_b32 v23, 0
  v_dot2c_f32_bf16 v23, s51, v160
  v_dot2c_f32_bf16 v23, s51, v161
  v_dot2c_f32_bf16 v23, s51, v162
  v_dot2c_f32_bf16 v23, s51, v163
  v_dot2c_f32_bf16 v23, s51, v164
  v_dot2c_f32_bf16 v23, s51, v165
  v_dot2c_f32_bf16 v23, s51, v166
  v_dot2c_f32_bf16 v23, s51, v167
  v_mfma_f32_16x16x32_bf16 v[40:43], v[228:231], a[232:235], v[40:43]
  ds_read_b64_tr_b16 a[216:217], v12 offset:0
  s_lshl_b32 s46, s31, 2
  s_add_u32 s46, s46, 7921664
  s_cmp_lt_u32 s31, 576
  s_cselect_b32 s46, s46, 0x7f000000
  v_cmp_eq_u32 vcc, 0, v1
  v_mov_b32 v173, 0x7f000000
  v_mov_b32 v174, s46
  v_cndmask_b32 v24, v173, v174, vcc
  v_mfma_f32_16x16x32_bf16 v[44:47], a[132:135], a[232:235], v[44:47]
  ds_read_b64_tr_b16 a[218:219], v12 offset:6144
  v_mov_b32 v173, v23
  s_nop 1
  v_mfma_f32_16x16x32_bf16 v[48:51], a[136:139], a[232:235], v[48:51]
  ds_read_b64_tr_b16 a[220:221], v13 offset:0
  v_permlane32_swap_b32 v173, v23
  v_add_f32 v23, v23, v173
  v_mfma_f32_16x16x32_bf16 v[52:55], a[140:143], a[232:235], v[52:55]
  s_add_u32 s37, s37, 110592
  s_add_u32 m0, s36, 36864
  ds_read_b64_tr_b16 a[222:223], v13 offset:6144
  v_mov_b32 v173, v23
  s_nop 1
  v_mfma_f32_16x16x32_bf16 v[108:111], a[248:251], a[232:235], v[108:111]
  buffer_load_dwordx4 v2, s[72:75], s37 offen lds
  ds_read_b64_tr_b16 a[224:225], v14 offset:0
  v_permlane16_swap_b32 v173, v23
  v_add_f32 v23, v23, v173
  v_mfma_f32_16x16x32_bf16 v[56:59], v[228:231], a[236:239], v[56:59]
  ds_read_b64_tr_b16 a[226:227], v14 offset:6144
  s_nop 1
  v_mfma_f32_16x16x32_bf16 v[60:63], a[132:135], a[236:239], v[60:63]
  v_add_f32_dpp v23, v23, v23 row_ror:8 row_mask:0xf bank_mask:0xf
  v_mfma_f32_16x16x32_bf16 v[64:67], a[136:139], a[236:239], v[64:67]
  s_add_u32 m0, s36, 37888
  s_nop 1
  v_mfma_f32_16x16x32_bf16 v[68:71], a[140:143], a[236:239], v[68:71]
  buffer_load_dwordx4 v3, s[72:75], s37 offen lds
  v_add_f32_dpp v23, v23, v23 row_ror:4 row_mask:0xf bank_mask:0xf
  v_mfma_f32_16x16x32_bf16 v[112:115], a[248:251], a[236:239], v[112:115]
  s_nop 1
  v_mfma_f32_16x16x32_bf16 v[72:75], v[228:231], a[240:243], v[72:75]
  v_add_f32_dpp v23, v23, v23 row_ror:2 row_mask:0xf bank_mask:0xf
  v_mfma_f32_16x16x32_bf16 v[76:79], a[132:135], a[240:243], v[76:79]
  s_add_u32 m0, s36, 38912
  s_nop 1
  v_mfma_f32_16x16x32_bf16 v[80:83], a[136:139], a[240:243], v[80:83]
  buffer_load_dwordx4 v4, s[72:75], s37 offen lds
  v_add_f32_dpp v23, v23, v23 row_ror:1 row_mask:0xf bank_mask:0xf
  v_mfma_f32_16x16x32_bf16 v[84:87], a[140:143], a[240:243], v[84:87]
  s_waitcnt vmcnt(12) lgkmcnt(0)
  v_mfma_f32_16x16x32_bf16 v[116:119], a[248:251], a[240:243], v[116:119]
  s_barrier
  v_mfma_f32_16x16x32_bf16 v[40:43], v[232:235], a[216:219], v[40:43]
  ds_read_b64_tr_b16 a[232:233], v12 offset:12288
  s_lshl_b32 s46, s29, 6
  s_add_u32 s46, s46, 7913472
  s_cmp_eq_u32 s28, 0
  s_cselect_b32 s46, s46, 0x7f000000
  v_cmp_eq_u32 vcc, 1, v145
  s_nop 1
  v_cndmask_b32 v152, v152, v153, vcc
  v_mfma_f32_16x16x32_bf16 v[44:47], a[144:147], a[216:219], v[44:47]
  ds_read_b64_tr_b16 a[234:235], v12 offset:18432
  v_cmp_eq_u32 vcc, 2, v145
  s_nop 1
  v_cndmask_b32 v152, v152, v154, vcc
  v_cmp_eq_u32 vcc, 3, v145
  s_nop 1
  v_cndmask_b32 v152, v152, v155, vcc
  v_mfma_f32_16x16x32_bf16 v[48:51], a[148:151], a[216:219], v[48:51]
  ds_read_b64_tr_b16 a[236:237], v13 offset:12288
  v_mul_f32 v172, 0x3ae38e39, v148
  v_mfma_f32_16x16x32_bf16 v[52:55], a[152:155], a[216:219], v[52:55]
  v_bfe_u32 v136, v22, 2, 2
  v_lshlrev_b32 v136, 3, v136
  v_and_b32 v137, 3, v22
  v_add_u32 v136, v136, v137
  v_lshrrev_b32 v137, 4, v22
  v_lshl_add_u32 v136, v137, 2, v136
  v_mul_u32_u24 v136, 3456, v136
  v_lshl_add_u32 v136, v5, 4, v136
  v_add_u32 v2, s35, v136
  v_add_u32 v3, 110592, v2
  v_lshrrev_b32 v137, 2, v5
  v_mul_u32_u24 v137, 110528, v137
  v_add3_u32 v4, v136, v137, s32
  s_mul_i32 s37, s101, 221184
  s_add_u32 m0, s36, 86016
  ds_read_b64_tr_b16 a[238:239], v13 offset:18432
  v_mul_f32 v173, 0x3ae38e39, v152
  v_mfma_f32_16x16x32_bf16 v[108:111], a[248:251], a[216:219], v[108:111]
  buffer_load_dwordx4 v2, s[72:75], s37 offen lds
  ds_read_b64_tr_b16 a[240:241], v14 offset:12288
  v_cmp_gt_u32 vcc, 16, v1
  v_mfma_f32_16x16x32_bf16 v[56:59], v[232:235], a[220:223], v[56:59]
  ds_read_b64_tr_b16 a[242:243], v14 offset:18432
  v_lshl_add_u32 v175, v1, 2, s46
  v_mfma_f32_16x16x32_bf16 v[60:63], a[144:147], a[220:223], v[60:63]
  v_fma_f32 v173, -v172, v172, v173
  v_mfma_f32_16x16x32_bf16 v[64:67], a[148:151], a[220:223], v[64:67]
  s_add_u32 m0, s36, 87040
  v_mov_b32 v174, 0x7f000000
  v_mfma_f32_16x16x32_bf16 v[68:71], a[152:155], a[220:223], v[68:71]
  buffer_load_dwordx4 v3, s[72:75], s37 offen lds
  v_cndmask_b32 v175, v174, v175, vcc
  v_mfma_f32_16x16x32_bf16 v[112:115], a[248:251], a[220:223], v[112:115]
  v_mov_b32 v25, v172
  v_mfma_f32_16x16x32_bf16 v[72:75], v[232:235], a[224:227], v[72:75]
  v_mov_b32 v26, v175
  v_mfma_f32_16x16x32_bf16 v[76:79], a[144:147], a[224:227], v[76:79]
  s_add_u32 m0, s36, 88064
  v_max_f32 v173, 0, v173
  v_mfma_f32_16x16x32_bf16 v[80:83], a[148:151], a[224:227], v[80:83]
  buffer_load_dwordx4 v4, s[72:75], s37 offen lds
  v_cvt_pk_bf16_f32 v174, v172, v172
  v_mfma_f32_16x16x32_bf16 v[84:87], a[152:155], a[224:227], v[84:87]
  s_waitcnt vmcnt(12) lgkmcnt(0)
  v_mfma_f32_16x16x32_bf16 v[116:119], a[248:251], a[224:227], v[116:119]
  s_barrier
  v_mfma_f32_16x16x32_bf16 v[40:43], v[236:239], a[232:235], v[40:43]
  ds_read_b64_tr_b16 a[216:217], v8 offset:0
  v_lshlrev_b32 v174, 16, v174
  v_cvt_pk_bf16_f32 v173, v173, v173
  v_mfma_f32_16x16x32_bf16 v[44:47], a[156:159], a[232:235], v[44:47]
  ds_read_b64_tr_b16 a[218:219], v8 offset:6144
  v_lshlrev_b32 v173, 16, v173
  v_add_f32 v173, 0x3727c5ac, v173
  v_mfma_f32_16x16x32_bf16 v[48:51], a[160:163], a[232:235], v[48:51]
  ds_read_b64_tr_b16 a[220:221], v9 offset:0
  v_cvt_pk_bf16_f32 v173, v173, v173
  v_mfma_f32_16x16x32_bf16 v[52:55], a[164:167], a[232:235], v[52:55]
  v_and_b32 v7, 7, v1
  v_lshlrev_b32 v7, 5, v7
  ds_read_b64_tr_b16 a[222:223], v9 offset:6144
  v_lshlrev_b32 v173, 16, v173
  v_mfma_f32_16x16x32_bf16 v[108:111], a[248:251], a[232:235], v[108:111]
  global_load_dword v6, v7, s[80:81] sc1
  ds_read_b64_tr_b16 a[224:225], v10 offset:0
  v_sqrt_f32 v173, v173
  v_mfma_f32_16x16x32_bf16 v[56:59], v[236:239], a[236:239], v[56:59]
  ds_read_b64_tr_b16 a[226:227], v10 offset:6144
  s_nop 0
  v_mfma_f32_16x16x32_bf16 v[60:63], a[156:159], a[236:239], v[60:63]
  v_cvt_pk_bf16_f32 v173, v173, v173
  v_mfma_f32_16x16x32_bf16 v[64:67], a[160:163], a[236:239], v[64:67]
  s_add_u32 s37, s37, 221184
  s_cmp_ge_u32 s37, 1990656
  s_cselect_b32 s37, 0, s37
  s_add_u32 m0, s36, 98304
  v_lshlrev_b32 v173, 16, v173
  v_mfma_f32_16x16x32_bf16 v[68:71], a[164:167], a[236:239], v[68:71]
  buffer_load_dwordx4 v2, s[72:75], s37 offen lds
  v_rcp_f32 v173, v173
  v_mfma_f32_16x16x32_bf16 v[112:115], a[248:251], a[236:239], v[112:115]
  s_nop 0
  v_mfma_f32_16x16x32_bf16 v[72:75], v[236:239], a[240:243], v[72:75]
  v_mul_f32 v174, v174, v173
  v_mfma_f32_16x16x32_bf16 v[76:79], a[156:159], a[240:243], v[76:79]
  s_add_u32 m0, s36, 99328
  ds_write_b32 v144, v173
  v_mfma_f32_16x16x32_bf16 v[80:83], a[160:163], a[240:243], v[80:83]
  buffer_load_dwordx4 v3, s[72:75], s37 offen lds
  ds_write_b32 v144, v174 offset:256
  v_mfma_f32_16x16x32_bf16 v[84:87], a[164:167], a[240:243], v[84:87]
  s_waitcnt vmcnt(12) lgkmcnt(2)
  v_mfma_f32_16x16x32_bf16 v[116:119], a[248:251], a[240:243], v[116:119]
  s_barrier
  v_mfma_f32_16x16x32_bf16 v[40:43], v[240:243], a[216:219], v[40:43]
  ds_read_b64_tr_b16 a[232:233], v8 offset:12288
  ds_write_b128 v35, v[168:171] offset:1520
  v_mfma_f32_16x16x32_bf16 v[44:47], a[168:171], a[216:219], v[44:47]
  ds_read_b64_tr_b16 a[234:235], v8 offset:18432
  v_mfma_f32_16x16x32_bf16 v[48:51], a[172:175], a[216:219], v[48:51]
  ds_read_b64_tr_b16 a[236:237], v9 offset:12288
  v_mfma_f32_16x16x32_bf16 v[52:55], a[176:179], a[216:219], v[52:55]
  s_add_u32 m0, s36, 100352
  ds_read_b64_tr_b16 a[238:239], v9 offset:18432
  v_mfma_f32_16x16x32_bf16 v[108:111], a[248:251], a[216:219], v[108:111]
  buffer_load_dwordx4 v4, s[72:75], s37 offen lds
  ds_read_b64_tr_b16 a[240:241], v10 offset:12288
  v_mfma_f32_16x16x32_bf16 v[56:59], v[240:243], a[220:223], v[56:59]
  ds_read_b64_tr_b16 a[242:243], v10 offset:18432
  v_mfma_f32_16x16x32_bf16 v[60:63], a[168:171], a[220:223], v[60:63]
  v_mfma_f32_16x16x32_bf16 v[64:67], a[172:175], a[220:223], v[64:67]
  s_add_u32 s37, s37, 221184
  s_cmp_ge_u32 s37, 1990656
  s_cselect_b32 s37, 0, s37
  s_add_u32 m0, s36, 110592
  v_mfma_f32_16x16x32_bf16 v[68:71], a[176:179], a[220:223], v[68:71]
  buffer_load_dwordx4 v2, s[72:75], s37 offen lds
  v_mfma_f32_16x16x32_bf16 v[112:115], a[248:251], a[220:223], v[112:115]
  v_mfma_f32_16x16x32_bf16 v[72:75], v[240:243], a[224:227], v[72:75]
  v_mfma_f32_16x16x32_bf16 v[76:79], a[168:171], a[224:227], v[76:79]
  s_add_u32 m0, s36, 111616
  v_mfma_f32_16x16x32_bf16 v[80:83], a[172:175], a[224:227], v[80:83]
  buffer_load_dwordx4 v3, s[72:75], s37 offen lds
  v_mfma_f32_16x16x32_bf16 v[84:87], a[176:179], a[224:227], v[84:87]
  s_waitcnt vmcnt(12) lgkmcnt(0)
  v_mfma_f32_16x16x32_bf16 v[116:119], a[248:251], a[224:227], v[116:119]
  s_barrier
  v_mfma_f32_16x16x32_bf16 v[40:43], v[244:247], a[232:235], v[40:43]
  ds_read_b64_tr_b16 a[216:217], v8 offset:24576
  ds_read_b128 v[88:91], v104
  v_mfma_f32_16x16x32_bf16 v[44:47], a[180:183], a[232:235], v[44:47]
  ds_read_b64_tr_b16 a[218:219], v8 offset:30720
  ds_read_b128 v[92:95], v104 offset:256
  v_mfma_f32_16x16x32_bf16 v[48:51], a[184:187], a[232:235], v[48:51]
  ds_read_b64_tr_b16 a[220:221], v9 offset:24576
  ds_read_b128 v[96:99], v105
  v_mfma_f32_16x16x32_bf16 v[52:55], a[188:191], a[232:235], v[52:55]
  s_add_u32 m0, s36, 112640
  ds_read_b64_tr_b16 a[222:223], v9 offset:30720
  ds_read_b128 v[100:103], v105 offset:256
  v_mfma_f32_16x16x32_bf16 v[108:111], a[248:251], a[232:235], v[108:111]
  buffer_load_dwordx4 v4, s[72:75], s37 offen lds
  ds_read_b64_tr_b16 a[224:225], v10 offset:24576
  ds_read_b128 v[160:163], v106
  v_mfma_f32_16x16x32_bf16 v[56:59], v[244:247], a[236:239], v[56:59]
  ds_read_b64_tr_b16 a[226:227], v10 offset:30720
  ds_read_b128 v[164:167], v106 offset:256
  v_mfma_f32_16x16x32_bf16 v[60:63], a[180:183], a[236:239], v[60:63]
  ds_read_b128 v[176:179], v107
  v_mfma_f32_16x16x32_bf16 v[64:67], a[184:187], a[236:239], v[64:67]
  s_add_u32 s37, s37, 221184
  s_cmp_ge_u32 s37, 1990656
  s_cselect_b32 s37, 0, s37
  s_add_u32 m0, s36, 122880
  ds_read_b128 v[180:183], v107 offset:256
  v_mfma_f32_16x16x32_bf16 v[68:71], a[188:191], a[236:239], v[68:71]
  buffer_load_dwordx4 v2, s[72:75], s37 offen lds
  v_mfma_f32_16x16x32_bf16 v[112:115], a[248:251], a[236:239], v[112:115]
  v_mfma_f32_16x16x32_bf16 v[72:75], v[244:247], a[240:243], v[72:75]
  v_mfma_f32_16x16x32_bf16 v[76:79], a[180:183], a[240:243], v[76:79]
L_wu_p1_1:
L_st_5000:
  s_cbranch_execz L_wuret_p1
  s_add_u32 m0, s36, 123904
  v_mfma_f32_16x16x32_bf16 v[80:83], a[184:187], a[240:243], v[80:83]
  buffer_load_dwordx4 v3, s[72:75], s37 offen lds
  v_mfma_f32_16x16x32_bf16 v[84:87], a[188:191], a[240:243], v[84:87]
  s_waitcnt vmcnt(12) lgkmcnt(3)
  v_mfma_f32_16x16x32_bf16 v[116:119], a[248:251], a[240:243], v[116:119]
  s_barrier
  v_mfma_f32_16x16x32_bf16 v[40:43], v[248:251], a[216:219], v[40:43]
  ds_read_b64_tr_b16 a[232:233], v8 offset:36864
  v_mfma_f32_16x16x32_bf16 v[44:47], a[192:195], a[216:219], v[44:47]
  ds_read_b64_tr_b16 a[234:235], v8 offset:43008
  v_mfma_f32_16x16x32_bf16 v[48:51], a[196:199], a[216:219], v[48:51]
  ds_read_b64_tr_b16 a[236:237], v9 offset:36864
  v_mfma_f32_16x16x32_bf16 v[52:55], a[200:203], a[216:219], v[52:55]
  s_add_u32 m0, s36, 124928
  ds_read_b64_tr_b16 a[238:239], v9 offset:43008
  v_mfma_f32_16x16x32_bf16 v[108:111], a[248:251], a[216:219], v[108:111]
  buffer_load_dwordx4 v4, s[72:75], s37 offen lds
  ds_read_b64_tr_b16 a[240:241], v10 offset:36864
  v_mfma_f32_16x16x32_bf16 v[56:59], v[248:251], a[220:223], v[56:59]
  ds_read_b64_tr_b16 a[242:243], v10 offset:43008
  v_mfma_f32_16x16x32_bf16 v[60:63], a[192:195], a[220:223], v[60:63]
  v_accvgpr_read_b32 v8, a252
  v_add_u32 v12, 61440, v8
  v_mfma_f32_16x16x32_bf16 v[64:67], a[196:199], a[220:223], v[64:67]
  s_add_u32 s37, s37, 221184
  s_cmp_ge_u32 s37, 1990656
  s_cselect_b32 s37, 0, s37
  s_add_u32 m0, s36, 135168
  v_add_u32 v16, 122880, v8
  v_accvgpr_read_b32 v9, a253
  v_mfma_f32_16x16x32_bf16 v[68:71], a[200:203], a[220:223], v[68:71]
  buffer_load_dwordx4 v2, s[72:75], s37 offen lds
  v_add_u32 v13, 61440, v9
  v_add_u32 v17, 122880, v9
  v_mfma_f32_16x16x32_bf16 v[112:115], a[248:251], a[220:223], v[112:115]
  v_accvgpr_read_b32 v10, a254
  v_add_u32 v14, 61440, v10
  v_mfma_f32_16x16x32_bf16 v[72:75], v[248:251], a[224:227], v[72:75]
  v_add_u32 v18, 122880, v10
  v_accvgpr_read_b32 v11, a255
  v_mfma_f32_16x16x32_bf16 v[76:79], a[192:195], a[224:227], v[76:79]
  s_add_u32 m0, s36, 136192
  v_add_u32 v15, 61440, v11
  v_mfma_f32_16x16x32_bf16 v[80:83], a[196:199], a[224:227], v[80:83]
  buffer_load_dwordx4 v3, s[72:75], s37 offen lds
  v_add_u32 v19, 122880, v11
  v_mfma_f32_16x16x32_bf16 v[84:87], a[200:203], a[224:227], v[84:87]
  s_waitcnt vmcnt(11) lgkmcnt(0)
L_s0_poll:
  v_cmp_gt_u32 vcc, 8, v6
  s_cbranch_vccz L_s0_go
  s_sub_u32 s100, s100, 1
  s_cmp_lt_i32 s100, 0
  s_cbranch_scc1 L_s0_go
  global_load_dword v6, v7, s[80:81] sc1
  s_waitcnt vmcnt(0)
  s_branch L_s0_poll
L_s0_go:
  v_mfma_f32_16x16x32_bf16 v[116:119], a[248:251], a[224:227], v[116:119]
  s_barrier
  v_mfma_f32_16x16x32_bf16 v[40:43], v[252:255], a[232:235], v[40:43]
  ds_read_b64_tr_b16 a[216:217], v12 offset:24576
  buffer_store_dword v23, v24, s[16:19], 0 offen sc1
  v_mfma_f32_16x16x32_bf16 v[44:47], a[204:207], a[232:235], v[44:47]
  ds_read_b64_tr_b16 a[218:219], v12 offset:30720
  buffer_store_dword v25, v26, s[16:19], 0 offen sc1
  v_mfma_f32_16x16x32_bf16 v[48:51], a[208:211], a[232:235], v[48:51]
  ds_read_b64_tr_b16 a[220:221], v13 offset:24576
  v_mfma_f32_16x16x32_bf16 v[52:55], a[212:215], a[232:235], v[52:55]
  s_add_u32 m0, s36, 137216
  ds_read_b64_tr_b16 a[222:223], v13 offset:30720
  v_mfma_f32_16x16x32_bf16 v[108:111], a[248:251], a[232:235], v[108:111]
  buffer_load_dwordx4 v4, s[72:75], s37 offen lds
  ds_read_b64_tr_b16 a[224:225], v14 offset:24576
  v_mfma_f32_16x16x32_bf16 v[56:59], v[252:255], a[236:239], v[56:59]
  ds_read_b64_tr_b16 a[226:227], v14 offset:30720
  v_mfma_f32_16x16x32_bf16 v[60:63], a[204:207], a[236:239], v[60:63]
  ds_read_b64_tr_b16 a[228:229], v15 offset:24576
  v_mfma_f32_16x16x32_bf16 v[64:67], a[208:211], a[236:239], v[64:67]
  s_add_u32 s37, s37, 221184
  s_cmp_ge_u32 s37, 1990656
  s_cselect_b32 s37, 0, s37
  s_add_u32 m0, s36, 49152
  ds_read_b64_tr_b16 a[230:231], v15 offset:30720
  v_mfma_f32_16x16x32_bf16 v[68:71], a[212:215], a[236:239], v[68:71]
  buffer_load_dwordx4 v2, s[72:75], s37 offen lds
  v_mfma_f32_16x16x32_bf16 v[112:115], a[248:251], a[236:239], v[112:115]
  v_mfma_f32_16x16x32_bf16 v[72:75], v[252:255], a[240:243], v[72:75]
  v_mfma_f32_16x16x32_bf16 v[76:79], a[204:207], a[240:243], v[76:79]
  s_add_u32 m0, s36, 50176
  v_mfma_f32_16x16x32_bf16 v[80:83], a[208:211], a[240:243], v[80:83]
  buffer_load_dwordx4 v3, s[72:75], s37 offen lds
  v_mfma_f32_16x16x32_bf16 v[84:87], a[212:215], a[240:243], v[84:87]
  s_waitcnt vmcnt(13) lgkmcnt(0)
  v_mfma_f32_16x16x32_bf16 v[116:119], a[248:251], a[240:243], v[116:119]
  s_barrier
  s_nop 3
  v_pk_mul_f32 v[132:133], v[92:93], v[108:109]
  v_pk_mul_f32 v[134:135], v[94:95], v[108:109]
  v_pk_fma_f32 v[40:41], v[40:41], v[88:89], v[132:133] neg_lo:[0,0,1] neg_hi:[0,0,1]
  v_pk_fma_f32 v[42:43], v[42:43], v[90:91], v[134:135] neg_lo:[0,0,1] neg_hi:[0,0,1]
  v_pk_mul_f32 v[132:133], v[100:101], v[108:109]
  v_pk_mul_f32 v[134:135], v[102:103], v[108:109]
  v_pk_fma_f32 v[44:45], v[44:45], v[96:97], v[132:133] neg_lo:[0,0,1] neg_hi:[0,0,1]
  v_pk_fma_f32 v[46:47], v[46:47], v[98:99], v[134:135] neg_lo:[0,0,1] neg_hi:[0,0,1]
  v_pk_mul_f32 v[132:133], v[164:165], v[108:109]
  v_pk_mul_f32 v[134:135], v[166:167], v[108:109]
  v_pk_fma_f32 v[48:49], v[48:49], v[160:161], v[132:133] neg_lo:[0,0,1] neg_hi:[0,0,1]
  s_add_u32 m0, s36, 51200
  s_nop 0
  buffer_load_dwordx4 v4, s[72:75], s37 offen lds
  v_pk_fma_f32 v[50:51], v[50:51], v[162:163], v[134:135] neg_lo:[0,0,1] neg_hi:[0,0,1]
  v_pk_mul_f32 v[132:133], v[180:181], v[108:109]
  v_pk_mul_f32 v[134:135], v[182:183], v[108:109]
  v_pk_fma_f32 v[52:53], v[52:53], v[176:177], v[132:133] neg_lo:[0,0,1] neg_hi:[0,0,1]
  v_pk_fma_f32 v[54:55], v[54:55], v[178:179], v[134:135] neg_lo:[0,0,1] neg_hi:[0,0,1]
  v_pk_mul_f32 v[132:133], v[92:93], v[112:113]
  v_pk_mul_f32 v[134:135], v[94:95], v[112:113]
  v_pk_fma_f32 v[56:57], v[56:57], v[88:89], v[132:133] neg_lo:[0,0,1] neg_hi:[0,0,1]
  v_pk_fma_f32 v[58:59], v[58:59], v[90:91], v[134:135] neg_lo:[0,0,1] neg_hi:[0,0,1]
  v_pk_mul_f32 v[132:133], v[100:101], v[112:113]
  v_pk_mul_f32 v[134:135], v[102:103], v[112:113]
  v_pk_fma_f32 v[60:61], v[60:61], v[96:97], v[132:133] neg_lo:[0,0,1] neg_hi:[0,0,1]
  s_add_u32 s37, s37, 221184
  s_cmp_ge_u32 s37, 1990656
  s_cselect_b32 s37, 0, s37
  s_add_u32 m0, s36, 61440
  s_nop 0
  buffer_load_dwordx4 v2, s[72:75], s37 offen lds
  v_pk_fma_f32 v[62:63], v[62:63], v[98:99], v[134:135] neg_lo:[0,0,1] neg_hi:[0,0,1]
  v_pk_mul_f32 v[132:133], v[164:165], v[112:113]
  v_pk_mul_f32 v[134:135], v[166:167], v[112:113]
  v_pk_fma_f32 v[64:65], v[64:65], v[160:161], v[132:133] neg_lo:[0,0,1] neg_hi:[0,0,1]
  v_pk_fma_f32 v[66:67], v[66:67], v[162:163], v[134:135] neg_lo:[0,0,1] neg_hi:[0,0,1]
  v_pk_mul_f32 v[132:133], v[180:181], v[112:113]
  v_pk_mul_f32 v[134:135], v[182:183], v[112:113]
  v_pk_fma_f32 v[68:69], v[68:69], v[176:177], v[132:133] neg_lo:[0,0,1] neg_hi:[0,0,1]
  v_pk_fma_f32 v[70:71], v[70:71], v[178:179], v[134:135] neg_lo:[0,0,1] neg_hi:[0,0,1]
  v_pk_mul_f32 v[132:133], v[92:93], v[116:117]
  v_pk_mul_f32 v[134:135], v[94:95], v[116:117]
  v_pk_fma_f32 v[72:73], v[72:73], v[88:89], v[132:133] neg_lo:[0,0,1] neg_hi:[0,0,1]
  s_add_u32 m0, s36, 62464
  s_nop 0
  buffer_load_dwordx4 v3, s[72:75], s37 offen lds
  v_pk_fma_f32 v[74:75], v[74:75], v[90:91], v[134:135] neg_lo:[0,0,1] neg_hi:[0,0,1]
  v_pk_mul_f32 v[132:133], v[100:101], v[116:117]
  v_pk_mul_f32 v[134:135], v[102:103], v[116:117]
  v_pk_fma_f32 v[76:77], v[76:77], v[96:97], v[132:133] neg_lo:[0,0,1] neg_hi:[0,0,1]
  v_pk_fma_f32 v[78:79], v[78:79], v[98:99], v[134:135] neg_lo:[0,0,1] neg_hi:[0,0,1]
  v_pk_mul_f32 v[132:133], v[164:165], v[116:117]
  v_pk_mul_f32 v[134:135], v[166:167], v[116:117]
  v_pk_fma_f32 v[80:81], v[80:81], v[160:161], v[132:133] neg_lo:[0,0,1] neg_hi:[0,0,1]
  v_pk_fma_f32 v[82:83], v[82:83], v[162:163], v[134:135] neg_lo:[0,0,1] neg_hi:[0,0,1]
  v_pk_mul_f32 v[132:133], v[180:181], v[116:117]
  v_pk_mul_f32 v[134:135], v[182:183], v[116:117]
  v_pk_fma_f32 v[84:85], v[84:85], v[176:177], v[132:133] neg_lo:[0,0,1] neg_hi:[0,0,1]
  s_add_u32 m0, s36, 63488
  s_nop 0
  buffer_load_dwordx4 v4, s[72:75], s37 offen lds
  v_pk_fma_f32 v[86:87], v[86:87], v[178:179], v[134:135] neg_lo:[0,0,1] neg_hi:[0,0,1]
  v_pk_mul_f32 v[160:161], v[40:41], s[54:55]
  v_pk_mul_f32 v[162:163], v[42:43], s[54:55]
  v_pk_mul_f32 v[164:165], v[44:45], s[54:55]
  v_pk_mul_f32 v[166:167], v[46:47], s[54:55]
  v_pk_mul_f32 v[168:169], v[48:49], s[54:55]
  v_pk_mul_f32 v[170:171], v[50:51], s[54:55]
  v_pk_mul_f32 v[172:173], v[52:53], s[54:55]
  v_pk_mul_f32 v[174:175], v[54:55], s[54:55]
  v_exp_f32_e64 v160, v160 clamp
  v_exp_f32_e64 v161, v161 clamp
  v_exp_f32_e64 v162, v162 clamp
  s_add_u32 s37, s37, 221184
  s_cmp_ge_u32 s37, 1990656
  s_cselect_b32 s37, 0, s37
  s_add_u32 m0, s36, 73728
  s_nop 0
  buffer_load_dwordx4 v2, s[72:75], s37 offen lds
  v_exp_f32_e64 v163, v163 clamp
  v_exp_f32_e64 v164, v164 clamp
  v_exp_f32_e64 v165, v165 clamp
  v_exp_f32_e64 v166, v166 clamp
  v_exp_f32_e64 v167, v167 clamp
  v_exp_f32_e64 v168, v168 clamp
  v_exp_f32_e64 v169, v169 clamp
  v_exp_f32_e64 v170, v170 clamp
  v_exp_f32_e64 v171, v171 clamp
  v_exp_f32_e64 v172, v172 clamp
  v_exp_f32_e64 v173, v173 clamp
  v_exp_f32_e64 v174, v174 clamp
  s_add_u32 m0, s36, 74752
  s_nop 0
  buffer_load_dwordx4 v3, s[72:75], s37 offen lds
  v_exp_f32_e64 v175, v175 clamp
  v_max_f32 v40, 0, v40
  v_max_f32 v41, 0, v41
  v_max_f32 v42, 0, v42
  v_max_f32 v43, 0, v43
  v_max_f32 v44, 0, v44
  v_max_f32 v45, 0, v45
  v_max_f32 v46, 0, v46
  v_max_f32 v47, 0, v47
  v_max_f32 v48, 0, v48
  v_max_f32 v49, 0, v49
  v_max_f32 v50, 0, v50
  s_add_u32 m0, s36, 75776
  s_nop 0
  buffer_load_dwordx4 v4, s[72:75], s37 offen lds
  v_max_f32 v51, 0, v51
  v_max_f32 v52, 0, v52
  v_max_f32 v53, 0, v53
  v_max_f32 v54, 0, v54
  v_max_f32 v55, 0, v55
  v_pk_add_f32 v[40:41], v[40:41], v[160:161]
  v_pk_add_f32 v[42:43], v[42:43], v[162:163]
  v_pk_add_f32 v[44:45], v[44:45], v[164:165]
  v_pk_add_f32 v[46:47], v[46:47], v[166:167]
  v_pk_add_f32 v[48:49], v[48:49], v[168:169]
  v_pk_add_f32 v[50:51], v[50:51], v[170:171]
  v_pk_add_f32 v[52:53], v[52:53], v[172:173]
  s_add_u32 s37, s37, 221184
  s_cmp_ge_u32 s37, 1990656
  s_cselect_b32 s37, 0, s37
  s_add_u32 m0, s36, 0
  s_nop 0
  buffer_load_dwordx4 v2, s[72:75], s37 offen lds
  v_pk_add_f32 v[54:55], v[54:55], v[174:175]
  v_pk_add_f32 v[40:41], v[40:41], s[56:57]
  v_pk_add_f32 v[42:43], v[42:43], s[56:57]
  v_pk_add_f32 v[44:45], v[44:45], s[56:57]
  v_pk_add_f32 v[46:47], v[46:47], s[56:57]
  v_pk_add_f32 v[48:49], v[48:49], s[56:57]
  v_pk_add_f32 v[50:51], v[50:51], s[56:57]
  v_pk_add_f32 v[52:53], v[52:53], s[56:57]
  v_pk_add_f32 v[54:55], v[54:55], s[56:57]
  v_cvt_pk_bf16_f32 v160, v40, v41
  v_cvt_pk_bf16_f32 v161, v42, v43
  v_cvt_pk_bf16_f32 v162, v44, v45
  s_add_u32 m0, s36, 1024
  s_nop 0
  buffer_load_dwordx4 v3, s[72:75], s37 offen lds
  v_cvt_pk_bf16_f32 v163, v46, v47
  v_cvt_pk_bf16_f32 v164, v48, v49
  v_cvt_pk_bf16_f32 v165, v50, v51
  v_cvt_pk_bf16_f32 v166, v52, v53
  v_cvt_pk_bf16_f32 v167, v54, v55
  v_cvt_pk_bf16_f32 v168, v56, v57
  v_cvt_pk_bf16_f32 v169, v58, v59
  v_cvt_pk_bf16_f32 v170, v60, v61
  v_cvt_pk_bf16_f32 v171, v62, v63
  v_cvt_pk_bf16_f32 v172, v64, v65
  v_cvt_pk_bf16_f32 v173, v66, v67
  v_cvt_pk_bf16_f32 v174, v68, v69
  s_add_u32 m0, s36, 2048
  s_nop 0
  buffer_load_dwordx4 v4, s[72:75], s37 offen lds
  v_cvt_pk_bf16_f32 v175, v70, v71
  v_pk_mul_f32 v[40:41], v[72:73], v[156:157] op_sel_hi:[1,0]
  v_pk_mul_f32 v[42:43], v[74:75], v[156:157] op_sel_hi:[1,0]
  v_pk_mul_f32 v[44:45], v[76:77], v[156:157] op_sel_hi:[1,0]
  v_pk_mul_f32 v[46:47], v[78:79], v[156:157] op_sel_hi:[1,0]
  v_pk_mul_f32 v[48:49], v[80:81], v[156:157] op_sel_hi:[1,0]
  v_pk_mul_f32 v[50:51], v[82:83], v[156:157] op_sel_hi:[1,0]
  v_pk_mul_f32 v[52:53], v[84:85], v[156:157] op_sel_hi:[1,0]
  v_pk_mul_f32 v[54:55], v[86:87], v[156:157] op_sel_hi:[1,0]
  v_exp_f32_e64 v40, v40 clamp
  v_exp_f32_e64 v41, v41 clamp
  v_exp_f32_e64 v42, v42 clamp
  v_lshrrev_b32 v136, 4, v22
  v_lshl_add_u32 v136, v136, 1, v22
  v_mul_u32_u24 v136, 1152, v136
  v_lshl_add_u32 v2, v5, 4, v136
  v_add_u32 v3, 128, v2
  v_add_u32 v4, 256, v2
  s_add_u32 s37, s42, 0
  s_add_u32 m0, s36, 12288
  s_nop 0
  buffer_load_dwordx4 v2, s[76:79], s37 offen lds
  v_exp_f32_e64 v43, v43 clamp
  v_exp_f32_e64 v44, v44 clamp
  v_exp_f32_e64 v45, v45 clamp
  v_exp_f32_e64 v46, v46 clamp
  v_exp_f32_e64 v47, v47 clamp
  v_exp_f32_e64 v48, v48 clamp
  v_exp_f32_e64 v49, v49 clamp
  v_exp_f32_e64 v50, v50 clamp
  v_exp_f32_e64 v51, v51 clamp
  v_exp_f32_e64 v52, v52 clamp
  v_exp_f32_e64 v53, v53 clamp
  v_exp_f32_e64 v54, v54 clamp
  s_add_u32 m0, s36, 13312
  s_nop 0
  buffer_load_dwordx4 v3, s[76:79], s37 offen lds
  v_exp_f32_e64 v55, v55 clamp
  v_med3_f32 v72, v72, v157, v158
  v_med3_f32 v73, v73, v157, v158
  v_med3_f32 v74, v74, v157, v158
  v_med3_f32 v75, v75, v157, v158
  v_med3_f32 v76, v76, v157, v158
  v_med3_f32 v77, v77, v157, v158
  v_med3_f32 v78, v78, v157, v158
  v_med3_f32 v79, v79, v157, v158
  v_med3_f32 v80, v80, v157, v158
  v_med3_f32 v81, v81, v157, v158
  v_med3_f32 v82, v82, v157, v158
  s_add_u32 m0, s36, 14336
  s_nop 0
  buffer_load_dwordx4 v4, s[76:79], s37 offen lds
  v_med3_f32 v83, v83, v157, v158
  v_med3_f32 v84, v84, v157, v158
  v_med3_f32 v85, v85, v157, v158
  v_med3_f32 v86, v86, v157, v158
  v_med3_f32 v87, v87, v157, v158
  v_pk_fma_f32 v[72:73], v[40:41], v[158:159], v[72:73] op_sel:[0,1,0] op_sel_hi:[1,1,1]
  v_pk_fma_f32 v[74:75], v[42:43], v[158:159], v[74:75] op_sel:[0,1,0] op_sel_hi:[1,1,1]
  v_pk_fma_f32 v[76:77], v[44:45], v[158:159], v[76:77] op_sel:[0,1,0] op_sel_hi:[1,1,1]
  v_pk_fma_f32 v[78:79], v[46:47], v[158:159], v[78:79] op_sel:[0,1,0] op_sel_hi:[1,1,1]
  v_pk_fma_f32 v[80:81], v[48:49], v[158:159], v[80:81] op_sel:[0,1,0] op_sel_hi:[1,1,1]
  v_pk_fma_f32 v[82:83], v[50:51], v[158:159], v[82:83] op_sel:[0,1,0] op_sel_hi:[1,1,1]
  v_pk_fma_f32 v[84:85], v[52:53], v[158:159], v[84:85] op_sel:[0,1,0] op_sel_hi:[1,1,1]
  s_add_u32 s37, s42, 41472
  s_add_u32 m0, s36, 24576
  s_nop 0
  buffer_load_dwordx4 v2, s[76:79], s37 offen lds
  v_pk_fma_f32 v[86:87], v[54:55], v[158:159], v[86:87] op_sel:[0,1,0] op_sel_hi:[1,1,1]
  v_pk_add_f32 v[72:73], v[72:73], v[32:33] op_sel_hi:[1,0]
  v_pk_add_f32 v[74:75], v[74:75], v[32:33] op_sel_hi:[1,0]
  v_pk_add_f32 v[76:77], v[76:77], v[32:33] op_sel_hi:[1,0]
  v_pk_add_f32 v[78:79], v[78:79], v[32:33] op_sel_hi:[1,0]
  v_pk_add_f32 v[80:81], v[80:81], v[32:33] op_sel_hi:[1,0]
  v_pk_add_f32 v[82:83], v[82:83], v[32:33] op_sel_hi:[1,0]
  v_pk_add_f32 v[84:85], v[84:85], v[32:33] op_sel_hi:[1,0]
  v_pk_add_f32 v[86:87], v[86:87], v[32:33] op_sel_hi:[1,0]
  s_nop 0
  v_cvt_pk_bf16_f32 v176, v72, v73
  v_cvt_pk_bf16_f32 v177, v74, v75
  s_add_u32 m0, s36, 25600
  s_nop 0
  buffer_load_dwordx4 v3, s[76:79], s37 offen lds
  v_cvt_pk_bf16_f32 v178, v76, v77
  v_cvt_pk_bf16_f32 v179, v78, v79
  v_cvt_pk_bf16_f32 v180, v80, v81
  v_cvt_pk_bf16_f32 v181, v82, v83
  v_cvt_pk_bf16_f32 v182, v84, v85
  v_cvt_pk_bf16_f32 v183, v86, v87
  s_nop 1
  v_mfma_f32_16x16x32_bf16 v[40:43], v[160:163], v[168:171], 0
  v_mfma_f32_16x16x32_bf16 v[44:47], v[160:163], v[176:179], 0
  v_mfma_f32_16x16x32_bf16 v[48:51], v[176:179], v[168:171], 0
  v_mfma_f32_16x16x32_bf16 v[52:55], v[176:179], v[176:179], 0
  v_mfma_f32_16x16x32_bf16 v[40:43], v[164:167], v[172:175], v[40:43]
  v_mfma_f32_16x16x32_bf16 v[44:47], v[164:167], v[180:183], v[44:47]
  v_mfma_f32_16x16x32_bf16 v[48:51], v[180:183], v[172:175], v[48:51]
  v_mfma_f32_16x16x32_bf16 v[52:55], v[180:183], v[180:183], v[52:55]
  v_mfma_f32_16x16x32_bf16 v[88:91], a[216:219], v[184:187], 0
  ds_read_b64_tr_b16 a[232:233], v12 offset:36864
  v_mfma_f32_16x16x32_bf16 v[88:91], a[220:223], v[188:191], v[88:91]
  ds_read_b64_tr_b16 a[234:235], v12 offset:43008
  v_mfma_f32_16x16x32_bf16 v[92:95], a[216:219], a[0:3], 0
  s_add_u32 m0, s36, 26624
  ds_read_b64_tr_b16 a[236:237], v13 offset:36864
  v_mfma_f32_16x16x32_bf16 v[92:95], a[220:223], a[12:15], v[92:95]
  buffer_load_dwordx4 v4, s[76:79], s37 offen lds
  ds_read_b64_tr_b16 a[238:239], v13 offset:43008
  v_cndmask_b32 v40, v40, 0, s[66:67]
  v_cndmask_b32 v41, v41, 0, s[66:67]
  ds_write_b128 v140, v[40:43]
  v_mfma_f32_16x16x32_bf16 v[96:99], a[216:219], a[4:7], 0
  ds_read_b64_tr_b16 a[240:241], v14 offset:36864
  v_cndmask_b32 v44, v44, 0, s[66:67]
  v_cndmask_b32 v45, v45, 0, s[66:67]
  ds_write_b128 v141, v[44:47]
  v_mfma_f32_16x16x32_bf16 v[96:99], a[220:223], a[16:19], v[96:99]
  s_add_u32 s37, s42, 82944
  s_add_u32 m0, s36, 36864
  ds_read_b64_tr_b16 a[242:243], v14 offset:43008
  v_cndmask_b32 v50, v50, 0, s[52:53]
  v_cndmask_b32 v51, v51, 0, s[52:53]
  ds_write_b128 v142, v[48:51]
  v_mfma_f32_16x16x32_bf16 v[100:103], a[216:219], a[8:11], 0
  buffer_load_dwordx4 v2, s[76:79], s37 offen lds
  ds_read_b64_tr_b16 a[244:245], v15 offset:36864
  v_cndmask_b32 v54, v54, 0, s[52:53]
  v_cndmask_b32 v55, v55, 0, s[52:53]
  ds_write_b128 v143, v[52:55]
  v_mfma_f32_16x16x32_bf16 v[100:103], a[220:223], a[20:23], v[100:103]
  ds_read_b64_tr_b16 a[246:247], v15 offset:43008
  ds_read_b32 v56, v33 offset:0
  ds_read_b32 v57, v33 offset:256
  ds_read_b32 v58, v33 offset:512
  v_mfma_f32_16x16x32_bf16 v[104:107], a[224:227], v[184:187], 0
  s_add_u32 m0, s36, 37888
  ds_read_b32 v59, v33 offset:768
  ds_read_b32 v60, v33 offset:1024
  ds_read_b32 v61, v33 offset:1280
  v_mfma_f32_16x16x32_bf16 v[104:107], a[228:231], v[188:191], v[104:107]
  buffer_load_dwordx4 v3, s[76:79], s37 offen lds
  v_mfma_f32_16x16x32_bf16 v[120:123], a[216:219], a[248:251], 0
  v_mfma_f32_16x16x32_bf16 v[120:123], a[220:223], a[248:251], v[120:123]
  s_add_u32 m0, s36, 38912
  v_mfma_f32_16x16x32_bf16 v[124:127], a[224:227], a[248:251], 0
  buffer_load_dwordx4 v4, s[76:79], s37 offen lds
  s_waitcnt vmcnt(29) lgkmcnt(0)
  v_mfma_f32_16x16x32_bf16 v[124:127], a[228:231], a[248:251], v[124:127]
  s_barrier
  v_mfma_f32_16x16x32_bf16 v[88:91], a[232:235], v[192:195], v[88:91]
  ds_read_b64_tr_b16 a[216:217], v12 offset:49152
  buffer_atomic_add_f32 v56, v37, s[16:19], s65 offen offset:0
  v_mfma_f32_16x16x32_bf16 v[88:91], a[236:239], v[196:199], v[88:91]
  ds_read_b64_tr_b16 a[218:219], v12 offset:55296
  buffer_atomic_add_f32 v57, v37, s[16:19], s65 offen offset:256
  v_mfma_f32_16x16x32_bf16 v[92:95], a[232:235], a[24:27], v[92:95]
  ds_read_b64_tr_b16 a[220:221], v13 offset:49152
  buffer_atomic_add_f32 v58, v37, s[16:19], s65 offen offset:512
  v_mfma_f32_16x16x32_bf16 v[92:95], a[236:239], a[36:39], v[92:95]
  ds_read_b64_tr_b16 a[222:223], v13 offset:55296
  buffer_atomic_add_f32 v59, v37, s[16:19], s65 offen offset:768
  v_mfma_f32_16x16x32_bf16 v[96:99], a[232:235], a[28:31], v[96:99]
  ds_read_b64_tr_b16 a[224:225], v14 offset:49152
  buffer_atomic_add_f32 v60, v37, s[16:19], s65 offen offset:1024
  v_mfma_f32_16x16x32_bf16 v[96:99], a[236:239], a[40:43], v[96:99]
  ds_read_b64_tr_b16 a[226:227], v14 offset:55296
  buffer_atomic_add_f32 v61, v37, s[16:19], s65 offen offset:1280
  v_mfma_f32_16x16x32_bf16 v[100:103], a[232:235], a[32:35], v[100:103]
  ds_read_b64_tr_b16 a[228:229], v15 offset:49152
  v_mfma_f32_16x16x32_bf16 v[100:103], a[236:239], a[44:47], v[100:103]
  ds_read_b64_tr_b16 a[230:231], v15 offset:55296
  v_mfma_f32_16x16x32_bf16 v[104:107], a[240:243], v[192:195], v[104:107]
  v_mfma_f32_16x16x32_bf16 v[104:107], a[244:247], v[196:199], v[104:107]
  v_mfma_f32_16x16x32_bf16 v[120:123], a[232:235], a[248:251], v[120:123]
  v_mfma_f32_16x16x32_bf16 v[120:123], a[236:239], a[248:251], v[120:123]
  v_mfma_f32_16x16x32_bf16 v[124:127], a[240:243], a[248:251], v[124:127]
  s_waitcnt vmcnt(32) lgkmcnt(0)
  v_mfma_f32_16x16x32_bf16 v[124:127], a[244:247], a[248:251], v[124:127]
  s_barrier
  v_mfma_f32_16x16x32_bf16 v[88:91], a[216:219], v[200:203], v[88:91]
  ds_read_b64_tr_b16 a[232:233], v16 offset:0
  ds_read_b32 v72, v131
  ds_read_b32 v73, v131 offset:256
  v_mfma_f32_16x16x32_bf16 v[88:91], a[220:223], v[204:207], v[88:91]
  ds_read_b64_tr_b16 a[234:235], v16 offset:6144
  ds_read_b32 v74, v138
  ds_read_b32 v75, v138 offset:256
  v_mfma_f32_16x16x32_bf16 v[92:95], a[216:219], a[48:51], v[92:95]
  ds_read_b64_tr_b16 a[236:237], v17 offset:0
  ds_read_b32 v76, v139
  ds_read_b32 v77, v139 offset:256
  v_mfma_f32_16x16x32_bf16 v[92:95], a[220:223], a[60:63], v[92:95]
  ds_read_b64_tr_b16 a[238:239], v17 offset:6144
  ds_read_b32 v78, v28
  ds_read_b32 v79, v28 offset:256
  v_mfma_f32_16x16x32_bf16 v[96:99], a[216:219], a[52:55], v[96:99]
  ds_read_b64_tr_b16 a[240:241], v18 offset:0
  s_and_b32 s66, s41, 1
  s_lshl_b32 s67, s24, 1
  s_add_u32 s67, s67, s66
  s_cmp_eq_u32 s66, 0
  s_cselect_b32 s58, 8, 0
  s_and_b32 s59, s24, 1
  v_and_b32 v36, 3, v1
  v_mfma_f32_16x16x32_bf16 v[96:99], a[220:223], a[64:67], v[96:99]
  ds_read_b64_tr_b16 a[242:243], v18 offset:6144
  s_lshl_b32 s50, s67, 5
  s_add_u32 s50, s50, s43
  v_mfma_f32_16x16x32_bf16 v[100:103], a[216:219], a[56:59], v[100:103]
  ds_read_b64_tr_b16 a[244:245], v19 offset:0
  v_lshl_add_u32 v34, v36, 3, s50
  v_add_u32 v39, 32, v34
  v_mfma_f32_16x16x32_bf16 v[100:103], a[220:223], a[68:71], v[100:103]
  ds_read_b64_tr_b16 a[246:247], v19 offset:6144
  v_lshrrev_b32 v35, 7, v34
  v_mul_u32_u24 v35, 896, v35
  v_mfma_f32_16x16x32_bf16 v[104:107], a[224:227], v[200:203], v[104:107]
  v_add_u32 v34, v34, v35
  v_lshrrev_b32 v35, 7, v39
  v_mfma_f32_16x16x32_bf16 v[104:107], a[228:231], v[204:207], v[104:107]
  v_mul_u32_u24 v35, 896, v35
  v_add_u32 v39, v39, v35
  v_mfma_f32_16x16x32_bf16 v[120:123], a[216:219], a[248:251], v[120:123]
  v_xor_b32 v34, v34, v21
  v_mfma_f32_16x16x32_bf16 v[120:123], a[220:223], a[248:251], v[120:123]
  v_add_u32 v140, v34, v20
  v_mfma_f32_16x16x32_bf16 v[124:127], a[224:227], a[248:251], v[124:127]
  s_waitcnt vmcnt(6) lgkmcnt(0)
  v_mfma_f32_16x16x32_bf16 v[124:127], a[228:231], a[248:251], v[124:127]
  s_barrier
  v_mfma_f32_16x16x32_bf16 v[88:91], a[232:235], v[208:211], v[88:91]
  ds_read_b64_tr_b16 a[216:217], v16 offset:12288
  v_add_u32 v144, 61440, v140
  v_add_u32 v148, 122880, v140
  v_mfma_f32_16x16x32_bf16 v[88:91], a[236:239], v[212:215], v[88:91]
  ds_read_b64_tr_b16 a[218:219], v16 offset:18432
  v_xor_b32 v39, v39, v21
  v_add_u32 v141, v39, v20
  v_mfma_f32_16x16x32_bf16 v[92:95], a[232:235], a[72:75], v[92:95]
  ds_read_b64_tr_b16 a[220:221], v17 offset:12288
  v_add_u32 v145, 61440, v141
  v_add_u32 v149, 122880, v141
  v_mfma_f32_16x16x32_bf16 v[92:95], a[236:239], a[84:87], v[92:95]
  ds_read_b64_tr_b16 a[222:223], v17 offset:18432
  s_lshl_b32 s49, s58, 5
  s_add_u32 s49, s49, s43
  v_mfma_f32_16x16x32_bf16 v[96:99], a[232:235], a[76:79], v[96:99]
  ds_read_b64_tr_b16 a[224:225], v18 offset:12288
  v_lshl_add_u32 v34, v36, 3, s49
  v_mfma_f32_16x16x32_bf16 v[96:99], a[236:239], a[88:91], v[96:99]
  ds_read_b64_tr_b16 a[226:227], v18 offset:18432
  v_lshrrev_b32 v35, 7, v34
  v_mfma_f32_16x16x32_bf16 v[100:103], a[232:235], a[80:83], v[100:103]
  ds_read_b64_tr_b16 a[228:229], v19 offset:12288
  v_mul_u32_u24 v35, 896, v35
  v_mfma_f32_16x16x32_bf16 v[100:103], a[236:239], a[92:95], v[100:103]
  ds_read_b64_tr_b16 a[230:231], v19 offset:18432
  v_add_u32 v34, v34, v35
  v_mfma_f32_16x16x32_bf16 v[104:107], a[240:243], v[208:211], v[104:107]
  v_xor_b32 v34, v34, v21
  v_mfma_f32_16x16x32_bf16 v[104:107], a[244:247], v[212:215], v[104:107]
  v_add_u32 v142, v34, v20
  v_mfma_f32_16x16x32_bf16 v[120:123], a[232:235], a[248:251], v[120:123]
  v_add_u32 v146, 61440, v142
  v_mfma_f32_16x16x32_bf16 v[120:123], a[236:239], a[248:251], v[120:123]
  v_add_u32 v150, 122880, v142
  v_mfma_f32_16x16x32_bf16 v[124:127], a[240:243], a[248:251], v[124:127]
  s_waitcnt vmcnt(24) lgkmcnt(0)
  v_mfma_f32_16x16x32_bf16 v[124:127], a[244:247], a[248:251], v[124:127]
  s_barrier
  v_mfma_f32_16x16x32_bf16 v[88:91], a[216:219], v[216:219], v[88:91]
  ds_read_b64_tr_b16 a[232:233], v8 offset:49152
  ds_read_b64_tr_b16 a[0:1], v140 offset:12288
  v_mfma_f32_16x16x32_bf16 v[88:91], a[220:223], v[220:223], v[88:91]
  ds_read_b64_tr_b16 a[234:235], v8 offset:55296
  ds_read_b64_tr_b16 a[2:3], v140 offset:18432
  v_mfma_f32_16x16x32_bf16 v[92:95], a[216:219], a[96:99], v[92:95]
  s_add_u32 s37, s42, 124416
  s_add_u32 m0, s36, 86016
  ds_read_b64_tr_b16 a[236:237], v9 offset:49152
  ds_read_b64_tr_b16 a[4:5], v141 offset:12288
  v_mfma_f32_16x16x32_bf16 v[92:95], a[220:223], a[108:111], v[92:95]
  buffer_load_dwordx4 v2, s[76:79], s37 offen lds
  ds_read_b64_tr_b16 a[238:239], v9 offset:55296
  ds_read_b64_tr_b16 a[6:7], v141 offset:18432
  v_mfma_f32_16x16x32_bf16 v[96:99], a[216:219], a[100:103], v[96:99]
  ds_read_b64_tr_b16 a[240:241], v10 offset:49152
  ds_read_b64_tr_b16 a[8:9], v142 offset:12288
  v_mfma_f32_16x16x32_bf16 v[96:99], a[220:223], a[112:115], v[96:99]
  s_add_u32 m0, s36, 87040
  ds_read_b64_tr_b16 a[242:243], v10 offset:55296
  ds_read_b64_tr_b16 a[10:11], v142 offset:18432
  v_mfma_f32_16x16x32_bf16 v[100:103], a[216:219], a[104:107], v[100:103]
  buffer_load_dwordx4 v3, s[76:79], s37 offen lds
  ds_read_b64_tr_b16 a[244:245], v11 offset:49152
  ds_read_b64_tr_b16 a[12:13], v140 offset:24576
  v_mfma_f32_16x16x32_bf16 v[100:103], a[220:223], a[116:119], v[100:103]
  ds_read_b64_tr_b16 a[246:247], v11 offset:55296
  ds_read_b64_tr_b16 a[14:15], v140 offset:30720
  v_mfma_f32_16x16x32_bf16 v[104:107], a[224:227], v[216:219], v[104:107]
  s_add_u32 m0, s36, 88064
  ds_read_b64_tr_b16 a[16:17], v141 offset:24576
  v_mfma_f32_16x16x32_bf16 v[104:107], a[228:231], v[220:223], v[104:107]
L_wu_p1_2:
L_st_6000:
  s_cbranch_execz L_wuret_p1
  buffer_load_dwordx4 v4, s[76:79], s37 offen lds
  ds_read_b64_tr_b16 a[18:19], v141 offset:30720
  v_mfma_f32_16x16x32_bf16 v[120:123], a[216:219], a[248:251], v[120:123]
  ds_read_b64_tr_b16 a[20:21], v142 offset:24576
  v_mfma_f32_16x16x32_bf16 v[120:123], a[220:223], a[248:251], v[120:123]
  s_add_u32 s37, s42, 165888
  s_add_u32 m0, s36, 98304
  ds_read_b64_tr_b16 a[22:23], v142 offset:30720
  v_mfma_f32_16x16x32_bf16 v[124:127], a[224:227], a[248:251], v[124:127]
  buffer_load_dwordx4 v2, s[76:79], s37 offen lds
  s_waitcnt vmcnt(25) lgkmcnt(5)
  v_mfma_f32_16x16x32_bf16 v[124:127], a[228:231], a[248:251], v[124:127]
  s_barrier
  v_mfma_f32_16x16x32_bf16 v[88:91], a[232:235], v[224:227], v[88:91]
  ds_read_b64_tr_b16 a[216:217], v12 offset:0
  ds_read_b64_tr_b16 a[24:25], v140 offset:36864
  ds_read_b64_tr_b16 a[26:27], v140 offset:43008
  v_mfma_f32_16x16x32_bf16 v[88:91], a[236:239], v[228:231], v[88:91]
  ds_read_b64_tr_b16 a[218:219], v12 offset:6144
  ds_read_b64_tr_b16 a[28:29], v141 offset:36864
  ds_read_b64_tr_b16 a[30:31], v141 offset:43008
  v_mfma_f32_16x16x32_bf16 v[92:95], a[232:235], a[120:123], v[92:95]
  s_add_u32 m0, s36, 99328
  ds_read_b64_tr_b16 a[220:221], v13 offset:0
  ds_read_b64_tr_b16 a[32:33], v142 offset:36864
  ds_read_b64_tr_b16 a[34:35], v142 offset:43008
  v_mfma_f32_16x16x32_bf16 v[92:95], a[236:239], a[132:135], v[92:95]
  buffer_load_dwordx4 v3, s[76:79], s37 offen lds
  ds_read_b64_tr_b16 a[222:223], v13 offset:6144
  v_and_b32 v34, 15, v1
  v_lshlrev_b32 v34, 4, v34
  v_mfma_f32_16x16x32_bf16 v[96:99], a[232:235], a[124:127], v[96:99]
  ds_read_b64_tr_b16 a[224:225], v14 offset:0
  v_lshrrev_b32 v36, 5, v1
  v_mfma_f32_16x16x32_bf16 v[96:99], a[236:239], a[136:139], v[96:99]
  s_add_u32 m0, s36, 100352
  ds_read_b64_tr_b16 a[226:227], v14 offset:6144
  v_lshl_add_u32 v36, v36, 8, v34
  v_mfma_f32_16x16x32_bf16 v[100:103], a[232:235], a[128:131], v[100:103]
  buffer_load_dwordx4 v4, s[76:79], s37 offen lds
  ds_read_b64_tr_b16 a[228:229], v15 offset:0
  v_bfe_u32 v37, v1, 4, 1
  v_mfma_f32_16x16x32_bf16 v[100:103], a[236:239], a[140:143], v[100:103]
  ds_read_b64_tr_b16 a[230:231], v15 offset:6144
  v_add_u32 v37, s24, v37
  v_mfma_f32_16x16x32_bf16 v[104:107], a[240:243], v[224:227], v[104:107]
  s_add_u32 s37, s42, 207360
  s_add_u32 m0, s36, 110592
  s_mul_i32 s38, s27, 73728
  v_mfma_f32_16x16x32_bf16 v[104:107], a[244:247], v[228:231], v[104:107]
  buffer_load_dwordx4 v2, s[76:79], s37 offen lds
  s_mul_i32 s64, s28, 2304
  v_mfma_f32_16x16x32_bf16 v[120:123], a[232:235], a[248:251], v[120:123]
  s_add_u32 s38, s38, s64
  v_mfma_f32_16x16x32_bf16 v[120:123], a[236:239], a[248:251], v[120:123]
  s_add_u32 m0, s36, 111616
  s_add_u32 s38, s38, 0
  v_mfma_f32_16x16x32_bf16 v[124:127], a[240:243], a[248:251], v[124:127]
  buffer_load_dwordx4 v3, s[76:79], s37 offen lds
  s_waitcnt vmcnt(26) lgkmcnt(0)
  v_mfma_f32_16x16x32_bf16 v[124:127], a[244:247], a[248:251], v[124:127]
  s_barrier
  v_mfma_f32_16x16x32_bf16 v[88:91], a[216:219], v[232:235], v[88:91]
  ds_read_b64_tr_b16 a[232:233], v12 offset:12288
  s_lshl_b32 s64, s24, 9
  s_add_u32 s64, s64, s38
  v_mfma_f32_16x16x32_bf16 v[88:91], a[220:223], v[236:239], v[88:91]
  ds_read_b64_tr_b16 a[234:235], v12 offset:18432
  s_mul_i32 s65, s24, 18432
  s_add_u32 s65, s65, s38
  v_mfma_f32_16x16x32_bf16 v[92:95], a[216:219], a[144:147], v[92:95]
  s_add_u32 m0, s36, 112640
  ds_read_b64_tr_b16 a[236:237], v13 offset:12288
  v_add_u32 v38, 0, v37
  v_mfma_f32_16x16x32_bf16 v[92:95], a[220:223], a[156:159], v[92:95]
  buffer_load_dwordx4 v4, s[76:79], s37 offen lds
  ds_read_b64_tr_b16 a[238:239], v13 offset:18432
  v_and_b32 v38, 3, v38
  v_mfma_f32_16x16x32_bf16 v[96:99], a[216:219], a[148:151], v[96:99]
  ds_read_b64_tr_b16 a[240:241], v14 offset:12288
  v_mul_u32_u24 v38, 18432, v38
  v_mfma_f32_16x16x32_bf16 v[96:99], a[220:223], a[160:163], v[96:99]
  s_add_u32 s37, s42, 248832
  s_add_u32 m0, s36, 147456
  ds_read_b64_tr_b16 a[242:243], v14 offset:18432
  v_add_u32 v152, v38, v36
  v_mfma_f32_16x16x32_bf16 v[100:103], a[216:219], a[152:155], v[100:103]
  buffer_load_dwordx4 v2, s[76:79], s37 offen lds
  ds_read_b64_tr_b16 a[244:245], v15 offset:12288
  v_add_u32 v38, 2, v37
  v_mfma_f32_16x16x32_bf16 v[100:103], a[220:223], a[164:167], v[100:103]
  ds_read_b64_tr_b16 a[246:247], v15 offset:18432
  v_and_b32 v38, 3, v38
  v_mfma_f32_16x16x32_bf16 v[104:107], a[224:227], v[232:235], v[104:107]
  s_add_u32 m0, s36, 148480
  v_mul_u32_u24 v38, 18432, v38
  v_mfma_f32_16x16x32_bf16 v[104:107], a[228:231], v[236:239], v[104:107]
  buffer_load_dwordx4 v3, s[76:79], s37 offen lds
  v_add_u32 v153, v38, v36
  v_mfma_f32_16x16x32_bf16 v[120:123], a[216:219], a[248:251], v[120:123]
  v_cmp_gt_u32 vcc, 16, v1
  v_mov_b32 v155, 0x7f000000
  v_mov_b32 v27, 1
  v_cndmask_b32 v154, v155, v34, vcc
  v_mfma_f32_16x16x32_bf16 v[120:123], a[220:223], a[248:251], v[120:123]
  s_add_u32 m0, s36, 149504
  v_cmp_eq_u32 vcc, 0, v0
  s_and_b32 s31, s2, 15
  s_lshl_b32 s31, s31, 8
  s_add_u32 s31, s31, 7925760
  v_cndmask_b32 v26, v155, 0, vcc
  v_mfma_f32_16x16x32_bf16 v[124:127], a[224:227], a[248:251], v[124:127]
  buffer_load_dwordx4 v4, s[76:79], s37 offen lds
  s_waitcnt vmcnt(12) lgkmcnt(0)
  v_mfma_f32_16x16x32_bf16 v[124:127], a[228:231], a[248:251], v[124:127]
  s_barrier
  v_mfma_f32_16x16x32_bf16 v[88:91], a[232:235], v[240:243], v[88:91]
  ds_read_b64_tr_b16 a[216:217], v8 offset:0
  buffer_atomic_add v27, v26, s[16:19], s31 offen sc0
  v_mfma_f32_16x16x32_bf16 v[88:91], a[236:239], v[244:247], v[88:91]
  ds_read_b64_tr_b16 a[218:219], v8 offset:6144
  v_mfma_f32_16x16x32_bf16 v[92:95], a[232:235], a[168:171], v[92:95]
  s_add_u32 s37, s42, 290304
  s_add_u32 m0, s36, 122880
  ds_read_b64_tr_b16 a[220:221], v9 offset:0
  v_mfma_f32_16x16x32_bf16 v[92:95], a[236:239], a[180:183], v[92:95]
  buffer_load_dwordx4 v2, s[76:79], s37 offen lds
  ds_read_b64_tr_b16 a[222:223], v9 offset:6144
  v_mfma_f32_16x16x32_bf16 v[96:99], a[232:235], a[172:175], v[96:99]
  ds_read_b64_tr_b16 a[224:225], v10 offset:0
  v_mfma_f32_16x16x32_bf16 v[96:99], a[236:239], a[184:187], v[96:99]
  s_add_u32 m0, s36, 123904
  ds_read_b64_tr_b16 a[226:227], v10 offset:6144
  v_mfma_f32_16x16x32_bf16 v[100:103], a[232:235], a[176:179], v[100:103]
  buffer_load_dwordx4 v3, s[76:79], s37 offen lds
  ds_read_b64_tr_b16 a[228:229], v11 offset:0
  v_mfma_f32_16x16x32_bf16 v[100:103], a[236:239], a[188:191], v[100:103]
  ds_read_b64_tr_b16 a[230:231], v11 offset:6144
  v_mfma_f32_16x16x32_bf16 v[104:107], a[240:243], v[240:243], v[104:107]
  s_add_u32 m0, s36, 124928
  v_mfma_f32_16x16x32_bf16 v[104:107], a[244:247], v[244:247], v[104:107]
  buffer_load_dwordx4 v4, s[76:79], s37 offen lds
  v_mfma_f32_16x16x32_bf16 v[120:123], a[232:235], a[248:251], v[120:123]
  v_mfma_f32_16x16x32_bf16 v[120:123], a[236:239], a[248:251], v[120:123]
  s_add_u32 s37, s42, 331776
  s_add_u32 m0, s36, 135168
  v_mfma_f32_16x16x32_bf16 v[124:127], a[240:243], a[248:251], v[124:127]
  buffer_load_dwordx4 v2, s[76:79], s37 offen lds
  s_waitcnt lgkmcnt(0)
  v_mfma_f32_16x16x32_bf16 v[124:127], a[244:247], a[248:251], v[124:127]
  s_barrier
  v_mfma_f32_16x16x32_bf16 v[88:91], a[216:219], v[248:251], v[88:91]
  v_mfma_f32_16x16x32_bf16 v[88:91], a[220:223], v[252:255], v[88:91]
  v_mfma_f32_16x16x32_bf16 v[92:95], a[216:219], a[192:195], v[92:95]
  s_add_u32 m0, s36, 136192
  v_mfma_f32_16x16x32_bf16 v[92:95], a[220:223], a[204:207], v[92:95]
  buffer_load_dwordx4 v3, s[76:79], s37 offen lds
  v_mfma_f32_16x16x32_bf16 v[96:99], a[216:219], a[196:199], v[96:99]
  v_mfma_f32_16x16x32_bf16 v[96:99], a[220:223], a[208:211], v[96:99]
  s_add_u32 m0, s36, 137216
  v_mfma_f32_16x16x32_bf16 v[100:103], a[216:219], a[200:203], v[100:103]
  buffer_load_dwordx4 v4, s[76:79], s37 offen lds
  v_mfma_f32_16x16x32_bf16 v[100:103], a[220:223], a[212:215], v[100:103]
  v_mfma_f32_16x16x32_bf16 v[104:107], a[224:227], v[248:251], v[104:107]
  s_add_u32 s37, s42, 373248
  s_add_u32 m0, s36, 49152
  v_mfma_f32_16x16x32_bf16 v[104:107], a[228:231], v[252:255], v[104:107]
  buffer_load_dwordx4 v2, s[76:79], s37 offen lds
  v_mfma_f32_16x16x32_bf16 v[120:123], a[216:219], a[248:251], v[120:123]
  v_mfma_f32_16x16x32_bf16 v[120:123], a[220:223], a[248:251], v[120:123]
  s_add_u32 m0, s36, 50176
  v_mfma_f32_16x16x32_bf16 v[124:127], a[224:227], a[248:251], v[124:127]
  buffer_load_dwordx4 v3, s[76:79], s37 offen lds
  v_mfma_f32_16x16x32_bf16 v[124:127], a[228:231], a[248:251], v[124:127]
  s_nop 3
  v_pk_mul_f32 v[132:133], v[120:121], v[72:73] op_sel:[0,1] op_sel_hi:[1,1]
  v_pk_mul_f32 v[134:135], v[122:123], v[72:73] op_sel:[0,1] op_sel_hi:[1,1]
  v_pk_fma_f32 v[88:89], v[88:89], v[72:73], v[132:133] op_sel_hi:[1,0,1] neg_lo:[0,0,1] neg_hi:[0,0,1]
  v_pk_fma_f32 v[90:91], v[90:91], v[72:73], v[134:135] op_sel_hi:[1,0,1] neg_lo:[0,0,1] neg_hi:[0,0,1]
  v_pk_mul_f32 v[132:133], v[120:121], v[74:75] op_sel:[0,1] op_sel_hi:[1,1]
  v_pk_mul_f32 v[134:135], v[122:123], v[74:75] op_sel:[0,1] op_sel_hi:[1,1]
  v_pk_fma_f32 v[92:93], v[92:93], v[74:75], v[132:133] op_sel_hi:[1,0,1] neg_lo:[0,0,1] neg_hi:[0,0,1]
  v_pk_fma_f32 v[94:95], v[94:95], v[74:75], v[134:135] op_sel_hi:[1,0,1] neg_lo:[0,0,1] neg_hi:[0,0,1]
  v_pk_mul_f32 v[132:133], v[120:121], v[76:77] op_sel:[0,1] op_sel_hi:[1,1]
  v_pk_mul_f32 v[134:135], v[122:123], v[76:77] op_sel:[0,1] op_sel_hi:[1,1]
  v_pk_fma_f32 v[96:97], v[96:97], v[76:77], v[132:133] op_sel_hi:[1,0,1] neg_lo:[0,0,1] neg_hi:[0,0,1]
  v_pk_fma_f32 v[98:99], v[98:99], v[76:77], v[134:135] op_sel_hi:[1,0,1] neg_lo:[0,0,1] neg_hi:[0,0,1]
  v_pk_mul_f32 v[132:133], v[120:121], v[78:79] op_sel:[0,1] op_sel_hi:[1,1]
  v_pk_mul_f32 v[134:135], v[122:123], v[78:79] op_sel:[0,1] op_sel_hi:[1,1]
  v_pk_fma_f32 v[100:101], v[100:101], v[78:79], v[132:133] op_sel_hi:[1,0,1] neg_lo:[0,0,1] neg_hi:[0,0,1]
  v_pk_fma_f32 v[102:103], v[102:103], v[78:79], v[134:135] op_sel_hi:[1,0,1] neg_lo:[0,0,1] neg_hi:[0,0,1]
  v_pk_mul_f32 v[132:133], v[124:125], v[72:73] op_sel:[0,1] op_sel_hi:[1,1]
  v_pk_mul_f32 v[134:135], v[126:127], v[72:73] op_sel:[0,1] op_sel_hi:[1,1]
  v_pk_fma_f32 v[104:105], v[104:105], v[72:73], v[132:133] op_sel_hi:[1,0,1] neg_lo:[0,0,1] neg_hi:[0,0,1]
  v_pk_fma_f32 v[106:107], v[106:107], v[72:73], v[134:135] op_sel_hi:[1,0,1] neg_lo:[0,0,1] neg_hi:[0,0,1]
  v_pk_mul_f32 v[160:161], v[88:89], s[54:55]
  v_pk_mul_f32 v[162:163], v[90:91], s[54:55]
  v_pk_mul_f32 v[164:165], v[92:93], s[54:55]
  v_pk_mul_f32 v[166:167], v[94:95], s[54:55]
  v_pk_mul_f32 v[168:169], v[96:97], s[54:55]
  v_pk_mul_f32 v[170:171], v[98:99], s[54:55]
  v_pk_mul_f32 v[172:173], v[100:101], s[54:55]
  v_pk_mul_f32 v[174:175], v[102:103], s[54:55]
  v_pk_mul_f32 v[176:177], v[104:105], s[54:55]
  v_pk_mul_f32 v[178:179], v[106:107], s[54:55]
  v_exp_f32_e64 v160, v160 clamp
  v_exp_f32_e64 v161, v161 clamp
  v_exp_f32_e64 v162, v162 clamp
  v_exp_f32_e64 v163, v163 clamp
  v_exp_f32_e64 v164, v164 clamp
  v_exp_f32_e64 v165, v165 clamp
  v_exp_f32_e64 v166, v166 clamp
  v_exp_f32_e64 v167, v167 clamp
  v_exp_f32_e64 v168, v168 clamp
  v_exp_f32_e64 v169, v169 clamp
  v_exp_f32_e64 v170, v170 clamp
  v_exp_f32_e64 v171, v171 clamp
  v_exp_f32_e64 v172, v172 clamp
  v_exp_f32_e64 v173, v173 clamp
  v_exp_f32_e64 v174, v174 clamp
  v_exp_f32_e64 v175, v175 clamp
  v_exp_f32_e64 v176, v176 clamp
  v_exp_f32_e64 v177, v177 clamp
  v_exp_f32_e64 v178, v178 clamp
  v_exp_f32_e64 v179, v179 clamp
  v_max_f32 v88, 0, v88
  v_max_f32 v89, 0, v89
  v_max_f32 v90, 0, v90
  v_max_f32 v91, 0, v91
  v_max_f32 v92, 0, v92
  v_max_f32 v93, 0, v93
  v_max_f32 v94, 0, v94
  v_max_f32 v95, 0, v95
  v_max_f32 v96, 0, v96
  v_max_f32 v97, 0, v97
  v_max_f32 v98, 0, v98
  v_max_f32 v99, 0, v99
  v_max_f32 v100, 0, v100
  v_max_f32 v101, 0, v101
  v_max_f32 v102, 0, v102
  v_max_f32 v103, 0, v103
  v_max_f32 v104, 0, v104
  v_max_f32 v105, 0, v105
  v_max_f32 v106, 0, v106
  v_max_f32 v107, 0, v107
  v_pk_add_f32 v[88:89], v[88:89], v[160:161]
  v_pk_add_f32 v[90:91], v[90:91], v[162:163]
  v_pk_add_f32 v[92:93], v[92:93], v[164:165]
  v_pk_add_f32 v[94:95], v[94:95], v[166:167]
  v_pk_add_f32 v[96:97], v[96:97], v[168:169]
  v_pk_add_f32 v[98:99], v[98:99], v[170:171]
  v_pk_add_f32 v[100:101], v[100:101], v[172:173]
  v_pk_add_f32 v[102:103], v[102:103], v[174:175]
  v_pk_add_f32 v[104:105], v[104:105], v[176:177]
  v_pk_add_f32 v[106:107], v[106:107], v[178:179]
  v_pk_add_f32 v[88:89], v[88:89], s[56:57]
  v_pk_add_f32 v[90:91], v[90:91], s[56:57]
  v_pk_add_f32 v[92:93], v[92:93], s[56:57]
  v_pk_add_f32 v[94:95], v[94:95], s[56:57]
  v_pk_add_f32 v[96:97], v[96:97], s[56:57]
  v_pk_add_f32 v[98:99], v[98:99], s[56:57]
  v_pk_add_f32 v[100:101], v[100:101], s[56:57]
  v_pk_add_f32 v[102:103], v[102:103], s[56:57]
  v_pk_add_f32 v[104:105], v[104:105], s[56:57]
  v_pk_add_f32 v[106:107], v[106:107], s[56:57]
  s_waitcnt vmcnt(8)
  v_cmp_eq_u32 vcc, 15, v27
  s_nop 1
  v_cndmask_b32 v25, v155, v26, vcc
  buffer_store_dword v27, v25, s[16:19], s31 offen offset:128 sc1
  v_cvt_pk_bf16_f32 v160, v88, v89
  v_cvt_pk_bf16_f32 v161, v90, v91
  v_cvt_pk_bf16_f32 v162, v92, v93
  v_cvt_pk_bf16_f32 v163, v94, v95
  v_cvt_pk_bf16_f32 v164, v96, v97
  v_cvt_pk_bf16_f32 v165, v98, v99
  v_cvt_pk_bf16_f32 v166, v100, v101
  v_cvt_pk_bf16_f32 v167, v102, v103
  v_cvt_pk_bf16_f32 v168, v104, v105
  v_cvt_pk_bf16_f32 v169, v106, v107
  v_mov_b32 v170, v168
  v_mov_b32 v171, v169
  v_permlane16_swap_b32 v160, v162
  v_permlane16_swap_b32 v161, v163
  v_permlane16_swap_b32 v164, v166
  v_permlane16_swap_b32 v165, v167
  v_permlane16_swap_b32 v168, v170
  v_permlane16_swap_b32 v169, v171
  buffer_store_dwordx4 v[160:163], v152, s[16:19], s64 offen sc1
  buffer_store_dwordx4 v[164:167], v153, s[16:19], s64 offen sc1
  buffer_store_dwordx4 v[168:171], v154, s[16:19], s65 offen offset:2048 sc1
  s_add_u32 m0, s36, 51200
  s_nop 0
  buffer_load_dwordx4 v4, s[76:79], s37 offen lds
  s_add_u32 s37, s42, 414720
  s_add_u32 m0, s36, 61440
  s_nop 0
  buffer_load_dwordx4 v2, s[76:79], s37 offen lds
  s_add_u32 m0, s36, 62464
  s_nop 0
  buffer_load_dwordx4 v3, s[76:79], s37 offen lds
  s_add_u32 m0, s36, 63488
  s_nop 0
  buffer_load_dwordx4 v4, s[76:79], s37 offen lds
  s_add_u32 s37, s42, 456192
  s_add_u32 m0, s36, 73728
  s_nop 0
  buffer_load_dwordx4 v2, s[76:79], s37 offen lds
  s_add_u32 m0, s36, 74752
  s_nop 0
  buffer_load_dwordx4 v3, s[76:79], s37 offen lds
  s_add_u32 m0, s36, 75776
  s_nop 0
  buffer_load_dwordx4 v4, s[76:79], s37 offen lds
  s_mov_b32 s27, s40
  s_mov_b32 s28, s41
  s_mov_b32 s29, s66
  s_mov_b32 s34, s67
  s_lshl_b32 s38, s2, 9
  s_add_u32 s38, s38, 7995780
  s_waitcnt vmcnt(7)
  s_barrier
  buffer_store_dword v155, v26, s[16:19], s38 offen sc1
  s_add_u32 s37, s42, 497664
  s_add_u32 m0, s36, 12288
  s_nop 0
  buffer_load_dwordx4 v2, s[76:79], s37 offen lds
  ds_read_b64_tr_b16 a[36:37], v144 offset:24576
  ds_read_b64_tr_b16 a[38:39], v144 offset:30720
  ds_read_b64_tr_b16 a[40:41], v145 offset:24576
  ds_read_b64_tr_b16 a[42:43], v145 offset:30720
  ds_read_b64_tr_b16 a[44:45], v146 offset:24576
  ds_read_b64_tr_b16 a[46:47], v146 offset:30720
  ds_read_b64_tr_b16 a[48:49], v144 offset:36864
  ds_read_b64_tr_b16 a[50:51], v144 offset:43008
  s_add_u32 m0, s36, 13312
  s_nop 0
  buffer_load_dwordx4 v3, s[76:79], s37 offen lds
  ds_read_b64_tr_b16 a[52:53], v145 offset:36864
  ds_read_b64_tr_b16 a[54:55], v145 offset:43008
  ds_read_b64_tr_b16 a[56:57], v146 offset:36864
  ds_read_b64_tr_b16 a[58:59], v146 offset:43008
  ds_read_b64_tr_b16 a[60:61], v144 offset:49152
  ds_read_b64_tr_b16 a[62:63], v144 offset:55296
  ds_read_b64_tr_b16 a[64:65], v145 offset:49152
  ds_read_b64_tr_b16 a[66:67], v145 offset:55296
  s_add_u32 m0, s36, 14336
  s_nop 0
  buffer_load_dwordx4 v4, s[76:79], s37 offen lds
  ds_read_b64_tr_b16 a[68:69], v146 offset:49152
  ds_read_b64_tr_b16 a[70:71], v146 offset:55296
  ds_read_b64_tr_b16 a[72:73], v148 offset:24576
  ds_read_b64_tr_b16 a[74:75], v148 offset:30720
  ds_read_b64_tr_b16 a[76:77], v149 offset:24576
  ds_read_b64_tr_b16 a[78:79], v149 offset:30720
  ds_read_b64_tr_b16 a[80:81], v150 offset:24576
  ds_read_b64_tr_b16 a[82:83], v150 offset:30720
  s_add_u32 s37, s42, 539136
  s_add_u32 m0, s36, 24576
  s_nop 0
  buffer_load_dwordx4 v2, s[76:79], s37 offen lds
  ds_read_b64_tr_b16 a[84:85], v148 offset:0
  ds_read_b64_tr_b16 a[86:87], v148 offset:6144
  ds_read_b64_tr_b16 a[88:89], v149 offset:0
  ds_read_b64_tr_b16 a[90:91], v149 offset:6144
  ds_read_b64_tr_b16 a[92:93], v150 offset:0
  ds_read_b64_tr_b16 a[94:95], v150 offset:6144
  ds_read_b64_tr_b16 a[96:97], v148 offset:12288
  ds_read_b64_tr_b16 a[98:99], v148 offset:18432
  s_add_u32 m0, s36, 25600
  s_nop 0
  buffer_load_dwordx4 v3, s[76:79], s37 offen lds
  ds_read_b64_tr_b16 a[100:101], v149 offset:12288
  ds_read_b64_tr_b16 a[102:103], v149 offset:18432
  ds_read_b64_tr_b16 a[104:105], v150 offset:12288
  ds_read_b64_tr_b16 a[106:107], v150 offset:18432
  v_bfe_u32 v34, v1, 3, 1
  v_mul_u32_u24 v34, 3072, v34
  v_and_b32 v35, 7, v1
  v_lshl_add_u32 v34, v35, 7, v34
  s_add_u32 m0, s36, 26624
  s_nop 0
  buffer_load_dwordx4 v4, s[76:79], s37 offen lds
  v_bfe_u32 v37, v1, 1, 2
  v_lshlrev_b32 v37, 5, v37
  v_lshrrev_b32 v39, 4, v1
  v_lshl_add_u32 v132, v39, 3, s50
  v_add_u32 v133, 32, v132
  v_lshl_add_u32 v134, v39, 3, s49
  v_lshrrev_b32 v35, 7, v132
  v_mul_u32_u24 v35, 896, v35
  s_add_u32 s37, s42, 580608
  s_add_u32 m0, s36, 36864
  s_nop 0
  buffer_load_dwordx4 v2, s[76:79], s37 offen lds
  v_add_u32 v132, v132, v35
  v_xor_b32 v132, v132, v37
  v_add_u32 v132, v132, v34
  v_lshrrev_b32 v35, 7, v133
  v_mul_u32_u24 v35, 896, v35
  v_add_u32 v133, v133, v35
  v_xor_b32 v133, v133, v37
  v_add_u32 v133, v133, v34
  s_add_u32 m0, s36, 37888
  s_nop 0
  buffer_load_dwordx4 v3, s[76:79], s37 offen lds
  v_lshrrev_b32 v35, 7, v134
  v_mul_u32_u24 v35, 896, v35
  v_add_u32 v134, v134, v35
  v_xor_b32 v134, v134, v37
  v_add_u32 v134, v134, v34
  s_mul_i32 s38, s59, 6144
  v_add_u32 v134, s38, v134
  s_lshr_b32 s3, s27, 4
  s_add_u32 m0, s36, 38912
  s_nop 0
  buffer_load_dwordx4 v4, s[76:79], s37 offen lds
  s_lshl_b32 s3, s3, 1
  s_bfe_u32 s39, s27, 0x30001
  s_lshl_b32 s39, s39, 5
  s_add_u32 s3, s3, s39
  s_lshl_b32 s3, s3, 9
  s_add_u32 s3, s3, 7995780
  v_and_b32 v252, 3, v1
  v_lshlrev_b32 v252, 12, v252
  s_add_u32 s37, s42, 622080
  s_add_u32 m0, s36, 0
  s_nop 0
  buffer_load_dwordx4 v2, s[76:79], s37 offen lds
  v_bfe_u32 v254, v1, 2, 1
  v_lshl_add_u32 v252, v254, 9, v252
  v_add_u32 v252, s3, v252
  v_lshlrev_b32 v253, 8, v1
  v_add_u32 v253, 7925888, v253
  v_cmp_gt_u32 vcc, 16, v1
  v_subrev_u32 v254, 192, v0
  s_nop 0
  v_cndmask_b32 v253, v252, v253, vcc
  v_cmp_gt_u32 vcc, 24, v254
  v_mov_b32 v254, 0x7f000000
  s_mov_b64 s[96:97], vcc
  v_cndmask_b32 v253, v254, v253, vcc
  s_lshl_b32 s30, s24, 10
  s_add_u32 m0, s36, 1024
  s_nop 0
  buffer_load_dwordx4 v3, s[76:79], s37 offen lds
  s_add_u32 s30, s30, 159744
  v_lshlrev_b32 v86, 4, v1
  v_mov_b32 v20, 0x7f000000
  v_cmp_gt_u32 vcc, 36, v1
  s_mul_i32 s33, s24, 576
  s_add_u32 s33, s33, 7921664
  v_cndmask_b32 v25, v20, v86, vcc
  v_cmp_gt_u32 vcc, 48, v1
  s_add_u32 m0, s36, 2048
  s_nop 0
  buffer_load_dwordx4 v4, s[76:79], s37 offen lds
  s_mul_i32 s38, s24, 12288
  s_add_u32 s62, s38, 7864320
  s_add_u32 s61, s38, 61440
  v_cndmask_b32 v15, v20, v86, vcc
  s_mul_i32 s46, s27, 36864
  s_mul_i32 s47, s24, 4608
  s_add_u32 s46, s46, s47
  s_add_u32 s46, s46, 0
  s_waitcnt lgkmcnt(0)
  s_barrier
  v_lshrrev_b32 v136, 4, v22
  v_lshlrev_b32 v136, 3, v136
  v_bfe_u32 v137, v22, 1, 1
  v_lshl_add_u32 v136, v137, 2, v136
  v_bfe_u32 v137, v22, 2, 2
  v_add_u32 v136, v136, v137
  v_mul_u32_u24 v136, 18, v136
  v_and_b32 v137, 1, v22
  v_add3_u32 v136, v136, v137, 16
  v_mul_u32_u24 v136, 1152, v136
  v_lshl_add_u32 v2, v5, 4, v136
  v_add_u32 v3, 128, v2
  v_add_u32 v4, 256, v2
  s_add_u32 s37, s42, 0
  s_add_u32 m0, s36, 110592
  s_nop 0
  buffer_load_dwordx4 v2, s[76:79], s37 offen lds
  s_add_u32 s47, s46, 18432
  v_lshrrev_b32 v16, 4, v1
  v_and_b32 v17, 15, v1
  v_mul_u32_u24 v18, 608, v16
  v_add_u32 v18, s61, v18
  v_lshl_add_u32 v23, v16, 4, s30
  v_mul_u32_u24 v24, 72, v16
  v_add_u32 v24, s30, v24
  s_add_u32 m0, s36, 111616
  s_nop 0
  buffer_load_dwordx4 v3, s[76:79], s37 offen lds
  s_lshl_b32 s38, s27, 7
  s_add_u32 s38, s38, 7913472
  v_lshl_add_u32 v75, v17, 2, s38
  v_cmp_gt_u32 s[64:65], 3, v16
  v_cmp_gt_u32 s[66:67], 2, v16
  v_cmp_lt_u32 s[56:57], 0, v16
  s_add_u32 s39, s61, 1520
  v_mov_b32 v21, s39
  s_add_u32 m0, s36, 112640
  s_nop 0
  buffer_load_dwordx4 v4, s[76:79], s37 offen lds
  s_and_b64 s[56:57], s[56:57], s[64:65]
  v_lshl_add_u32 v19, v17, 4, v18
  v_add_u32 v20, 0, v19
  v_cndmask_b32 v76, v21, v20, s[64:65]
  v_add_u32 v20, 304, v19
  v_cndmask_b32 v77, v21, v20, s[66:67]
  v_add_u32 v20, -304, v19
  v_cndmask_b32 v78, v21, v20, s[56:57]
  s_add_u32 s37, s42, 331776
  s_add_u32 m0, s36, 147456
  s_nop 0
  buffer_load_dwordx4 v2, s[76:79], s37 offen lds
  v_add_u32 v20, 0, v19
  v_cndmask_b32 v79, v21, v20, s[64:65]
  v_lshlrev_b32 v84, 4, v17
  v_add_u32 v84, 159744, v84
  s_lshl_b32 s38, s24, 2
  v_and_b32 v16, 1, v16
  v_lshl_add_u32 v16, v16, 8, s38
  v_add_u32 v85, v16, v84
  s_add_u32 m0, s36, 148480
  s_nop 0
  buffer_load_dwordx4 v3, s[76:79], s37 offen lds
  v_and_b32 v19, 3, v17
  v_cmp_eq_u32 s[50:51], 2, v19
  v_and_b32 v16, 1, v17
  v_add_u32 v16, 16, v16
  v_lshrrev_b32 v17, 1, v17
  v_cndmask_b32 v16, v16, 18, s[50:51]
  v_lshl_add_u32 v19, v16, 4, v18
  v_cmp_eq_u32 s[44:45], 0, v17
  s_add_u32 m0, s36, 149504
  s_nop 0
  buffer_load_dwordx4 v4, s[76:79], s37 offen lds
  s_or_b64 s[44:45], s[44:45], s[50:51]
  s_and_b64 vcc, s[44:45], s[64:65]
  v_add_u32 v20, 0, v19
  v_cndmask_b32 v80, v21, v20, vcc
  s_and_b64 vcc, s[44:45], s[66:67]
  v_add_u32 v20, 304, v19
  v_cndmask_b32 v8, v21, v20, vcc
  v_cmp_eq_u32 s[44:45], 2, v17
  v_mov_b32 v136, v22
  v_mul_u32_u24 v136, 1152, v136
  v_lshl_add_u32 v2, v5, 4, v136
  v_add_u32 v3, 128, v2
  v_add_u32 v4, 256, v2
  s_mul_i32 s37, s40, 36864
  s_add_u32 s37, s37, s42
  s_add_u32 m0, s36, 122880
  s_nop 0
  buffer_load_dwordx4 v2, s[68:71], s37 offen lds
  s_or_b64 s[44:45], s[44:45], s[50:51]
  s_and_b64 vcc, s[44:45], s[64:65]
  v_add_u32 v20, 0, v19
  v_cndmask_b32 v9, v21, v20, vcc
  s_and_b64 vcc, s[44:45], s[66:67]
  v_add_u32 v20, 304, v19
  v_cndmask_b32 v10, v21, v20, vcc
  v_cmp_eq_u32 s[44:45], 4, v17
  s_add_u32 m0, s36, 123904
  s_nop 0
  buffer_load_dwordx4 v3, s[68:71], s37 offen lds
  s_or_b64 s[44:45], s[44:45], s[50:51]
  s_and_b64 vcc, s[44:45], s[56:57]
  v_add_u32 v20, -304, v19
  v_cndmask_b32 v11, v21, v20, vcc
  s_and_b64 vcc, s[44:45], s[64:65]
  v_add_u32 v20, 0, v19
  v_cndmask_b32 v12, v21, v20, vcc
  v_cmp_eq_u32 s[44:45], 6, v17
  s_add_u32 m0, s36, 124928
  s_nop 0
  buffer_load_dwordx4 v4, s[68:71], s37 offen lds
  s_or_b64 s[44:45], s[44:45], s[50:51]
  s_and_b64 vcc, s[44:45], s[56:57]
  v_add_u32 v20, -304, v19
  v_cndmask_b32 v13, v21, v20, vcc
  s_and_b64 vcc, s[44:45], s[64:65]
  v_add_u32 v20, 0, v19
  v_cndmask_b32 v14, v21, v20, vcc
  v_add_u32 v81, 122880, v86
  buffer_load_dword v252, v253, s[16:19], 0 offen sc1
  s_lshl_b32 s38, s24, 13
  v_add_u32 v82, s38, v81
  s_lshr_b32 s38, s24, 1
  s_lshl_b32 s38, s38, 11
  s_lshl_b32 s39, s59, 3
  s_add_u32 s38, s38, s39
  s_add_u32 s38, s38, 32768
  v_add_u32 v83, s38, v81
  s_lshl_b32 s38, s59, 10
  v_add_u32 v7, s38, v81
  s_bitcmp1_b32 s24, 0
  s_cselect_b32 s72, s8, s4
  s_cselect_b32 s73, s9, s5
  s_mov_b32 s74, s6
  s_mov_b32 s75, 0x20000
  s_lshr_b32 s63, s2, 3
  s_mul_i32 s63, s63, 165888
  s_and_b32 s3, s2, 7
  s_mul_i32 s3, s3, 1152
  s_add_u32 s63, s63, s3
  s_lshr_b32 s3, s24, 1
  s_lshl_b32 s3, s3, 9
  s_add_u32 s63, s63, s3
  v_min_u32 v6, 17, v1
  v_mul_u32_u24 v6, 9216, v6
  v_mov_b32 v240, 0
  v_mov_b32 v241, 0
  v_mov_b32 v242, 0
  v_mov_b32 v243, 0
  v_mov_b32 v244, 0
  v_mov_b32 v245, 0
  v_mov_b32 v246, 0
  v_mov_b32 v247, 0
  v_mov_b32 v248, 0
L_wu_p1_3:
L_st_7000:
  s_cbranch_execz L_wuret_p1
  v_mov_b32 v249, 0
  v_mov_b32 v250, 0
  v_mov_b32 v251, 0
  s_waitcnt vmcnt(23)
  s_barrier
  ds_read_b64_tr_b16 a[108:109], v140 offset:49152
  ds_read_b64_tr_b16 a[110:111], v140 offset:55296
  ds_read_b64_tr_b16 a[112:113], v141 offset:49152
  ds_read_b64_tr_b16 a[114:115], v141 offset:55296
  ds_read_b64_tr_b16 a[116:117], v142 offset:49152
  ds_read_b64_tr_b16 a[118:119], v142 offset:55296
  ds_read_b64_tr_b16 a[120:121], v144 offset:0
  ds_read_b64_tr_b16 a[122:123], v144 offset:6144
  ds_read_b64_tr_b16 a[124:125], v145 offset:0
  ds_read_b64_tr_b16 a[126:127], v145 offset:6144
  ds_read_b64_tr_b16 a[128:129], v146 offset:0
  ds_read_b64_tr_b16 a[130:131], v146 offset:6144
  ds_read_b64_tr_b16 a[132:133], v144 offset:12288
  ds_read_b64_tr_b16 a[134:135], v144 offset:18432
  ds_read_b64_tr_b16 a[136:137], v145 offset:12288
  ds_read_b64_tr_b16 a[138:139], v145 offset:18432
  ds_read_b64_tr_b16 a[140:141], v146 offset:12288
  ds_read_b64_tr_b16 a[142:143], v146 offset:18432
  v_add_u32 v132, 122880, v132
  v_add_u32 v133, 122880, v133
  v_add_u32 v134, 122880, v134
  s_mov_b64 exec, 0
  s_cmp_eq_u32 s24, 0
  s_cbranch_scc1 L_wu_s1_0
L_wuret_s1:
  s_mov_b64 exec, -1
L_s1_poll:
  s_waitcnt vmcnt(0)
  v_cmp_gt_u32 vcc, 15, v252
  s_and_b64 vcc, vcc, s[96:97]
  s_cbranch_scc0 L_s1_go
  buffer_load_dword v252, v253, s[16:19], 0 offen sc1
  s_sub_u32 s100, s100, 1
  s_cmp_lt_i32 s100, 0
  s_cbranch_scc0 L_s1_poll
L_s1_go:
  s_waitcnt vmcnt(0) lgkmcnt(0)
  s_barrier
  s_mov_b32 m0, s30
  s_nop 0
  buffer_load_dwordx4 v25, s[16:19], s33 offen sc1 lds
  s_add_u32 m0, s61, 0
  s_add_u32 s37, s62, 0
  buffer_load_dwordx4 v86, s[16:19], s37 offen offset:0 sc1 lds
  buffer_load_dwordx4 v86, s[16:19], s37 offen offset:1024 sc1 lds
  buffer_load_dwordx4 v[88:91], v15, s[16:19], s46 offen offset:0 sc1
  buffer_load_dwordx4 v[92:95], v15, s[16:19], s47 offen offset:0 sc1
  buffer_load_dwordx4 v86, s[16:19], s37 offen offset:2048 sc1 lds
  buffer_load_dwordx4 v[96:99], v15, s[16:19], s46 offen offset:512 sc1
  buffer_load_dwordx4 v[100:103], v15, s[16:19], s47 offen offset:512 sc1
  buffer_load_dwordx4 v86, s[16:19], s37 offen offset:3072 sc1 lds
  s_add_u32 m0, s61, 4096
  s_add_u32 s37, s62, 4096
  buffer_load_dwordx4 v86, s[16:19], s37 offen offset:0 sc1 lds
  buffer_load_dwordx4 v[104:107], v15, s[16:19], s46 offen offset:1024 sc1
  buffer_load_dwordx4 v[108:111], v15, s[16:19], s47 offen offset:1024 sc1
  buffer_load_dwordx4 v86, s[16:19], s37 offen offset:1024 sc1 lds
  buffer_load_dwordx4 v[112:115], v15, s[16:19], s46 offen offset:1536 sc1
  buffer_load_dwordx4 v[116:119], v15, s[16:19], s47 offen offset:1536 sc1
  ds_read_b64 v[64:65], v132 offset:0
  ds_read_b64 v[66:67], v133 offset:0
  ds_read_b64 v[68:69], v132 offset:6144
  ds_read_b64 v[70:71], v133 offset:6144
  ds_read_b64 v[72:73], v134
  ds_read_b64_tr_b16 a[144:145], v140 offset:12288
  ds_read_b64_tr_b16 a[146:147], v140 offset:18432
  ds_read_b64_tr_b16 a[148:149], v141 offset:12288
  ds_read_b64_tr_b16 a[150:151], v141 offset:18432
  ds_read_b64_tr_b16 a[152:153], v142 offset:12288
  ds_read_b64_tr_b16 a[154:155], v142 offset:18432
  ds_read_b64_tr_b16 a[156:157], v140 offset:24576
  ds_read_b64_tr_b16 a[158:159], v140 offset:30720
  ds_read_b64_tr_b16 a[160:161], v141 offset:24576
  ds_read_b64_tr_b16 a[162:163], v141 offset:30720
  ds_read_b64_tr_b16 a[164:165], v142 offset:24576
  ds_read_b64_tr_b16 a[166:167], v142 offset:30720
  ds_read_b64_tr_b16 a[168:169], v140 offset:36864
  ds_read_b64_tr_b16 a[170:171], v140 offset:43008
  ds_read_b64_tr_b16 a[172:173], v141 offset:36864
  ds_read_b64_tr_b16 a[174:175], v141 offset:43008
  ds_read_b64_tr_b16 a[176:177], v142 offset:36864
  ds_read_b64_tr_b16 a[178:179], v142 offset:43008
  ds_read_b64_tr_b16 a[180:181], v140 offset:0
  ds_read_b64_tr_b16 a[182:183], v140 offset:6144
  ds_read_b64_tr_b16 a[184:185], v141 offset:0
  ds_read_b64_tr_b16 a[186:187], v141 offset:6144
  ds_read_b64_tr_b16 a[188:189], v142 offset:0
  ds_read_b64_tr_b16 a[190:191], v142 offset:6144
  ds_read_b64_tr_b16 a[192:193], v144 offset:49152
  ds_read_b64_tr_b16 a[194:195], v144 offset:55296
  ds_read_b64_tr_b16 a[196:197], v145 offset:49152
  ds_read_b64_tr_b16 a[198:199], v145 offset:55296
  ds_read_b64_tr_b16 a[200:201], v146 offset:49152
  ds_read_b64_tr_b16 a[202:203], v146 offset:55296
  ds_read_b64_tr_b16 a[204:205], v148 offset:24576
  ds_read_b64_tr_b16 a[206:207], v148 offset:30720
  ds_read_b64_tr_b16 a[208:209], v149 offset:24576
  ds_read_b64_tr_b16 a[210:211], v149 offset:30720
  ds_read_b64_tr_b16 a[212:213], v150 offset:24576
  ds_read_b64_tr_b16 a[214:215], v150 offset:30720
  s_waitcnt vmcnt(12)
  ds_read_b128 v[152:155], v76 offset:0
  ds_read_b128 v[160:163], v80 offset:0
  ds_read_b128 v[156:159], v77 offset:0
  ds_read_b128 v[164:167], v8 offset:0
  buffer_load_dwordx4 v86, s[16:19], s37 offen offset:2048 sc1 lds
  buffer_load_dwordx4 v86, s[16:19], s37 offen offset:3072 sc1 lds
  buffer_load_dwordx4 v[120:123], v15, s[16:19], s46 offen offset:2304 sc1
  buffer_load_dwordx4 v[124:127], v15, s[16:19], s47 offen offset:2304 sc1
  ds_read2_b64 v[28:31], v23 offset0:0 offset1:1
  ds_read2_b64 v[32:35], v23 offset0:9 offset1:10
  ds_read2_b64 v[36:39], v23 offset0:18 offset1:19
  ds_read2_b64 v[40:43], v23 offset0:27 offset1:28
  ds_read2_b64 v[44:47], v23 offset0:36 offset1:37
  ds_read2_b64 v[48:51], v23 offset0:45 offset1:46
  ds_read2_b64 v[52:55], v23 offset0:54 offset1:55
  ds_read2_b64 v[56:59], v23 offset0:63 offset1:64
  ds_read2_b64 v[60:63], v24 offset0:8 offset1:44
  s_waitcnt vmcnt(13)
  ds_read_b128 v[168:171], v76 offset:1536
  ds_read_b128 v[176:179], v9 offset:1536
  ds_read_b128 v[172:175], v77 offset:1536
  ds_read_b128 v[180:183], v10 offset:1536
  v_mov_b32 v24, 0
  v_mov_b32 v25, 0
  v_mov_b32 v26, 0x358637bd
  v_mov_b32 v27, 0
  s_waitcnt lgkmcnt(13)
  v_cvt_pk_bf16_f32 v184, v152, v153
  v_cvt_pk_bf16_f32 v185, v154, v155
  v_cvt_pk_bf16_f32 v186, v156, v157
  v_cvt_pk_bf16_f32 v187, v158, v159
  v_cvt_pk_bf16_f32 v188, v160, v161
  v_cvt_pk_bf16_f32 v189, v162, v163
  v_cvt_pk_bf16_f32 v190, v164, v165
  v_cvt_pk_bf16_f32 v191, v166, v167
  s_waitcnt vmcnt(9)
  ds_read_b128 v[152:155], v78 offset:3072
  ds_read_b128 v[160:163], v11 offset:3072
  ds_read_b128 v[156:159], v79 offset:3072
  ds_read_b128 v[164:167], v12 offset:3072
  s_waitcnt vmcnt(14) lgkmcnt(4)
  v_mfma_f32_16x16x32_bf16 v[204:207], v[188:191], v[88:91], v[24:27]
  v_cvt_pk_bf16_f32 v192, v168, v169
  v_cvt_pk_bf16_f32 v193, v170, v171
  v_mfma_f32_16x16x32_bf16 v[212:215], v[188:191], v[92:95], v[24:27]
  v_cvt_pk_bf16_f32 v194, v172, v173
  v_cvt_pk_bf16_f32 v195, v174, v175
  v_mfma_f32_16x16x32_bf16 v[200:203], v[184:187], v[88:91], 0
  v_cvt_pk_bf16_f32 v196, v176, v177
  v_cvt_pk_bf16_f32 v197, v178, v179
  v_mfma_f32_16x16x32_bf16 v[208:211], v[184:187], v[92:95], 0
  v_cvt_pk_bf16_f32 v198, v180, v181
  v_cvt_pk_bf16_f32 v199, v182, v183
  s_add_u32 m0, s61, 8192
  s_add_u32 s37, s62, 8192
  buffer_load_dwordx4 v86, s[16:19], s37 offen offset:0 sc1 lds
  buffer_load_dwordx4 v[128:131], v15, s[16:19], s46 offen offset:2816 sc1
  buffer_load_dwordx4 v[132:135], v15, s[16:19], s47 offen offset:2816 sc1
  s_waitcnt vmcnt(9)
  ds_read_b128 v[168:171], v78 offset:4608
  ds_read_b128 v[176:179], v13 offset:4608
  ds_read_b128 v[172:175], v79 offset:4608
  ds_read_b128 v[180:183], v14 offset:4608
  s_waitcnt vmcnt(14) lgkmcnt(4)
  v_mfma_f32_16x16x32_bf16 v[220:223], v[196:199], v[96:99], v[24:27]
  v_cvt_pk_bf16_f32 v184, v152, v153
  v_cvt_pk_bf16_f32 v185, v154, v155
  v_mfma_f32_16x16x32_bf16 v[228:231], v[196:199], v[100:103], v[24:27]
  v_cvt_pk_bf16_f32 v186, v156, v157
  v_cvt_pk_bf16_f32 v187, v158, v159
  v_mfma_f32_16x16x32_bf16 v[216:219], v[192:195], v[96:99], 0
  v_cvt_pk_bf16_f32 v188, v160, v161
  v_cvt_pk_bf16_f32 v189, v162, v163
  v_mfma_f32_16x16x32_bf16 v[224:227], v[192:195], v[100:103], 0
  v_cvt_pk_bf16_f32 v190, v164, v165
  v_cvt_pk_bf16_f32 v191, v166, v167
  v_rcp_f32 v16, v206
  v_rcp_f32 v18, v214
  s_nop 0
  v_pk_mul_f32 v[200:201], v[200:201], v[16:17] op_sel_hi:[1,0]
  v_pk_mul_f32 v[202:203], v[202:203], v[16:17] op_sel_hi:[1,0]
  v_pk_fma_f32 v[240:241], v[204:205], v[16:17], v[240:241] op_sel_hi:[1,0,1]
  v_pk_mul_f32 v[208:209], v[208:209], v[18:19] op_sel_hi:[1,0]
  v_pk_mul_f32 v[210:211], v[210:211], v[18:19] op_sel_hi:[1,0]
  v_pk_fma_f32 v[244:245], v[212:213], v[18:19], v[244:245] op_sel_hi:[1,0,1]
  v_pk_fma_f32 v[248:249], v[200:201], v[28:29], v[248:249]
  v_pk_fma_f32 v[248:249], v[202:203], v[30:31], v[248:249]
  v_cvt_pk_bf16_f32 v232, v200, v201
  v_cvt_pk_bf16_f32 v233, v202, v203
  v_pk_fma_f32 v[250:251], v[208:209], v[28:29], v[250:251]
  v_pk_fma_f32 v[250:251], v[210:211], v[30:31], v[250:251]
  v_cvt_pk_bf16_f32 v236, v208, v209
  v_cvt_pk_bf16_f32 v237, v210, v211
  buffer_load_dwordx4 v86, s[16:19], s37 offen offset:1024 sc1 lds
  buffer_load_dwordx4 v86, s[16:19], s37 offen offset:2048 sc1 lds
  buffer_load_dwordx4 v[136:139], v15, s[16:19], s46 offen offset:3328 sc1
  buffer_load_dwordx4 v[140:143], v15, s[16:19], s47 offen offset:3328 sc1
  s_waitcnt vmcnt(9)
  ds_read_b128 v[152:155], v76 offset:6144
  ds_read_b128 v[160:163], v80 offset:6144
  ds_read_b128 v[156:159], v77 offset:6144
  ds_read_b128 v[164:167], v8 offset:6144
  s_waitcnt vmcnt(14) lgkmcnt(4)
  v_mfma_f32_16x16x32_bf16 v[204:207], v[188:191], v[104:107], v[24:27]
  v_cvt_pk_bf16_f32 v192, v168, v169
  v_cvt_pk_bf16_f32 v193, v170, v171
  v_mfma_f32_16x16x32_bf16 v[212:215], v[188:191], v[108:111], v[24:27]
  v_cvt_pk_bf16_f32 v194, v172, v173
  v_cvt_pk_bf16_f32 v195, v174, v175
  v_mfma_f32_16x16x32_bf16 v[200:203], v[184:187], v[104:107], 0
  v_cvt_pk_bf16_f32 v196, v176, v177
  v_cvt_pk_bf16_f32 v197, v178, v179
  v_mfma_f32_16x16x32_bf16 v[208:211], v[184:187], v[108:111], 0
  v_cvt_pk_bf16_f32 v198, v180, v181
  v_cvt_pk_bf16_f32 v199, v182, v183
  v_rcp_f32 v16, v222
  v_rcp_f32 v18, v230
  s_nop 0
  v_pk_mul_f32 v[216:217], v[216:217], v[16:17] op_sel_hi:[1,0]
  v_pk_mul_f32 v[218:219], v[218:219], v[16:17] op_sel_hi:[1,0]
  v_pk_fma_f32 v[240:241], v[220:221], v[16:17], v[240:241] op_sel_hi:[1,0,1]
  v_pk_mul_f32 v[224:225], v[224:225], v[18:19] op_sel_hi:[1,0]
  v_pk_mul_f32 v[226:227], v[226:227], v[18:19] op_sel_hi:[1,0]
  v_pk_fma_f32 v[244:245], v[228:229], v[18:19], v[244:245] op_sel_hi:[1,0,1]
  v_pk_fma_f32 v[248:249], v[216:217], v[32:33], v[248:249]
  v_pk_fma_f32 v[248:249], v[218:219], v[34:35], v[248:249]
  v_cvt_pk_bf16_f32 v234, v216, v217
  v_cvt_pk_bf16_f32 v235, v218, v219
  v_pk_fma_f32 v[250:251], v[224:225], v[32:33], v[250:251]
  v_pk_fma_f32 v[250:251], v[226:227], v[34:35], v[250:251]
  v_cvt_pk_bf16_f32 v238, v224, v225
  v_cvt_pk_bf16_f32 v239, v226, v227
  s_barrier
  ds_write_b128 v82, v[232:235] offset:0
  ds_write_b128 v82, v[236:239] offset:1024
  buffer_load_dwordx4 v86, s[16:19], s37 offen offset:3072 sc1 lds
  buffer_load_dwordx4 v[144:147], v15, s[16:19], s46 offen offset:3840 sc1
  buffer_load_dwordx4 v[148:151], v15, s[16:19], s47 offen offset:3840 sc1
  buffer_load_dword v74, v75, s[16:19], 0 offen offset:0 sc1
  buffer_load_dword v75, v75, s[16:19], 0 offen offset:64 sc1
  s_lshl_b32 s101, s26, 2
  s_add_u32 s101, s101, s24
  s_mul_i32 s101, s101, 384
  s_add_u32 s101, s101, L_s2_go-L_pcbase
  v_min_u32 v254, 2, v1
  v_lshl_add_u32 v254, v254, 7, s101
  v_min_u32 v254, L_end-L_pcbase, v254
  global_load_dword v255, v254, s[0:1] sc1
  buffer_load_dword v255, v6, s[72:75], s63 offen offset:0 nt
  buffer_load_dword v255, v6, s[72:75], s63 offen offset:128 nt
  buffer_load_dword v255, v6, s[72:75], s63 offen offset:0 sc1
  buffer_load_dword v255, v6, s[72:75], s63 offen offset:128 sc1
  s_waitcnt vmcnt(16)
  ds_read_b128 v[168:171], v76 offset:7680
  ds_read_b128 v[176:179], v9 offset:7680
  ds_read_b128 v[172:175], v77 offset:7680
  ds_read_b128 v[180:183], v10 offset:7680
  s_waitcnt vmcnt(21) lgkmcnt(6)
  v_mfma_f32_16x16x32_bf16 v[220:223], v[196:199], v[112:115], v[24:27]
  v_cvt_pk_bf16_f32 v184, v152, v153
  v_cvt_pk_bf16_f32 v185, v154, v155
  v_mfma_f32_16x16x32_bf16 v[228:231], v[196:199], v[116:119], v[24:27]
  v_cvt_pk_bf16_f32 v186, v156, v157
  v_cvt_pk_bf16_f32 v187, v158, v159
  v_mfma_f32_16x16x32_bf16 v[216:219], v[192:195], v[112:115], 0
  v_cvt_pk_bf16_f32 v188, v160, v161
  v_cvt_pk_bf16_f32 v189, v162, v163
  v_mfma_f32_16x16x32_bf16 v[224:227], v[192:195], v[116:119], 0
  v_cvt_pk_bf16_f32 v190, v164, v165
  v_cvt_pk_bf16_f32 v191, v166, v167
  v_rcp_f32 v16, v206
  v_rcp_f32 v18, v214
  s_nop 0
  v_pk_mul_f32 v[200:201], v[200:201], v[16:17] op_sel_hi:[1,0]
  v_pk_mul_f32 v[202:203], v[202:203], v[16:17] op_sel_hi:[1,0]
  v_pk_fma_f32 v[240:241], v[204:205], v[16:17], v[240:241] op_sel_hi:[1,0,1]
  v_pk_mul_f32 v[208:209], v[208:209], v[18:19] op_sel_hi:[1,0]
  v_pk_mul_f32 v[210:211], v[210:211], v[18:19] op_sel_hi:[1,0]
  v_pk_fma_f32 v[244:245], v[212:213], v[18:19], v[244:245] op_sel_hi:[1,0,1]
  v_pk_fma_f32 v[248:249], v[200:201], v[36:37], v[248:249]
  v_pk_fma_f32 v[248:249], v[202:203], v[38:39], v[248:249]
  v_cvt_pk_bf16_f32 v232, v200, v201
  v_cvt_pk_bf16_f32 v233, v202, v203
  v_pk_fma_f32 v[250:251], v[208:209], v[36:37], v[250:251]
  v_pk_fma_f32 v[250:251], v[210:211], v[38:39], v[250:251]
  v_cvt_pk_bf16_f32 v236, v208, v209
  v_cvt_pk_bf16_f32 v237, v210, v211
  s_waitcnt vmcnt(12)
  ds_read_b128 v[152:155], v78 offset:9216
  ds_read_b128 v[160:163], v11 offset:9216
  ds_read_b128 v[156:159], v79 offset:9216
  ds_read_b128 v[164:167], v12 offset:9216
  s_waitcnt vmcnt(17) lgkmcnt(4)
  v_mfma_f32_16x16x32_bf16 v[204:207], v[188:191], v[120:123], v[24:27]
  v_cvt_pk_bf16_f32 v192, v168, v169
  v_cvt_pk_bf16_f32 v193, v170, v171
  v_mfma_f32_16x16x32_bf16 v[212:215], v[188:191], v[124:127], v[24:27]
  v_cvt_pk_bf16_f32 v194, v172, v173
  v_cvt_pk_bf16_f32 v195, v174, v175
  v_mfma_f32_16x16x32_bf16 v[200:203], v[184:187], v[120:123], 0
  v_cvt_pk_bf16_f32 v196, v176, v177
  v_cvt_pk_bf16_f32 v197, v178, v179
  v_mfma_f32_16x16x32_bf16 v[208:211], v[184:187], v[124:127], 0
  v_cvt_pk_bf16_f32 v198, v180, v181
  v_cvt_pk_bf16_f32 v199, v182, v183
  v_rcp_f32 v16, v222
  v_rcp_f32 v18, v230
  s_nop 0
  v_pk_mul_f32 v[216:217], v[216:217], v[16:17] op_sel_hi:[1,0]
  v_pk_mul_f32 v[218:219], v[218:219], v[16:17] op_sel_hi:[1,0]
  v_pk_fma_f32 v[240:241], v[220:221], v[16:17], v[240:241] op_sel_hi:[1,0,1]
  v_pk_mul_f32 v[224:225], v[224:225], v[18:19] op_sel_hi:[1,0]
  v_pk_mul_f32 v[226:227], v[226:227], v[18:19] op_sel_hi:[1,0]
  v_pk_fma_f32 v[244:245], v[228:229], v[18:19], v[244:245] op_sel_hi:[1,0,1]
  v_pk_fma_f32 v[248:249], v[216:217], v[40:41], v[248:249]
  v_pk_fma_f32 v[248:249], v[218:219], v[42:43], v[248:249]
  v_cvt_pk_bf16_f32 v234, v216, v217
  v_cvt_pk_bf16_f32 v235, v218, v219
  v_pk_fma_f32 v[250:251], v[224:225], v[40:41], v[250:251]
  v_pk_fma_f32 v[250:251], v[226:227], v[42:43], v[250:251]
  v_cvt_pk_bf16_f32 v238, v224, v225
  v_cvt_pk_bf16_f32 v239, v226, v227
  ds_write_b128 v82, v[232:235] offset:2048
  ds_write_b128 v82, v[236:239] offset:3072
  s_waitcnt vmcnt(9)
  ds_read_b128 v[168:171], v78 offset:10752
  ds_read_b128 v[176:179], v13 offset:10752
  ds_read_b128 v[172:175], v79 offset:10752
  ds_read_b128 v[180:183], v14 offset:10752
  s_waitcnt vmcnt(14) lgkmcnt(6)
  v_mfma_f32_16x16x32_bf16 v[220:223], v[196:199], v[128:131], v[24:27]
  v_cvt_pk_bf16_f32 v184, v152, v153
  v_cvt_pk_bf16_f32 v185, v154, v155
  v_mfma_f32_16x16x32_bf16 v[228:231], v[196:199], v[132:135], v[24:27]
  v_cvt_pk_bf16_f32 v186, v156, v157
  v_cvt_pk_bf16_f32 v187, v158, v159
  v_mfma_f32_16x16x32_bf16 v[216:219], v[192:195], v[128:131], 0
  v_cvt_pk_bf16_f32 v188, v160, v161
  v_cvt_pk_bf16_f32 v189, v162, v163
  v_mfma_f32_16x16x32_bf16 v[224:227], v[192:195], v[132:135], 0
  v_cvt_pk_bf16_f32 v190, v164, v165
  v_cvt_pk_bf16_f32 v191, v166, v167
  v_rcp_f32 v16, v206
  v_rcp_f32 v18, v214
  s_nop 0
  v_pk_mul_f32 v[200:201], v[200:201], v[16:17] op_sel_hi:[1,0]
  v_pk_mul_f32 v[202:203], v[202:203], v[16:17] op_sel_hi:[1,0]
  v_pk_fma_f32 v[242:243], v[204:205], v[16:17], v[242:243] op_sel_hi:[1,0,1]
  v_pk_mul_f32 v[208:209], v[208:209], v[18:19] op_sel_hi:[1,0]
  v_pk_mul_f32 v[210:211], v[210:211], v[18:19] op_sel_hi:[1,0]
  v_pk_fma_f32 v[246:247], v[212:213], v[18:19], v[246:247] op_sel_hi:[1,0,1]
  v_pk_fma_f32 v[248:249], v[200:201], v[44:45], v[248:249]
  v_pk_fma_f32 v[248:249], v[202:203], v[46:47], v[248:249]
  v_cvt_pk_bf16_f32 v232, v200, v201
  v_cvt_pk_bf16_f32 v233, v202, v203
  v_pk_fma_f32 v[250:251], v[208:209], v[44:45], v[250:251]
  v_pk_fma_f32 v[250:251], v[210:211], v[46:47], v[250:251]
  v_cvt_pk_bf16_f32 v236, v208, v209
  v_cvt_pk_bf16_f32 v237, v210, v211
  s_waitcnt vmcnt(10) lgkmcnt(0)
  v_mfma_f32_16x16x32_bf16 v[204:207], v[188:191], v[136:139], v[24:27]
  v_cvt_pk_bf16_f32 v192, v168, v169
  v_cvt_pk_bf16_f32 v193, v170, v171
  v_mfma_f32_16x16x32_bf16 v[212:215], v[188:191], v[140:143], v[24:27]
  v_cvt_pk_bf16_f32 v194, v172, v173
  v_cvt_pk_bf16_f32 v195, v174, v175
  v_mfma_f32_16x16x32_bf16 v[200:203], v[184:187], v[136:139], 0
  v_cvt_pk_bf16_f32 v196, v176, v177
  v_cvt_pk_bf16_f32 v197, v178, v179
  v_mfma_f32_16x16x32_bf16 v[208:211], v[184:187], v[140:143], 0
  v_cvt_pk_bf16_f32 v198, v180, v181
  v_cvt_pk_bf16_f32 v199, v182, v183
  v_rcp_f32 v16, v222
  v_rcp_f32 v18, v230
  s_nop 0
  v_pk_mul_f32 v[216:217], v[216:217], v[16:17] op_sel_hi:[1,0]
  v_pk_mul_f32 v[218:219], v[218:219], v[16:17] op_sel_hi:[1,0]
  v_pk_fma_f32 v[242:243], v[220:221], v[16:17], v[242:243] op_sel_hi:[1,0,1]
  v_pk_mul_f32 v[224:225], v[224:225], v[18:19] op_sel_hi:[1,0]
  v_pk_mul_f32 v[226:227], v[226:227], v[18:19] op_sel_hi:[1,0]
  v_pk_fma_f32 v[246:247], v[228:229], v[18:19], v[246:247] op_sel_hi:[1,0,1]
  v_pk_fma_f32 v[248:249], v[216:217], v[48:49], v[248:249]
  v_pk_fma_f32 v[248:249], v[218:219], v[50:51], v[248:249]
  v_cvt_pk_bf16_f32 v234, v216, v217
  v_cvt_pk_bf16_f32 v235, v218, v219
  v_pk_fma_f32 v[250:251], v[224:225], v[48:49], v[250:251]
  v_pk_fma_f32 v[250:251], v[226:227], v[50:51], v[250:251]
  v_cvt_pk_bf16_f32 v238, v224, v225
  v_cvt_pk_bf16_f32 v239, v226, v227
  ds_write_b128 v82, v[232:235] offset:4096
  ds_write_b128 v82, v[236:239] offset:5120
  s_waitcnt vmcnt(7)
  v_mfma_f32_16x16x32_bf16 v[220:223], v[196:199], v[144:147], v[24:27]
  v_mfma_f32_16x16x32_bf16 v[228:231], v[196:199], v[148:151], v[24:27]
  v_mfma_f32_16x16x32_bf16 v[216:219], v[192:195], v[144:147], 0
  v_mfma_f32_16x16x32_bf16 v[224:227], v[192:195], v[148:151], 0
  v_rcp_f32 v16, v206
  v_rcp_f32 v18, v214
  s_nop 0
  v_pk_mul_f32 v[200:201], v[200:201], v[16:17] op_sel_hi:[1,0]
  v_pk_mul_f32 v[202:203], v[202:203], v[16:17] op_sel_hi:[1,0]
  v_pk_fma_f32 v[242:243], v[204:205], v[16:17], v[242:243] op_sel_hi:[1,0,1]
  v_pk_mul_f32 v[208:209], v[208:209], v[18:19] op_sel_hi:[1,0]
  v_pk_mul_f32 v[210:211], v[210:211], v[18:19] op_sel_hi:[1,0]
  v_pk_fma_f32 v[246:247], v[212:213], v[18:19], v[246:247] op_sel_hi:[1,0,1]
  v_pk_fma_f32 v[248:249], v[200:201], v[52:53], v[248:249]
  v_pk_fma_f32 v[248:249], v[202:203], v[54:55], v[248:249]
  v_cvt_pk_bf16_f32 v232, v200, v201
  v_cvt_pk_bf16_f32 v233, v202, v203
  v_pk_fma_f32 v[250:251], v[208:209], v[52:53], v[250:251]
  v_pk_fma_f32 v[250:251], v[210:211], v[54:55], v[250:251]
  v_cvt_pk_bf16_f32 v236, v208, v209
  v_cvt_pk_bf16_f32 v237, v210, v211
  s_nop 3
  v_rcp_f32 v16, v222
  v_rcp_f32 v18, v230
  s_nop 0
  v_pk_mul_f32 v[216:217], v[216:217], v[16:17] op_sel_hi:[1,0]
  v_pk_mul_f32 v[218:219], v[218:219], v[16:17] op_sel_hi:[1,0]
  v_pk_fma_f32 v[242:243], v[220:221], v[16:17], v[242:243] op_sel_hi:[1,0,1]
  v_pk_mul_f32 v[224:225], v[224:225], v[18:19] op_sel_hi:[1,0]
  v_pk_mul_f32 v[226:227], v[226:227], v[18:19] op_sel_hi:[1,0]
  v_pk_fma_f32 v[246:247], v[228:229], v[18:19], v[246:247] op_sel_hi:[1,0,1]
  v_pk_fma_f32 v[248:249], v[216:217], v[56:57], v[248:249]
  v_pk_fma_f32 v[248:249], v[218:219], v[58:59], v[248:249]
  v_cvt_pk_bf16_f32 v234, v216, v217
  v_cvt_pk_bf16_f32 v235, v218, v219
  v_pk_fma_f32 v[250:251], v[224:225], v[56:57], v[250:251]
  v_pk_fma_f32 v[250:251], v[226:227], v[58:59], v[250:251]
  v_cvt_pk_bf16_f32 v238, v224, v225
  v_cvt_pk_bf16_f32 v239, v226, v227
  ds_write_b128 v82, v[232:235] offset:6144
  ds_write_b128 v82, v[236:239] offset:7168
  v_pk_fma_f32 v[248:249], v[240:241], v[60:61], v[248:249]
  v_pk_fma_f32 v[248:249], v[242:243], v[62:63], v[248:249]
  v_cvt_pk_bf16_f32 v232, v240, v241
  v_cvt_pk_bf16_f32 v233, v242, v243
  ds_write_b64 v83, v[232:233] offset:0
  v_add_f32 v248, v248, v249
  v_pk_fma_f32 v[250:251], v[244:245], v[60:61], v[250:251]
  v_pk_fma_f32 v[250:251], v[246:247], v[62:63], v[250:251]
  v_cvt_pk_bf16_f32 v236, v244, v245
  v_cvt_pk_bf16_f32 v237, v246, v247
  ds_write_b64 v83, v[236:237] offset:1024
  v_add_f32 v250, v250, v251
  s_nop 1
  v_permlane16_swap_b32 v248, v250
  v_add_f32 v248, v248, v250
  v_mov_b32 v250, v248
  s_nop 1
  v_permlane32_swap_b32 v250, v248
  v_add_f32 v248, v248, v250
  ds_write_b32 v85, v248
  s_waitcnt lgkmcnt(0)
  s_barrier
  ds_read_b128 v[88:91], v81 offset:0
  ds_read_b128 v[92:95], v81 offset:1024
  ds_read_b128 v[28:31], v7 offset:0
  ds_read_b128 v[96:99], v81 offset:2048
  ds_read_b128 v[100:103], v81 offset:3072
  ds_read_b128 v[32:35], v7 offset:2048
  ds_read_b128 v[104:107], v81 offset:4096
  ds_read_b128 v[108:111], v81 offset:5120
  ds_read_b128 v[36:39], v7 offset:4096
  ds_read_b128 v[44:47], v84 offset:0
  ds_read_b128 v[48:51], v84 offset:256
  s_waitcnt lgkmcnt(8)
  v_mfma_f32_16x16x32_bf16 v[232:235], a[0:3], v[88:91], 0
  ds_read_b128 v[112:115], v81 offset:6144
  s_cmp_ge_u32 s24, 2
  s_cselect_b32 s60, 0x7f000000, 0
  v_mfma_f32_16x16x32_bf16 v[236:239], a[4:7], v[88:91], 0
  ds_read_b128 v[116:119], v81 offset:7168
  v_lshl_add_u32 v87, v1, 3, s60
  v_mfma_f32_16x16x32_bf16 v[240:243], a[0:3], v[92:95], 0
  ds_read_b128 v[40:43], v7 offset:6144
  s_mov_b32 s54, 0xffff0000
  v_mfma_f32_16x16x32_bf16 v[244:247], a[4:7], v[92:95], 0
  s_lshr_b32 s38, s27, 1
  s_mul_i32 s38, s38, 73728
  v_mfma_f32_16x16x32_bf16 v[248:251], a[8:11], v[28:31], 0
  s_waitcnt lgkmcnt(8)
  s_and_b32 s39, s27, 1
  s_lshl_b32 s39, s39, 11
  v_mfma_f32_16x16x32_bf16 v[232:235], a[12:15], v[96:99], v[232:235]
  ds_read_b128 v[120:123], v81 offset:8192
  s_add_u32 s38, s38, s39
  v_mfma_f32_16x16x32_bf16 v[236:239], a[16:19], v[96:99], v[236:239]
  ds_read_b128 v[124:127], v81 offset:9216
  s_mul_i32 s39, s28, 9
  v_mfma_f32_16x16x32_bf16 v[240:243], a[12:15], v[100:103], v[240:243]
  ds_read_b128 v[28:31], v7 offset:8192
  s_add_u32 s52, s39, s34
  v_mfma_f32_16x16x32_bf16 v[244:247], a[16:19], v[100:103], v[244:247]
  s_lshr_b32 s52, s52, 1
  s_lshl_b32 s52, s52, 12
  v_mfma_f32_16x16x32_bf16 v[248:251], a[20:23], v[32:35], v[248:251]
  s_waitcnt lgkmcnt(8)
  s_add_u32 s52, s52, s38
  s_add_u32 s53, s39, s58
  v_mfma_f32_16x16x32_bf16 v[232:235], a[24:27], v[104:107], v[232:235]
  ds_read_b128 v[128:131], v81 offset:10240
  s_lshr_b32 s53, s53, 1
  v_mfma_f32_16x16x32_bf16 v[236:239], a[28:31], v[104:107], v[236:239]
  ds_read_b128 v[132:135], v81 offset:11264
  s_lshl_b32 s53, s53, 12
  v_mfma_f32_16x16x32_bf16 v[240:243], a[24:27], v[108:111], v[240:243]
  ds_read_b128 v[32:35], v7 offset:10240
  s_add_u32 s53, s53, s38
  v_mfma_f32_16x16x32_bf16 v[244:247], a[28:31], v[108:111], v[244:247]
  s_lshl_b32 s39, s59, 10
  s_add_u32 s53, s53, s39
  v_mfma_f32_16x16x32_bf16 v[248:251], a[32:35], v[36:39], v[248:251]
  s_waitcnt lgkmcnt(6)
  s_lshl_b32 s39, s29, 9
  s_add_u32 s53, s53, s39
  v_mfma_f32_16x16x32_bf16 v[232:235], a[36:39], v[112:115], v[232:235]
  ds_read_b128 v[136:139], v81 offset:12288
  s_mul_i32 s32, s25, 576
  v_mfma_f32_16x16x32_bf16 v[236:239], a[40:43], v[112:115], v[236:239]
  ds_read_b128 v[140:143], v81 offset:13312
  s_bfe_u32 s38, s2, 0x10003
  v_mfma_f32_16x16x32_bf16 v[240:243], a[36:39], v[116:119], v[240:243]
  ds_read_b128 v[36:39], v7 offset:12288
  s_lshl_b32 s38, s38, 8
  v_mfma_f32_16x16x32_bf16 v[244:247], a[40:43], v[116:119], v[244:247]
  s_add_u32 s32, s32, s38
  s_lshl_b32 s32, s32, 1
  v_mfma_f32_16x16x32_bf16 v[248:251], a[44:47], v[40:43], v[248:251]
  s_waitcnt lgkmcnt(6)
  s_mul_i32 s31, s24, 3072
  v_lshrrev_b32 v8, 3, v1
  s_waitcnt vmcnt(5)
  v_mfma_f32_16x16x32_bf16 v[232:235], a[48:51], v[120:123], v[232:235]
  ds_read_b128 v[144:147], v81 offset:14336
  s_lshl_b32 s38, s24, 3
  v_mfma_f32_16x16x32_bf16 v[236:239], a[52:55], v[120:123], v[236:239]
  ds_read_b128 v[148:151], v81 offset:15360
  v_add_u32 v8, s38, v8
  v_mfma_f32_16x16x32_bf16 v[240:243], a[48:51], v[124:127], v[240:243]
  ds_read_b128 v[40:43], v7 offset:14336
  v_lshrrev_b32 v9, 4, v1
  v_mfma_f32_16x16x32_bf16 v[244:247], a[52:55], v[124:127], v[244:247]
  v_lshlrev_b32 v9, 1, v9
  v_and_b32 v10, 7, v1
  v_mfma_f32_16x16x32_bf16 v[248:251], a[56:59], v[28:31], v[248:251]
  s_waitcnt lgkmcnt(6)
  v_xor_b32 v9, v9, v10
  v_mul_u32_u24 v10, 9216, v8
  v_mfma_f32_16x16x32_bf16 v[232:235], a[60:63], v[128:131], v[232:235]
  ds_read_b128 v[152:155], v81 offset:16384
  v_lshl_add_u32 v2, v9, 4, v10
  v_mfma_f32_16x16x32_bf16 v[236:239], a[64:67], v[128:131], v[236:239]
  ds_read_b128 v[156:159], v81 offset:17408
  v_add_u32 v3, 293888, v2
  v_mfma_f32_16x16x32_bf16 v[240:243], a[60:63], v[132:135], v[240:243]
  ds_read_b128 v[28:31], v7 offset:16384
  v_add_u32 v4, 587776, v2
  v_mfma_f32_16x16x32_bf16 v[244:247], a[64:67], v[132:135], v[244:247]
  v_add_f32 v44, v44, v45
  v_add_f32 v46, v46, v47
  v_mfma_f32_16x16x32_bf16 v[248:251], a[68:71], v[32:35], v[248:251]
  s_waitcnt lgkmcnt(6)
  v_add_f32 v44, v44, v46
  v_fmac_f32 v74, 0x3ae38e39, v44
  v_mfma_f32_16x16x32_bf16 v[232:235], a[72:75], v[136:139], v[232:235]
L_wu_s1_0:
L_st_8000:
  s_cbranch_execz L_wuret_s1
  ds_read_b128 v[160:163], v81 offset:18432
  v_cvt_pk_bf16_f32 v44, v74, v74
  v_mfma_f32_16x16x32_bf16 v[236:239], a[76:79], v[136:139], v[236:239]
  ds_read_b128 v[164:167], v81 offset:19456
  v_lshlrev_b32 v44, 16, v44
  v_mfma_f32_16x16x32_bf16 v[240:243], a[72:75], v[140:143], v[240:243]
  ds_read_b128 v[32:35], v7 offset:18432
  v_sub_f32 v45, v74, v44
  v_mfma_f32_16x16x32_bf16 v[244:247], a[76:79], v[140:143], v[244:247]
  v_mov_b32 v74, v44
  v_mul_f32 v45, v45, v45
  v_mfma_f32_16x16x32_bf16 v[248:251], a[80:83], v[36:39], v[248:251]
  s_waitcnt lgkmcnt(6)
  v_mul_f32 v46, 0xc1100000, v45
  v_mov_b32 v47, 0
  v_mfma_f32_16x16x32_bf16 v[232:235], a[84:87], v[144:147], v[232:235]
  ds_read_b128 v[168:171], v81 offset:20480
  v_add_f32 v48, v48, v49
  v_mfma_f32_16x16x32_bf16 v[236:239], a[88:91], v[144:147], v[236:239]
  ds_read_b128 v[172:175], v81 offset:21504
  v_add_f32 v50, v50, v51
  v_mfma_f32_16x16x32_bf16 v[240:243], a[84:87], v[148:151], v[240:243]
  ds_read_b128 v[36:39], v7 offset:20480
  v_add_f32 v48, v48, v50
  v_mfma_f32_16x16x32_bf16 v[244:247], a[88:91], v[148:151], v[244:247]
  v_fmac_f32 v75, 0x3ae38e39, v48
  v_cvt_pk_bf16_f32 v48, v75, v75
  v_mfma_f32_16x16x32_bf16 v[248:251], a[92:95], v[40:43], v[248:251]
  s_waitcnt lgkmcnt(6)
  v_lshlrev_b32 v48, 16, v48
  v_sub_f32 v49, v75, v48
  v_mfma_f32_16x16x32_bf16 v[232:235], a[96:99], v[152:155], v[232:235]
  ds_read_b128 v[176:179], v81 offset:22528
  v_mov_b32 v75, v48
  v_mfma_f32_16x16x32_bf16 v[236:239], a[100:103], v[152:155], v[236:239]
  ds_read_b128 v[180:183], v81 offset:23552
  v_mul_f32 v49, v49, v49
  v_mfma_f32_16x16x32_bf16 v[240:243], a[96:99], v[156:159], v[240:243]
  ds_read_b128 v[40:43], v7 offset:22528
  v_mul_f32 v50, 0xc1100000, v49
  v_mfma_f32_16x16x32_bf16 v[244:247], a[100:103], v[156:159], v[244:247]
  v_mov_b32 v51, 0
  s_cmp_eq_u32 s59, 0
  s_cselect_b64 vcc, -1, 0
  v_cndmask_b32 v21, v75, v74, vcc
  v_mfma_f32_16x16x32_bf16 v[248:251], a[104:107], v[28:31], v[248:251]
  s_waitcnt lgkmcnt(6)
  v_lshlrev_b32 v88, 16, v64
  v_and_b32 v89, s54, v64
  v_mfma_f32_16x16x32_bf16 v[232:235], a[108:111], v[160:163], v[232:235]
  ds_read_b128 v[184:187], v81 offset:24576
  v_lshlrev_b32 v90, 16, v65
  v_mfma_f32_16x16x32_bf16 v[236:239], a[112:115], v[160:163], v[236:239]
  ds_read_b128 v[188:191], v81 offset:25600
  v_and_b32 v91, s54, v65
  v_mfma_f32_16x16x32_bf16 v[240:243], a[108:111], v[164:167], v[240:243]
  ds_read_b128 v[28:31], v7 offset:24576
  v_lshlrev_b32 v92, 16, v66
  v_mfma_f32_16x16x32_bf16 v[244:247], a[112:115], v[164:167], v[244:247]
  v_and_b32 v93, s54, v66
  v_lshlrev_b32 v94, 16, v67
  v_mfma_f32_16x16x32_bf16 v[248:251], a[116:119], v[32:35], v[248:251]
  s_waitcnt lgkmcnt(6)
  v_and_b32 v95, s54, v67
  v_lshlrev_b32 v96, 16, v68
  v_mfma_f32_16x16x32_bf16 v[232:235], a[120:123], v[168:171], v[232:235]
  ds_read_b128 v[192:195], v81 offset:26624
  v_and_b32 v97, s54, v68
  v_mfma_f32_16x16x32_bf16 v[236:239], a[124:127], v[168:171], v[236:239]
  ds_read_b128 v[196:199], v81 offset:27648
  v_lshlrev_b32 v98, 16, v69
  v_mfma_f32_16x16x32_bf16 v[240:243], a[120:123], v[172:175], v[240:243]
  ds_read_b128 v[32:35], v7 offset:26624
  v_and_b32 v99, s54, v69
  v_mfma_f32_16x16x32_bf16 v[244:247], a[124:127], v[172:175], v[244:247]
  v_lshlrev_b32 v100, 16, v70
  v_and_b32 v101, s54, v70
  v_mfma_f32_16x16x32_bf16 v[248:251], a[128:131], v[36:39], v[248:251]
  s_waitcnt lgkmcnt(6)
  v_lshlrev_b32 v102, 16, v71
  v_and_b32 v103, s54, v71
  v_mfma_f32_16x16x32_bf16 v[232:235], a[132:135], v[176:179], v[232:235]
  ds_read_b128 v[200:203], v81 offset:28672
  v_lshlrev_b32 v104, 16, v72
  v_mfma_f32_16x16x32_bf16 v[236:239], a[136:139], v[176:179], v[236:239]
  ds_read_b128 v[204:207], v81 offset:29696
  v_and_b32 v105, s54, v72
  v_mfma_f32_16x16x32_bf16 v[240:243], a[132:135], v[180:183], v[240:243]
  ds_read_b128 v[36:39], v7 offset:28672
  v_lshlrev_b32 v106, 16, v73
  v_mfma_f32_16x16x32_bf16 v[244:247], a[136:139], v[180:183], v[244:247]
  v_and_b32 v107, s54, v73
  s_add_u32 s56, s52, 2621440
  s_add_u32 s57, s52, 5242880
  v_mfma_f32_16x16x32_bf16 v[248:251], a[140:143], v[40:43], v[248:251]
  s_waitcnt lgkmcnt(6)
  s_add_u32 s52, s53, 2621440
  s_add_u32 s53, s53, 5242880
  v_mfma_f32_16x16x32_bf16 v[232:235], a[144:147], v[184:187], v[232:235]
  ds_read_b128 v[208:211], v81 offset:30720
  s_lshl_b32 s38, s28, 2
  s_add_u32 s38, s38, s24
  s_lshl_b32 s38, s38, 13
  v_mfma_f32_16x16x32_bf16 v[236:239], a[148:151], v[184:187], v[236:239]
  ds_read_b128 v[212:215], v81 offset:31744
  s_lshl_b32 s39, s27, 7
  s_add_u32 s38, s38, s39
  s_add_u32 s65, s38, 7733248
  v_mfma_f32_16x16x32_bf16 v[240:243], a[144:147], v[188:191], v[240:243]
  ds_read_b128 v[40:43], v7 offset:30720
  v_cmp_gt_u32 vcc, 32, v1
  v_mfma_f32_16x16x32_bf16 v[244:247], a[148:151], v[188:191], v[244:247]
  s_add_u32 m0, s31, 0
  s_add_u32 s35, s32, 0
  buffer_load_dwordx4 v2, s[4:7], s35 offen offset:0 lds
  v_mov_b32 v19, 0x7f000000
  v_mfma_f32_16x16x32_bf16 v[248:251], a[152:155], v[28:31], v[248:251]
  s_waitcnt lgkmcnt(6)
  v_lshlrev_b32 v17, 2, v1
  v_cndmask_b32 v17, v19, v17, vcc
  v_mfma_f32_16x16x32_bf16 v[232:235], a[156:159], v[192:195], v[232:235]
  ds_read_b128 v[216:219], v81 offset:32768
  v_cmp_eq_u32 vcc, 0, v0
  v_mfma_f32_16x16x32_bf16 v[236:239], a[160:163], v[192:195], v[236:239]
  ds_read_b128 v[220:223], v81 offset:33792
  s_lshr_b32 s39, s27, 2
  s_lshl_b32 s39, s39, 8
  s_add_u32 s64, s39, 7925760
  v_mfma_f32_16x16x32_bf16 v[240:243], a[156:159], v[196:199], v[240:243]
  ds_read_b128 v[28:31], v7 offset:32768
  v_cndmask_b32 v252, v19, 0, vcc
  v_mfma_f32_16x16x32_bf16 v[244:247], a[160:163], v[196:199], v[244:247]
  buffer_load_dwordx4 v3, s[4:7], s35 offen offset:1024 lds
  v_mov_b32 v253, 1
  v_mfma_f32_16x16x32_bf16 v[248:251], a[164:167], v[32:35], v[248:251]
  s_waitcnt lgkmcnt(6)
  s_cmp_eq_u32 s24, 0
  s_cselect_b32 s66, 1.0, 0
  v_mfma_f32_16x16x32_bf16 v[232:235], a[168:171], v[200:203], v[232:235]
  ds_read_b128 v[224:227], v81 offset:34816
  s_cmp_eq_u32 s24, 1
  s_cselect_b32 s67, 1.0, 0
  v_mfma_f32_16x16x32_bf16 v[236:239], a[172:175], v[200:203], v[236:239]
  ds_read_b128 v[228:231], v81 offset:35840
  v_cmp_gt_u32 s[48:49], 16, v1
  v_mfma_f32_16x16x32_bf16 v[240:243], a[168:171], v[204:207], v[240:243]
  ds_read_b128 v[32:35], v7 offset:34816
  v_mfma_f32_16x16x32_bf16 v[244:247], a[172:175], v[204:207], v[244:247]
  buffer_load_dwordx4 v4, s[4:7], s35 offen offset:2048 lds
  v_mfma_f32_16x16x32_bf16 v[248:251], a[176:179], v[36:39], v[248:251]
  s_waitcnt lgkmcnt(6)
  v_mfma_f32_16x16x32_bf16 v[232:235], a[180:183], v[208:211], v[232:235]
  v_mfma_f32_16x16x32_bf16 v[236:239], a[184:187], v[208:211], v[236:239]
  v_mfma_f32_16x16x32_bf16 v[240:243], a[180:183], v[212:215], v[240:243]
  v_mfma_f32_16x16x32_bf16 v[244:247], a[184:187], v[212:215], v[244:247]
  s_add_u32 m0, s31, 12288
  s_add_u32 s35, s32, 0
  buffer_load_dwordx4 v2, s[8:11], s35 offen offset:0 lds
  v_mfma_f32_16x16x32_bf16 v[248:251], a[188:191], v[40:43], v[248:251]
  s_waitcnt lgkmcnt(3)
  v_mfma_f32_16x16x32_bf16 v[232:235], a[192:195], v[216:219], v[232:235]
  v_mfma_f32_16x16x32_bf16 v[236:239], a[196:199], v[216:219], v[236:239]
  v_mfma_f32_16x16x32_bf16 v[240:243], a[192:195], v[220:223], v[240:243]
  v_mfma_f32_16x16x32_bf16 v[244:247], a[196:199], v[220:223], v[244:247]
  buffer_load_dwordx4 v3, s[8:11], s35 offen offset:1024 lds
  v_mfma_f32_16x16x32_bf16 v[248:251], a[200:203], v[28:31], v[248:251]
  s_waitcnt lgkmcnt(0)
  v_mfma_f32_16x16x32_bf16 v[232:235], a[204:207], v[224:227], v[232:235]
  v_mfma_f32_16x16x32_bf16 v[236:239], a[208:211], v[224:227], v[236:239]
  v_mfma_f32_16x16x32_bf16 v[240:243], a[204:207], v[228:231], v[240:243]
  v_mfma_f32_16x16x32_bf16 v[244:247], a[208:211], v[228:231], v[244:247]
  buffer_load_dwordx4 v4, s[8:11], s35 offen offset:2048 lds
  v_mfma_f32_16x16x32_bf16 v[248:251], a[212:215], v[32:35], v[248:251]
  s_nop 3
  v_cvt_pk_bf16_f32 v232, v232, v233
  v_cvt_pk_bf16_f32 v234, v234, v235
  v_and_b32 v233, s54, v232
  v_lshlrev_b32 v232, 16, v232
  v_and_b32 v235, s54, v234
  v_lshlrev_b32 v234, 16, v234
  v_pk_add_f32 v[232:233], v[232:233], v[88:89]
  v_pk_add_f32 v[234:235], v[234:235], v[90:91]
  v_cvt_pk_bf16_f32 v144, v232, v233
  v_cvt_pk_bf16_f32 v145, v234, v235
  v_lshlrev_b32 v232, 16, v144
  v_and_b32 v233, s54, v144
  v_lshlrev_b32 v234, 16, v145
  v_and_b32 v235, s54, v145
  v_sub_f32 v232, v232, v74
  v_sub_f32 v233, v233, v74
  v_sub_f32 v234, v234, v74
  v_sub_f32 v235, v235, v74
  v_cvt_pk_bf16_f32 v112, v232, v233
  v_cvt_pk_bf16_f32 v113, v234, v235
  v_cvt_pk_bf16_f32 v236, v236, v237
  v_cvt_pk_bf16_f32 v238, v238, v239
  v_and_b32 v237, s54, v236
  v_lshlrev_b32 v236, 16, v236
  v_and_b32 v239, s54, v238
  v_lshlrev_b32 v238, 16, v238
  v_pk_add_f32 v[236:237], v[236:237], v[92:93]
  v_pk_add_f32 v[238:239], v[238:239], v[94:95]
  v_cvt_pk_bf16_f32 v146, v236, v237
  v_cvt_pk_bf16_f32 v147, v238, v239
  v_lshlrev_b32 v236, 16, v146
  v_and_b32 v237, s54, v146
  v_lshlrev_b32 v238, 16, v147
  v_and_b32 v239, s54, v147
  v_sub_f32 v236, v236, v74
  v_sub_f32 v237, v237, v74
  v_sub_f32 v238, v238, v74
  v_sub_f32 v239, v239, v74
  v_cvt_pk_bf16_f32 v114, v236, v237
  v_cvt_pk_bf16_f32 v115, v238, v239
  buffer_store_dwordx4 v[112:115], v86, s[16:19], s56 offen offset:0 sc1
  v_cvt_pk_bf16_f32 v240, v240, v241
  v_cvt_pk_bf16_f32 v242, v242, v243
  v_and_b32 v241, s54, v240
  v_lshlrev_b32 v240, 16, v240
  v_and_b32 v243, s54, v242
  v_lshlrev_b32 v242, 16, v242
  v_pk_add_f32 v[240:241], v[240:241], v[96:97]
  v_pk_add_f32 v[242:243], v[242:243], v[98:99]
  v_cvt_pk_bf16_f32 v148, v240, v241
  v_cvt_pk_bf16_f32 v149, v242, v243
  v_lshlrev_b32 v240, 16, v148
  v_and_b32 v241, s54, v148
  v_lshlrev_b32 v242, 16, v149
  v_and_b32 v243, s54, v149
  v_sub_f32 v240, v240, v75
  v_sub_f32 v241, v241, v75
  v_sub_f32 v242, v242, v75
  v_sub_f32 v243, v243, v75
  v_cvt_pk_bf16_f32 v116, v240, v241
  v_cvt_pk_bf16_f32 v117, v242, v243
  v_cvt_pk_bf16_f32 v244, v244, v245
  v_cvt_pk_bf16_f32 v246, v246, v247
  v_and_b32 v245, s54, v244
  v_lshlrev_b32 v244, 16, v244
  v_and_b32 v247, s54, v246
  v_lshlrev_b32 v246, 16, v246
  v_pk_add_f32 v[244:245], v[244:245], v[100:101]
  v_pk_add_f32 v[246:247], v[246:247], v[102:103]
  v_cvt_pk_bf16_f32 v150, v244, v245
  v_cvt_pk_bf16_f32 v151, v246, v247
  v_lshlrev_b32 v244, 16, v150
  v_and_b32 v245, s54, v150
  v_lshlrev_b32 v246, 16, v151
  v_and_b32 v247, s54, v151
  v_sub_f32 v244, v244, v75
  v_sub_f32 v245, v245, v75
  v_sub_f32 v246, v246, v75
  v_sub_f32 v247, v247, v75
  v_cvt_pk_bf16_f32 v118, v244, v245
  v_cvt_pk_bf16_f32 v119, v246, v247
  buffer_store_dwordx4 v[116:119], v86, s[16:19], s56 offen offset:1024 sc1
  v_cvt_pk_bf16_f32 v248, v248, v249
  v_cvt_pk_bf16_f32 v250, v250, v251
  v_and_b32 v249, s54, v248
  v_lshlrev_b32 v248, 16, v248
  v_and_b32 v251, s54, v250
  v_lshlrev_b32 v250, 16, v250
  v_pk_add_f32 v[248:249], v[248:249], v[104:105]
  v_pk_add_f32 v[250:251], v[250:251], v[106:107]
  v_cvt_pk_bf16_f32 v152, v248, v249
  v_cvt_pk_bf16_f32 v153, v250, v251
  v_lshlrev_b32 v248, 16, v152
  v_and_b32 v249, s54, v152
  v_lshlrev_b32 v250, 16, v153
  v_and_b32 v251, s54, v153
  v_sub_f32 v248, v248, v21
  v_sub_f32 v249, v249, v21
  v_sub_f32 v250, v250, v21
  v_sub_f32 v251, v251, v21
  v_cvt_pk_bf16_f32 v120, v248, v249
  v_cvt_pk_bf16_f32 v121, v250, v251
  buffer_store_dwordx2 v[120:121], v87, s[16:19], s52 offen sc1
  v_pk_fma_f32 v[124:125], v[232:233], v[232:233], v[46:47]
  v_pk_fma_f32 v[124:125], v[234:235], v[234:235], v[124:125]
  v_pk_fma_f32 v[124:125], v[236:237], v[236:237], v[124:125]
  v_pk_fma_f32 v[124:125], v[238:239], v[238:239], v[124:125]
  v_pk_fma_f32 v[126:127], v[240:241], v[240:241], v[50:51]
  v_pk_fma_f32 v[126:127], v[242:243], v[242:243], v[126:127]
  v_pk_fma_f32 v[126:127], v[244:245], v[244:245], v[126:127]
  v_pk_fma_f32 v[126:127], v[246:247], v[246:247], v[126:127]
  v_pk_mul_f32 v[128:129], v[248:249], v[248:249]
  v_pk_fma_f32 v[128:129], v[250:251], v[250:251], v[128:129]
  v_add_f32 v124, v124, v125
  v_add_f32 v126, v126, v127
  v_add_f32 v128, v128, v129
  v_fmac_f32 v124, s66, v128
  v_fmac_f32 v126, s67, v128
  buffer_store_dwordx4 v[144:147], v86, s[16:19], s57 offen offset:0 sc1
  buffer_store_dwordx4 v[148:151], v86, s[16:19], s57 offen offset:1024 sc1
  v_permlane16_swap_b32 v124, v126
  v_add_f32 v124, v124, v126
  v_mov_b32 v126, v124
  buffer_store_dwordx2 v[152:153], v87, s[16:19], s53 offen sc1
  s_nop 0
  v_permlane32_swap_b32 v126, v124
  v_add_f32 v124, v124, v126
  buffer_store_dword v124, v17, s[16:19], s65 offen sc1
  v_lshrrev_b32 v2, 6, v0
  v_and_b32 v1, 63, v0
  v_readfirstlane_b32 s24, v2
  s_lshr_b32 s27, s2, 4
  s_and_b32 s29, s2, 7
  s_bfe_u32 s30, s2, 0x10003
  s_lshr_b32 s25, s24, 1
  s_and_b32 s26, s24, 1
  s_mul_i32 s37, s29, 576
  s_lshl_b32 s38, s30, 8
  s_add_u32 s39, s38, s37
  s_lshl_b32 s32, s39, 1
  s_lshl_b32 s35, s30, 9
  s_mul_i32 s34, s39, 1152
  s_add_u32 s34, s34, s35
  s_xor_b32 s38, s38, 256
  s_add_u32 s38, s38, s37
  s_mul_i32 s40, s38, 1152
  s_add_u32 s40, s40, s35
  s_lshl_b32 s38, s30, 6
  s_mul_i32 s41, s37, 1152
  s_add_u32 s41, s41, s38
  s_add_u32 s41, s41, 1024
  s_lshl_b32 s39, s30, 5
  s_add_u32 s39, s39, s37
  s_add_u32 s39, s39, 512
  s_lshl_b32 s33, s39, 1
  v_lshlrev_b32 v222, 4, v1
  s_lshl_b32 s35, s27, 1
  s_add_u32 s35, s35, s25
  s_mul_i32 s36, s35, 73728
  v_add_u32 v20, s36, v222
  v_and_b32 v221, 15, v1
  s_lshl_b32 s36, s35, 8
  s_add_u32 s36, s36, 7733248
  v_lshl_add_u32 v221, v221, 4, s36
  v_lshrrev_b32 v196, 4, v1
  v_lshl_add_u32 v221, v196, 15, v221
  v_lshrrev_b32 v196, 3, v1
  s_lshl_b32 s35, s24, 3
  v_add_u32 v196, s35, v196
  v_lshrrev_b32 v197, 4, v1
  v_lshlrev_b32 v197, 1, v197
  v_and_b32 v198, 7, v1
  v_xor_b32 v197, v197, v198
  v_mul_u32_u24 v198, 9216, v196
  v_lshl_add_u32 v2, v197, 4, v198
  v_add_u32 v3, 293888, v2
  v_add_u32 v4, 587776, v2
  v_lshrrev_b32 v199, 2, v197
  v_mul_u32_u24 v199, 294912, v199
  v_add_u32 v199, v199, v198
  v_and_b32 v198, 3, v197
  v_lshl_add_u32 v5, v198, 4, v199
  v_add_u32 v6, 588800, v5
  v_add_u32 v7, 1177600, v5
  v_mul_u32_u24 v198, 1152, v196
  v_lshl_add_u32 v8, v197, 4, v198
  v_add_u32 v9, 35840, v8
  v_add_u32 v10, 71680, v8
  s_mul_i32 s35, s30, 258048
  s_sub_u32 s56, 366592, s35
  s_add_u32 s57, s35, 108544
  v_lshrrev_b32 v196, 5, v1
  v_mul_u32_u24 v196, 3072, v196
  v_bfe_u32 v197, v1, 2, 3
  v_lshl_add_u32 v196, v197, 7, v196
  v_and_b32 v197, 3, v1
  v_lshl_add_u32 v196, v197, 3, v196
  v_bfe_u32 v197, v1, 3, 2
  s_lshl_b32 s35, s26, 1
  s_add_u32 s36, s35, 0
  v_xor_b32 v198, s36, v197
  v_lshl_add_u32 v12, v198, 5, v196
  v_add_u32 v14, 61440, v12
  s_add_u32 s36, s26, 0
  v_xor_b32 v198, s36, v197
  v_lshl_add_u32 v16, v198, 5, v196
  v_add_u32 v18, 61440, v16
  s_add_u32 s36, s35, 1
  v_xor_b32 v198, s36, v197
  v_lshl_add_u32 v13, v198, 5, v196
  v_add_u32 v15, 61440, v13
  s_add_u32 s36, s26, 2
  v_xor_b32 v198, s36, v197
  v_lshl_add_u32 v17, v198, 5, v196
  v_add_u32 v19, 61440, v17
  s_mul_i32 s36, s25, 36864
  s_add_u32 s44, s36, 86016
  v_add_u32 v23, s44, v222
  s_lshl_b32 s35, s26, 12
  v_add_u32 v21, s35, v23
  s_lshl_b32 s35, s26, 9
  s_add_u32 s35, s35, s44
  v_lshl_add_u32 v22, v1, 3, s35
  s_mul_i32 s42, s2, 73728
  s_add_u32 s42, s42, 27176960
  s_xor_b32 s43, s2, 8
  s_mul_i32 s43, s43, 73728
  s_add_u32 s43, s43, s36
  s_mul_i32 s35, s26, 6144
  s_add_u32 s43, s43, s35
  s_add_u32 s43, s43, 27262976
  s_add_u32 s44, s44, s35
  s_mul_i32 s36, s25, 12288
  s_add_u32 s36, s36, 86016
  v_add_u32 v220, s36, v222
  v_lshl_add_u32 v0, v1, 3, s36
  s_mul_i32 s37, s29, 2359296
  s_lshl_b32 s36, s26, 12
  s_add_u32 s37, s37, s36
  s_lshl_b32 s36, s30, 15
  s_add_u32 s37, s37, s36
  s_add_u32 s37, s37, 8388608
  s_mul_i32 s31, s24, 3072
  s_mul_i32 s39, s24, 6144
  s_add_u32 s39, s39, 86016
  s_mul_i32 s28, s26, 6144
  s_add_u32 s28, s28, 2621440
  s_lshl_b32 s45, s2, 9
  s_add_u32 s45, s45, 7995392
  s_xor_b32 s46, s2, 8
  s_lshl_b32 s46, s46, 9
  s_add_u32 s46, s46, 7995392
  s_lshr_b32 s47, s2, 3
  s_lshl_b32 s47, s47, 11
  s_add_u32 s47, s47, 7929856
  s_lshr_b32 s54, s29, 2
  s_lshl_b32 s54, s54, 1
  s_add_u32 s54, s54, s25
  s_lshl_b32 s54, s54, 7
  s_add_u32 s54, s54, s47
  s_lshl_b32 s35, s24, 7
  s_add_u32 s47, s47, s35
  v_cmp_eq_u32 vcc, 0, v1
  v_mov_b32 v196, 0x7f000000
  s_nop 0
  v_cndmask_b32 v223, v196, 0, vcc
  s_bitcmp1_b32 s24, 0
  s_cselect_b32 s48, s8, s4
  s_cselect_b32 s49, s9, s5
  s_mov_b32 s50, s6
  s_mov_b32 s51, 0x20000
  s_lshr_b32 s52, s2, 3
  s_mul_i32 s52, s52, 165888
  s_and_b32 s3, s2, 7
  s_mul_i32 s3, s3, 1152
  s_add_u32 s52, s52, s3
  s_lshr_b32 s3, s24, 1
  s_lshl_b32 s3, s3, 9
  s_add_u32 s52, s52, s3
  s_lshr_b32 s35, s2, 3
  s_mul_i32 s53, s35, 20736
  s_mul_i32 s35, s29, 663552
  s_add_u32 s53, s53, s35
  s_lshl_b32 s35, s26, 9
  s_add_u32 s53, s53, s35
  s_lshl_b32 s35, s25, 7
  s_add_u32 s53, s53, s35
  s_add_u32 m0, s31, 24576
  s_add_u32 s35, s32, 128
  buffer_load_dwordx4 v2, s[4:7], s35 offen offset:0 lds
  buffer_load_dwordx4 v3, s[4:7], s35 offen offset:1024 lds
  buffer_load_dwordx4 v4, s[4:7], s35 offen offset:2048 lds
  s_waitcnt vmcnt(3)
  s_barrier
  buffer_store_dword v253, v252, s[16:19], s45 offen offset:384 sc1
  s_add_u32 m0, s31, 36864
  s_add_u32 s35, s32, 884736
  buffer_load_dwordx4 v2, s[4:7], s35 offen offset:0 lds
  buffer_load_dwordx4 v3, s[4:7], s35 offen offset:1024 lds
  buffer_load_dwordx4 v4, s[4:7], s35 offen offset:2048 lds
  s_add_u32 m0, s31, 49152
  s_add_u32 s35, s32, 884736
  buffer_load_dwordx4 v2, s[8:11], s35 offen offset:0 lds
  buffer_load_dwordx4 v3, s[8:11], s35 offen offset:1024 lds
  buffer_load_dwordx4 v4, s[8:11], s35 offen offset:2048 lds
  s_add_u32 m0, s31, 61440
  s_add_u32 s35, s32, 884864
  buffer_load_dwordx4 v2, s[4:7], s35 offen offset:0 lds
  buffer_load_dwordx4 v3, s[4:7], s35 offen offset:1024 lds
  buffer_load_dwordx4 v4, s[4:7], s35 offen offset:2048 lds
  s_add_u32 m0, s31, 73728
  s_add_u32 s35, s32, 1769472
  buffer_load_dwordx4 v2, s[4:7], s35 offen offset:0 lds
  buffer_load_dwordx4 v3, s[4:7], s35 offen offset:1024 lds
  buffer_load_dwordx4 v4, s[4:7], s35 offen offset:2048 lds
  s_mov_b64 exec, 0
  s_cmp_eq_u32 s24, 0
  s_cbranch_scc1 L_wu_s2_0
  s_cmp_eq_u32 s24, 1
  s_cbranch_scc1 L_wu_s2_1
  s_cmp_eq_u32 s24, 2
  s_cbranch_scc1 L_wu_s2_2
L_wuret_s2:
  s_mov_b64 exec, -1
  s_cmp_lg_u32 s24, 3
  s_cbranch_scc1 L_s2_go
  s_lshr_b32 s38, s27, 1
  s_and_b32 s3, s27, 1
  s_lshl_b32 s3, s3, 7
  s_add_u32 s38, s38, s3
  s_lshl_b32 s38, s38, 9
  s_add_u32 s38, s38, 7995776
  v_and_b32 v255, 15, v1
  v_lshlrev_b32 v255, 12, v255
L_s2_poll:
  buffer_load_dword v254, v255, s[16:19], s38 offen sc1
  s_waitcnt vmcnt(0)
  v_cmp_gt_u32 vcc, 1, v254
  s_cbranch_vccz L_s2_go
  s_sub_u32 s100, s100, 1
  s_cmp_lt_i32 s100, 0
  s_cbranch_scc0 L_s2_poll
L_s2_go:
  s_barrier
  s_nop 0
  s_add_u32 m0, s39, 0
  s_add_u32 s36, s28, 0
  buffer_load_dwordx4 v20, s[16:19], s36 offen offset:0 sc1 lds
  buffer_load_dwordx4 v20, s[16:19], s36 offen offset:1024 sc1 lds
  buffer_load_dwordx4 v20, s[16:19], s36 offen offset:2048 sc1 lds
  s_add_u32 m0, s39, 3072
  s_add_u32 s36, s28, 3072
  buffer_load_dwordx4 v20, s[16:19], s36 offen offset:0 sc1 lds
  buffer_load_dwordx4 v20, s[16:19], s36 offen offset:1024 sc1 lds
  ds_read_b64_tr_b16 v[160:161], v12 offset:0
  buffer_load_dwordx4 v20, s[16:19], s36 offen offset:2048 sc1 lds
  ds_read_b64_tr_b16 v[162:163], v12 offset:6144
  s_add_u32 m0, s39, 24576
  s_add_u32 s36, s28, 12288
  buffer_load_dwordx4 v20, s[16:19], s36 offen offset:0 sc1 lds
  ds_read_b64_tr_b16 v[164:165], v12 offset:1024
  buffer_load_dwordx4 v20, s[16:19], s36 offen offset:1024 sc1 lds
  ds_read_b64_tr_b16 v[166:167], v12 offset:7168
  buffer_load_dwordx4 v20, s[16:19], s36 offen offset:2048 sc1 lds
  ds_read_b64_tr_b16 v[168:169], v12 offset:2048
  s_add_u32 m0, s39, 27648
  s_add_u32 s36, s28, 15360
  buffer_load_dwordx4 v20, s[16:19], s36 offen offset:0 sc1 lds
  ds_read_b64_tr_b16 v[170:171], v12 offset:8192
  buffer_load_dwordx4 v20, s[16:19], s36 offen offset:1024 sc1 lds
  ds_read_b64_tr_b16 v[172:173], v13 offset:0
  buffer_load_dwordx4 v20, s[16:19], s36 offen offset:2048 sc1 lds
  ds_read_b64_tr_b16 v[174:175], v13 offset:6144
  s_add_u32 m0, s39, 49152
  s_add_u32 s36, s28, 24576
  buffer_load_dwordx4 v20, s[16:19], s36 offen offset:0 sc1 lds
  ds_read_b64_tr_b16 v[176:177], v13 offset:1024
  buffer_load_dwordx4 v20, s[16:19], s36 offen offset:1024 sc1 lds
  ds_read_b64_tr_b16 v[178:179], v13 offset:7168
  buffer_load_dwordx4 v20, s[16:19], s36 offen offset:2048 sc1 lds
  ds_read_b64_tr_b16 v[180:181], v13 offset:2048
  s_add_u32 m0, s39, 52224
  s_add_u32 s36, s28, 27648
  buffer_load_dwordx4 v20, s[16:19], s36 offen offset:0 sc1 lds
  ds_read_b64_tr_b16 v[182:183], v13 offset:8192
  buffer_load_dwordx4 v20, s[16:19], s36 offen offset:1024 sc1 lds
  buffer_load_dwordx4 v20, s[16:19], s36 offen offset:2048 sc1 lds
  s_waitcnt vmcnt(12)
  s_barrier
  ds_read_b128 a[0:3], v220 offset:0
  ds_read_b128 a[16:19], v220 offset:4096
  ds_read_b128 a[32:35], v220 offset:8192
  ds_read_b128 a[4:7], v220 offset:1024
  ds_read_b128 a[20:23], v220 offset:5120
  ds_read_b128 a[36:39], v220 offset:9216
  ds_read_b128 a[8:11], v220 offset:2048
  ds_read_b128 a[24:27], v220 offset:6144
  ds_read_b128 a[40:43], v220 offset:10240
  ds_read_b128 a[12:15], v220 offset:3072
  ds_read_b128 a[28:31], v220 offset:7168
  ds_read_b128 a[44:47], v220 offset:11264
  s_waitcnt lgkmcnt(9)
  v_mfma_f32_16x16x32_bf16 v[32:35], v[160:163], a[0:3], 0
  ds_read_b64_tr_b16 v[184:185], v12 offset:12288
  v_mfma_f32_16x16x32_bf16 v[32:35], v[164:167], a[16:19], v[32:35]
  v_mfma_f32_16x16x32_bf16 v[32:35], v[168:171], a[32:35], v[32:35]
  s_waitcnt lgkmcnt(7)
  ds_read_b64_tr_b16 v[186:187], v12 offset:18432
  v_mfma_f32_16x16x32_bf16 v[36:39], v[160:163], a[4:7], 0
  v_mfma_f32_16x16x32_bf16 v[36:39], v[164:167], a[20:23], v[36:39]
  ds_read_b64_tr_b16 v[188:189], v12 offset:13312
  v_mfma_f32_16x16x32_bf16 v[36:39], v[168:171], a[36:39], v[36:39]
  s_waitcnt lgkmcnt(6)
  v_mfma_f32_16x16x32_bf16 v[40:43], v[160:163], a[8:11], 0
  ds_read_b64_tr_b16 v[190:191], v12 offset:19456
  v_mfma_f32_16x16x32_bf16 v[40:43], v[164:167], a[24:27], v[40:43]
  v_mfma_f32_16x16x32_bf16 v[40:43], v[168:171], a[40:43], v[40:43]
  s_waitcnt lgkmcnt(4)
  ds_read_b64_tr_b16 v[192:193], v12 offset:14336
  v_mfma_f32_16x16x32_bf16 v[44:47], v[160:163], a[12:15], 0
  v_mfma_f32_16x16x32_bf16 v[44:47], v[164:167], a[28:31], v[44:47]
  ds_read_b64_tr_b16 v[194:195], v12 offset:20480
  v_mfma_f32_16x16x32_bf16 v[44:47], v[168:171], a[44:47], v[44:47]
  s_waitcnt lgkmcnt(15)
  v_mfma_f32_16x16x32_bf16 v[48:51], v[172:175], a[0:3], 0
  ds_read_b64_tr_b16 v[160:161], v13 offset:12288
  v_mfma_f32_16x16x32_bf16 v[48:51], v[176:179], a[16:19], v[48:51]
  v_mfma_f32_16x16x32_bf16 v[48:51], v[180:183], a[32:35], v[48:51]
  ds_read_b64_tr_b16 v[162:163], v13 offset:18432
  v_mfma_f32_16x16x32_bf16 v[52:55], v[172:175], a[4:7], 0
  v_mfma_f32_16x16x32_bf16 v[52:55], v[176:179], a[20:23], v[52:55]
  ds_read_b64_tr_b16 v[164:165], v13 offset:13312
  v_mfma_f32_16x16x32_bf16 v[52:55], v[180:183], a[36:39], v[52:55]
  v_mfma_f32_16x16x32_bf16 v[56:59], v[172:175], a[8:11], 0
  ds_read_b64_tr_b16 v[166:167], v13 offset:19456
  v_mfma_f32_16x16x32_bf16 v[56:59], v[176:179], a[24:27], v[56:59]
  v_mfma_f32_16x16x32_bf16 v[56:59], v[180:183], a[40:43], v[56:59]
  ds_read_b64_tr_b16 v[168:169], v13 offset:14336
  v_mfma_f32_16x16x32_bf16 v[60:63], v[172:175], a[12:15], 0
  v_mfma_f32_16x16x32_bf16 v[60:63], v[176:179], a[28:31], v[60:63]
  s_waitcnt lgkmcnt(5) vmcnt(31)
  ds_read_b64_tr_b16 v[170:171], v13 offset:20480
  v_mfma_f32_16x16x32_bf16 v[60:63], v[180:183], a[44:47], v[60:63]
  s_barrier
  v_mfma_f32_16x16x32_bf16 v[64:67], v[184:187], a[0:3], 0
  ds_read_b64_tr_b16 v[172:173], v12 offset:24576
  v_mfma_f32_16x16x32_bf16 v[64:67], v[188:191], a[16:19], v[64:67]
  s_add_u32 s36, s28, 36864
  v_mfma_f32_16x16x32_bf16 v[64:67], v[192:195], a[32:35], v[64:67]
  s_add_u32 m0, s39, 0
  ds_read_b64_tr_b16 v[174:175], v12 offset:30720
  v_mfma_f32_16x16x32_bf16 v[68:71], v[184:187], a[4:7], 0
  buffer_load_dwordx4 v20, s[16:19], s36 offen offset:0 sc1 lds
  v_mfma_f32_16x16x32_bf16 v[68:71], v[188:191], a[20:23], v[68:71]
  ds_read_b64_tr_b16 v[176:177], v12 offset:25600
  v_mfma_f32_16x16x32_bf16 v[68:71], v[192:195], a[36:39], v[68:71]
  v_mfma_f32_16x16x32_bf16 v[72:75], v[184:187], a[8:11], 0
  ds_read_b64_tr_b16 v[178:179], v12 offset:31744
  v_mfma_f32_16x16x32_bf16 v[72:75], v[188:191], a[24:27], v[72:75]
  buffer_load_dwordx4 v20, s[16:19], s36 offen offset:1024 sc1 lds
  v_mfma_f32_16x16x32_bf16 v[72:75], v[192:195], a[40:43], v[72:75]
  ds_read_b64_tr_b16 v[180:181], v12 offset:26624
  v_mfma_f32_16x16x32_bf16 v[76:79], v[184:187], a[12:15], 0
  v_mfma_f32_16x16x32_bf16 v[76:79], v[188:191], a[28:31], v[76:79]
  ds_read_b64_tr_b16 v[182:183], v12 offset:32768
  v_mfma_f32_16x16x32_bf16 v[76:79], v[192:195], a[44:47], v[76:79]
  s_waitcnt lgkmcnt(6)
  buffer_load_dwordx4 v20, s[16:19], s36 offen offset:2048 sc1 lds
  v_mfma_f32_16x16x32_bf16 v[80:83], v[160:163], a[0:3], 0
  ds_read_b64_tr_b16 v[184:185], v13 offset:24576
  v_mfma_f32_16x16x32_bf16 v[80:83], v[164:167], a[16:19], v[80:83]
  s_add_u32 s36, s28, 39936
  v_mfma_f32_16x16x32_bf16 v[80:83], v[168:171], a[32:35], v[80:83]
L_wu_s2_0:
L_st_9000:
  s_cbranch_execz L_st_a000
  s_add_u32 m0, s39, 3072
  ds_read_b64_tr_b16 v[186:187], v13 offset:30720
  v_mfma_f32_16x16x32_bf16 v[84:87], v[160:163], a[4:7], 0
  buffer_load_dwordx4 v20, s[16:19], s36 offen offset:0 sc1 lds
  v_mfma_f32_16x16x32_bf16 v[84:87], v[164:167], a[20:23], v[84:87]
  ds_read_b64_tr_b16 v[188:189], v13 offset:25600
  v_mfma_f32_16x16x32_bf16 v[84:87], v[168:171], a[36:39], v[84:87]
  v_mfma_f32_16x16x32_bf16 v[88:91], v[160:163], a[8:11], 0
  ds_read_b64_tr_b16 v[190:191], v13 offset:31744
  v_mfma_f32_16x16x32_bf16 v[88:91], v[164:167], a[24:27], v[88:91]
  buffer_load_dwordx4 v20, s[16:19], s36 offen offset:1024 sc1 lds
  v_mfma_f32_16x16x32_bf16 v[88:91], v[168:171], a[40:43], v[88:91]
  ds_read_b64_tr_b16 v[192:193], v13 offset:26624
  v_mfma_f32_16x16x32_bf16 v[92:95], v[160:163], a[12:15], 0
  v_mfma_f32_16x16x32_bf16 v[92:95], v[164:167], a[28:31], v[92:95]
  s_waitcnt lgkmcnt(5) vmcnt(11)
  ds_read_b64_tr_b16 v[194:195], v13 offset:32768
  v_mfma_f32_16x16x32_bf16 v[92:95], v[168:171], a[44:47], v[92:95]
  s_barrier
  v_mfma_f32_16x16x32_bf16 v[96:99], v[172:175], a[0:3], 0
  ds_read_b64_tr_b16 v[160:161], v12 offset:36864
  ds_read_b128 a[48:51], v220 offset:24576
  v_mfma_f32_16x16x32_bf16 v[96:99], v[176:179], a[16:19], v[96:99]
  ds_read2st64_b64 a[64:67], v0 offset0:56 offset1:57
  v_mfma_f32_16x16x32_bf16 v[96:99], v[180:183], a[32:35], v[96:99]
  ds_read_b64_tr_b16 v[162:163], v12 offset:43008
  ds_read_b128 a[80:83], v220 offset:32768
  v_mfma_f32_16x16x32_bf16 v[100:103], v[172:175], a[4:7], 0
  buffer_load_dwordx4 v20, s[16:19], s36 offen offset:2048 sc1 lds
  v_mfma_f32_16x16x32_bf16 v[100:103], v[176:179], a[20:23], v[100:103]
  ds_read_b64_tr_b16 v[164:165], v12 offset:37888
  ds_read_b128 a[52:55], v220 offset:25600
  v_mfma_f32_16x16x32_bf16 v[100:103], v[180:183], a[36:39], v[100:103]
  s_add_u32 s35, s32, 1769472
  ds_read2st64_b64 a[68:71], v0 offset0:58 offset1:59
  v_mfma_f32_16x16x32_bf16 v[104:107], v[172:175], a[8:11], 0
  s_add_u32 m0, s31, 0
  ds_read_b64_tr_b16 v[166:167], v12 offset:44032
  ds_read_b128 a[84:87], v220 offset:33792
  v_mfma_f32_16x16x32_bf16 v[104:107], v[176:179], a[24:27], v[104:107]
  buffer_load_dwordx4 v2, s[8:11], s35 offen offset:0 lds
  v_mfma_f32_16x16x32_bf16 v[104:107], v[180:183], a[40:43], v[104:107]
  ds_read_b64_tr_b16 v[168:169], v12 offset:38912
  ds_read_b128 a[56:59], v220 offset:26624
  v_mfma_f32_16x16x32_bf16 v[108:111], v[172:175], a[12:15], 0
  ds_read2st64_b64 a[72:75], v0 offset0:60 offset1:61
  v_mfma_f32_16x16x32_bf16 v[108:111], v[176:179], a[28:31], v[108:111]
  ds_read_b64_tr_b16 v[170:171], v12 offset:45056
  ds_read_b128 a[88:91], v220 offset:34816
  v_mfma_f32_16x16x32_bf16 v[108:111], v[180:183], a[44:47], v[108:111]
  s_waitcnt lgkmcnt(15)
  buffer_load_dwordx4 v3, s[8:11], s35 offen offset:1024 lds
  v_mfma_f32_16x16x32_bf16 v[112:115], v[184:187], a[0:3], 0
  s_movk_i32 s3, 0
  ds_read_b64_tr_b16 v[172:173], v13 offset:36864
  ds_read_b128 a[60:63], v220 offset:27648
  v_mfma_f32_16x16x32_bf16 v[112:115], v[188:191], a[16:19], v[112:115]
  ds_read2st64_b64 a[76:79], v0 offset0:62 offset1:63
  v_mfma_f32_16x16x32_bf16 v[112:115], v[192:195], a[32:35], v[112:115]
  ds_read_b64_tr_b16 v[174:175], v13 offset:43008
  ds_read_b128 a[92:95], v220 offset:35840
  v_mfma_f32_16x16x32_bf16 v[116:119], v[184:187], a[4:7], 0
  buffer_load_dwordx4 v4, s[8:11], s35 offen offset:2048 lds
  v_mfma_f32_16x16x32_bf16 v[116:119], v[188:191], a[20:23], v[116:119]
  ds_read_b64_tr_b16 v[176:177], v13 offset:37888
  v_mfma_f32_16x16x32_bf16 v[116:119], v[192:195], a[36:39], v[116:119]
  s_add_u32 s35, s32, 2654208
  buffer_load_dwordx4 v[204:207], v221, s[16:19], s3 offen sc1
  v_mfma_f32_16x16x32_bf16 v[120:123], v[184:187], a[8:11], 0
  s_add_u32 m0, s31, 12288
  s_movk_i32 s3, 8192
  ds_read_b64_tr_b16 v[178:179], v13 offset:44032
  v_mfma_f32_16x16x32_bf16 v[120:123], v[188:191], a[24:27], v[120:123]
  buffer_load_dwordx4 v2, s[4:7], s35 offen offset:0 lds
  v_mfma_f32_16x16x32_bf16 v[120:123], v[192:195], a[40:43], v[120:123]
  ds_read_b64_tr_b16 v[180:181], v13 offset:38912
  v_mfma_f32_16x16x32_bf16 v[124:127], v[184:187], a[12:15], 0
  buffer_load_dwordx4 v[208:211], v221, s[16:19], s3 offen sc1
  v_mfma_f32_16x16x32_bf16 v[124:127], v[188:191], a[28:31], v[124:127]
  s_waitcnt lgkmcnt(3) vmcnt(36)
  s_movk_i32 s3, 16384
  ds_read_b64_tr_b16 v[182:183], v13 offset:45056
  v_mfma_f32_16x16x32_bf16 v[124:127], v[192:195], a[44:47], v[124:127]
  s_barrier
  v_mfma_f32_16x16x32_bf16 v[32:35], v[160:163], a[48:51], v[32:35]
  ds_read_b64_tr_b16 v[184:185], v12 offset:49152
  v_mfma_f32_16x16x32_bf16 v[32:35], v[164:167], a[64:67], v[32:35]
  s_add_u32 s36, s28, 49152
  buffer_load_dwordx4 v[212:215], v221, s[16:19], s3 offen sc1
  v_mfma_f32_16x16x32_bf16 v[32:35], v[168:171], a[80:83], v[32:35]
  s_add_u32 m0, s39, 24576
  s_movk_i32 s3, 24576
  ds_read_b64_tr_b16 v[186:187], v12 offset:55296
  v_mfma_f32_16x16x32_bf16 v[36:39], v[160:163], a[52:55], v[36:39]
  buffer_load_dwordx4 v20, s[16:19], s36 offen offset:0 sc1 lds
  v_mfma_f32_16x16x32_bf16 v[36:39], v[164:167], a[68:71], v[36:39]
  ds_read_b64_tr_b16 v[188:189], v12 offset:50176
  v_mfma_f32_16x16x32_bf16 v[36:39], v[168:171], a[84:87], v[36:39]
  buffer_load_dwordx4 v[216:219], v221, s[16:19], s3 offen sc1
  v_mfma_f32_16x16x32_bf16 v[40:43], v[160:163], a[56:59], v[40:43]
  ds_read_b64_tr_b16 v[190:191], v12 offset:56320
  v_mfma_f32_16x16x32_bf16 v[40:43], v[164:167], a[72:75], v[40:43]
  buffer_load_dwordx4 v20, s[16:19], s36 offen offset:1024 sc1 lds
  v_mfma_f32_16x16x32_bf16 v[40:43], v[168:171], a[88:91], v[40:43]
  ds_read_b64_tr_b16 v[192:193], v12 offset:51200
  v_mfma_f32_16x16x32_bf16 v[44:47], v[160:163], a[60:63], v[44:47]
  v_mfma_f32_16x16x32_bf16 v[44:47], v[164:167], a[76:79], v[44:47]
  ds_read_b64_tr_b16 v[194:195], v12 offset:57344
  v_mfma_f32_16x16x32_bf16 v[44:47], v[168:171], a[92:95], v[44:47]
  s_waitcnt lgkmcnt(6)
  buffer_load_dwordx4 v20, s[16:19], s36 offen offset:2048 sc1 lds
  v_mfma_f32_16x16x32_bf16 v[48:51], v[172:175], a[48:51], v[48:51]
  ds_read_b64_tr_b16 v[160:161], v13 offset:49152
  v_mfma_f32_16x16x32_bf16 v[48:51], v[176:179], a[64:67], v[48:51]
  s_add_u32 s36, s28, 52224
  v_mfma_f32_16x16x32_bf16 v[48:51], v[180:183], a[80:83], v[48:51]
  s_add_u32 m0, s39, 27648
  ds_read_b64_tr_b16 v[162:163], v13 offset:55296
  v_mfma_f32_16x16x32_bf16 v[52:55], v[172:175], a[52:55], v[52:55]
  buffer_load_dwordx4 v20, s[16:19], s36 offen offset:0 sc1 lds
  v_mfma_f32_16x16x32_bf16 v[52:55], v[176:179], a[68:71], v[52:55]
  ds_read_b64_tr_b16 v[164:165], v13 offset:50176
  v_mfma_f32_16x16x32_bf16 v[52:55], v[180:183], a[84:87], v[52:55]
  v_mfma_f32_16x16x32_bf16 v[56:59], v[172:175], a[56:59], v[56:59]
  ds_read_b64_tr_b16 v[166:167], v13 offset:56320
  v_mfma_f32_16x16x32_bf16 v[56:59], v[176:179], a[72:75], v[56:59]
  buffer_load_dwordx4 v20, s[16:19], s36 offen offset:1024 sc1 lds
  v_mfma_f32_16x16x32_bf16 v[56:59], v[180:183], a[88:91], v[56:59]
  ds_read_b64_tr_b16 v[168:169], v13 offset:51200
  v_mfma_f32_16x16x32_bf16 v[60:63], v[172:175], a[60:63], v[60:63]
  v_mfma_f32_16x16x32_bf16 v[60:63], v[176:179], a[76:79], v[60:63]
  s_waitcnt lgkmcnt(5) vmcnt(40)
  ds_read_b64_tr_b16 v[170:171], v13 offset:57344
  v_mfma_f32_16x16x32_bf16 v[60:63], v[180:183], a[92:95], v[60:63]
  s_barrier
  v_mfma_f32_16x16x32_bf16 v[64:67], v[184:187], a[48:51], v[64:67]
  ds_read_b64_tr_b16 v[172:173], v14 offset:0
  v_mfma_f32_16x16x32_bf16 v[64:67], v[188:191], a[64:67], v[64:67]
  v_mfma_f32_16x16x32_bf16 v[64:67], v[192:195], a[80:83], v[64:67]
  ds_read_b64_tr_b16 v[174:175], v14 offset:6144
  v_mfma_f32_16x16x32_bf16 v[68:71], v[184:187], a[52:55], v[68:71]
  buffer_load_dwordx4 v20, s[16:19], s36 offen offset:2048 sc1 lds
  v_mfma_f32_16x16x32_bf16 v[68:71], v[188:191], a[68:71], v[68:71]
  ds_read_b64_tr_b16 v[176:177], v14 offset:1024
  v_mfma_f32_16x16x32_bf16 v[68:71], v[192:195], a[84:87], v[68:71]
  v_mfma_f32_16x16x32_bf16 v[72:75], v[184:187], a[56:59], v[72:75]
  s_add_u32 m0, s31, 12288
  ds_read_b64_tr_b16 v[178:179], v14 offset:7168
  v_mfma_f32_16x16x32_bf16 v[72:75], v[188:191], a[72:75], v[72:75]
  buffer_load_dwordx4 v3, s[4:7], s35 offen offset:1024 lds
  v_mfma_f32_16x16x32_bf16 v[72:75], v[192:195], a[88:91], v[72:75]
  ds_read_b64_tr_b16 v[180:181], v14 offset:2048
  v_mfma_f32_16x16x32_bf16 v[76:79], v[184:187], a[60:63], v[76:79]
  v_mfma_f32_16x16x32_bf16 v[76:79], v[188:191], a[76:79], v[76:79]
  ds_read_b64_tr_b16 v[182:183], v14 offset:8192
  v_mfma_f32_16x16x32_bf16 v[76:79], v[192:195], a[92:95], v[76:79]
  s_waitcnt lgkmcnt(6)
  buffer_load_dwordx4 v4, s[4:7], s35 offen offset:2048 lds
  v_mfma_f32_16x16x32_bf16 v[80:83], v[160:163], a[48:51], v[80:83]
  ds_read_b64_tr_b16 v[184:185], v15 offset:0
  v_mfma_f32_16x16x32_bf16 v[80:83], v[164:167], a[64:67], v[80:83]
  v_mfma_f32_16x16x32_bf16 v[80:83], v[168:171], a[80:83], v[80:83]
  s_add_u32 m0, s31, 24576
  ds_read_b64_tr_b16 v[186:187], v15 offset:6144
  v_mfma_f32_16x16x32_bf16 v[84:87], v[160:163], a[52:55], v[84:87]
  buffer_load_dwordx4 v2, s[8:11], s35 offen offset:0 lds
  v_mfma_f32_16x16x32_bf16 v[84:87], v[164:167], a[68:71], v[84:87]
  ds_read_b64_tr_b16 v[188:189], v15 offset:1024
  v_mfma_f32_16x16x32_bf16 v[84:87], v[168:171], a[84:87], v[84:87]
  v_mfma_f32_16x16x32_bf16 v[88:91], v[160:163], a[56:59], v[88:91]
  ds_read_b64_tr_b16 v[190:191], v15 offset:7168
  v_mfma_f32_16x16x32_bf16 v[88:91], v[164:167], a[72:75], v[88:91]
  buffer_load_dwordx4 v3, s[8:11], s35 offen offset:1024 lds
  v_mfma_f32_16x16x32_bf16 v[88:91], v[168:171], a[88:91], v[88:91]
  ds_read_b64_tr_b16 v[192:193], v15 offset:2048
  v_mfma_f32_16x16x32_bf16 v[92:95], v[160:163], a[60:63], v[92:95]
  v_mfma_f32_16x16x32_bf16 v[92:95], v[164:167], a[76:79], v[92:95]
  s_waitcnt lgkmcnt(5) vmcnt(24)
  ds_read_b64_tr_b16 v[194:195], v15 offset:8192
  v_mfma_f32_16x16x32_bf16 v[92:95], v[168:171], a[92:95], v[92:95]
  s_barrier
  v_mfma_f32_16x16x32_bf16 v[96:99], v[172:175], a[48:51], v[96:99]
  ds_read_b64_tr_b16 v[160:161], v14 offset:12288
  ds_read_b128 a[96:99], v220 offset:49152
  v_mfma_f32_16x16x32_bf16 v[96:99], v[176:179], a[64:67], v[96:99]
  ds_read_b128 a[112:115], v220 offset:53248
  v_mfma_f32_16x16x32_bf16 v[96:99], v[180:183], a[80:83], v[96:99]
  ds_read_b64_tr_b16 v[162:163], v14 offset:18432
  ds_read_b128 a[128:131], v220 offset:57344
  v_mfma_f32_16x16x32_bf16 v[100:103], v[172:175], a[52:55], v[100:103]
  buffer_load_dwordx4 v4, s[8:11], s35 offen offset:2048 lds
  v_mfma_f32_16x16x32_bf16 v[100:103], v[176:179], a[68:71], v[100:103]
  ds_read_b64_tr_b16 v[164:165], v14 offset:13312
  ds_read_b128 a[100:103], v220 offset:50176
  v_mfma_f32_16x16x32_bf16 v[100:103], v[180:183], a[84:87], v[100:103]
  s_add_u32 s35, s32, 3538944
  ds_read_b128 a[116:119], v220 offset:54272
  v_mfma_f32_16x16x32_bf16 v[104:107], v[172:175], a[56:59], v[104:107]
  s_add_u32 m0, s31, 36864
  ds_read_b64_tr_b16 v[166:167], v14 offset:19456
  ds_read_b128 a[132:135], v220 offset:58368
  s_waitcnt vmcnt(10)
  v_add_u32 v11, 122880, v12
  s_lshl_b32 s38, s25, 8
  s_add_u32 s38, s38, 159744
  v_mfma_f32_16x16x32_bf16 v[104:107], v[176:179], a[72:75], v[104:107]
  buffer_load_dwordx4 v2, s[4:7], s35 offen offset:0 lds
  v_add_u32 v221, 122880, v13
  v_and_b32 v198, 15, v1
  v_mfma_f32_16x16x32_bf16 v[104:107], v[180:183], a[88:91], v[104:107]
  ds_read_b64_tr_b16 v[168:169], v14 offset:14336
  ds_read_b128 a[104:107], v220 offset:51200
  v_lshl_add_u32 v199, v198, 4, s38
  v_mfma_f32_16x16x32_bf16 v[108:111], v[172:175], a[60:63], v[108:111]
  ds_read_b128 a[120:123], v220 offset:55296
  v_lshl_add_u32 v198, v198, 2, s38
  v_add_f32 v204, v204, v208
  v_mfma_f32_16x16x32_bf16 v[108:111], v[176:179], a[76:79], v[108:111]
  ds_read_b64_tr_b16 v[170:171], v14 offset:20480
  ds_read_b128 a[136:139], v220 offset:59392
  v_add_f32 v212, v212, v216
  v_mfma_f32_16x16x32_bf16 v[108:111], v[180:183], a[92:95], v[108:111]
  s_waitcnt lgkmcnt(15)
  buffer_load_dwordx4 v3, s[4:7], s35 offen offset:1024 lds
  v_add_f32 v204, v204, v212
  v_mov_b32 v200, v204
  v_mfma_f32_16x16x32_bf16 v[112:115], v[184:187], a[48:51], v[112:115]
  ds_read_b64_tr_b16 v[172:173], v15 offset:12288
  ds_read_b128 a[108:111], v220 offset:52224
  v_add_f32 v205, v205, v209
  v_mfma_f32_16x16x32_bf16 v[112:115], v[188:191], a[64:67], v[112:115]
  ds_read_b128 a[124:127], v220 offset:56320
  v_permlane32_swap_b32 v200, v204
  v_add_f32 v204, v204, v200
  v_mfma_f32_16x16x32_bf16 v[112:115], v[192:195], a[80:83], v[112:115]
  ds_read_b64_tr_b16 v[174:175], v15 offset:18432
  ds_read_b128 a[140:143], v220 offset:60416
  v_mov_b32 v200, v204
  v_mfma_f32_16x16x32_bf16 v[116:119], v[184:187], a[52:55], v[116:119]
  buffer_load_dwordx4 v4, s[4:7], s35 offen offset:2048 lds
  v_add_f32 v213, v213, v217
  v_add_f32 v205, v205, v213
  v_mfma_f32_16x16x32_bf16 v[116:119], v[188:191], a[68:71], v[116:119]
  ds_read_b64_tr_b16 v[176:177], v15 offset:13312
  v_permlane16_swap_b32 v200, v204
  v_add_f32 v204, v204, v200
  v_mfma_f32_16x16x32_bf16 v[116:119], v[192:195], a[84:87], v[116:119]
  v_mul_f32 v204, 0x3ae38e39, v204
  v_cvt_pk_bf16_f32 v204, v204, v204
  v_lshlrev_b32 v204, 16, v204
  v_mfma_f32_16x16x32_bf16 v[120:123], v[184:187], a[56:59], v[120:123]
  s_add_u32 m0, s31, 49152
  ds_read_b64_tr_b16 v[178:179], v15 offset:19456
  v_add_f32 v204, 0x3727c5ac, v204
  v_cvt_pk_bf16_f32 v204, v204, v204
  v_mfma_f32_16x16x32_bf16 v[120:123], v[188:191], a[72:75], v[120:123]
  buffer_load_dwordx4 v2, s[8:11], s35 offen offset:0 lds
  v_lshlrev_b32 v204, 16, v204
  v_mov_b32 v201, v205
  v_mfma_f32_16x16x32_bf16 v[120:123], v[192:195], a[88:91], v[120:123]
  ds_read_b64_tr_b16 v[180:181], v15 offset:14336
  v_sqrt_f32 v204, v204
  v_mfma_f32_16x16x32_bf16 v[124:127], v[184:187], a[60:63], v[124:127]
  v_permlane32_swap_b32 v201, v205
  v_add_f32 v205, v205, v201
  v_mov_b32 v201, v205
  v_mfma_f32_16x16x32_bf16 v[124:127], v[188:191], a[76:79], v[124:127]
  s_waitcnt lgkmcnt(3) vmcnt(20)
  ds_read_b64_tr_b16 v[182:183], v15 offset:20480
  v_cvt_pk_bf16_f32 v204, v204, v204
  v_mfma_f32_16x16x32_bf16 v[124:127], v[192:195], a[92:95], v[124:127]
  s_barrier
  v_mfma_f32_16x16x32_bf16 v[32:35], v[160:163], a[96:99], v[32:35]
  ds_read_b64_tr_b16 v[184:185], v12 offset:0
  v_lshlrev_b32 v204, 16, v204
  v_mfma_f32_16x16x32_bf16 v[32:35], v[164:167], a[112:115], v[32:35]
  s_add_u32 s36, s28, 61440
  v_rcp_f32 v204, v204
  v_permlane16_swap_b32 v201, v205
  v_mfma_f32_16x16x32_bf16 v[32:35], v[168:171], a[128:131], v[32:35]
  s_add_u32 m0, s39, 49152
  ds_read_b64_tr_b16 v[186:187], v12 offset:6144
  v_add_f32 v205, v205, v201
  v_mfma_f32_16x16x32_bf16 v[36:39], v[160:163], a[100:103], v[36:39]
  buffer_load_dwordx4 v20, s[16:19], s36 offen offset:0 sc1 lds
  v_mul_f32 v205, 0x3ae38e39, v205
  v_mfma_f32_16x16x32_bf16 v[36:39], v[164:167], a[116:119], v[36:39]
  ds_read_b64_tr_b16 v[188:189], v12 offset:1024
  v_cvt_pk_bf16_f32 v205, v205, v205
  v_mfma_f32_16x16x32_bf16 v[36:39], v[168:171], a[132:135], v[36:39]
  v_lshlrev_b32 v205, 16, v205
  v_add_f32 v205, 0x3727c5ac, v205
  v_mfma_f32_16x16x32_bf16 v[40:43], v[160:163], a[104:107], v[40:43]
  ds_read_b64_tr_b16 v[190:191], v12 offset:7168
  v_cvt_pk_bf16_f32 v205, v205, v205
  v_mfma_f32_16x16x32_bf16 v[40:43], v[164:167], a[120:123], v[40:43]
  buffer_load_dwordx4 v20, s[16:19], s36 offen offset:1024 sc1 lds
  v_lshlrev_b32 v205, 16, v205
  v_mfma_f32_16x16x32_bf16 v[40:43], v[168:171], a[136:139], v[40:43]
  ds_read_b64_tr_b16 v[192:193], v12 offset:2048
  v_sqrt_f32 v205, v205
  v_mfma_f32_16x16x32_bf16 v[44:47], v[160:163], a[108:111], v[44:47]
  v_add_f32 v206, v206, v210
  v_add_f32 v214, v214, v218
  v_mfma_f32_16x16x32_bf16 v[44:47], v[164:167], a[124:127], v[44:47]
  ds_read_b64_tr_b16 v[194:195], v12 offset:8192
  v_cvt_pk_bf16_f32 v205, v205, v205
  v_mfma_f32_16x16x32_bf16 v[44:47], v[168:171], a[140:143], v[44:47]
  s_waitcnt lgkmcnt(6)
  buffer_load_dwordx4 v20, s[16:19], s36 offen offset:2048 sc1 lds
  v_lshlrev_b32 v205, 16, v205
  v_mfma_f32_16x16x32_bf16 v[48:51], v[172:175], a[96:99], v[48:51]
  ds_read_b64_tr_b16 v[160:161], v13 offset:0
  v_add_f32 v206, v206, v214
  v_mfma_f32_16x16x32_bf16 v[48:51], v[176:179], a[112:115], v[48:51]
  s_add_u32 s36, s28, 64512
  v_rcp_f32 v205, v205
  v_mfma_f32_16x16x32_bf16 v[48:51], v[180:183], a[128:131], v[48:51]
  s_add_u32 m0, s39, 52224
  ds_read_b64_tr_b16 v[162:163], v13 offset:6144
  v_mov_b32 v202, v206
  v_mfma_f32_16x16x32_bf16 v[52:55], v[172:175], a[100:103], v[52:55]
  buffer_load_dwordx4 v20, s[16:19], s36 offen offset:0 sc1 lds
  v_add_f32 v207, v207, v211
  v_add_f32 v215, v215, v219
  v_mfma_f32_16x16x32_bf16 v[52:55], v[176:179], a[116:119], v[52:55]
  ds_read_b64_tr_b16 v[164:165], v13 offset:1024
  v_permlane32_swap_b32 v202, v206
  v_mfma_f32_16x16x32_bf16 v[52:55], v[180:183], a[132:135], v[52:55]
  v_add_f32 v206, v206, v202
  v_mov_b32 v202, v206
  v_mfma_f32_16x16x32_bf16 v[56:59], v[172:175], a[104:107], v[56:59]
  ds_read_b64_tr_b16 v[166:167], v13 offset:7168
  v_add_f32 v207, v207, v215
  v_mfma_f32_16x16x32_bf16 v[56:59], v[176:179], a[120:123], v[56:59]
  buffer_load_dwordx4 v20, s[16:19], s36 offen offset:1024 sc1 lds
  v_permlane16_swap_b32 v202, v206
  v_mfma_f32_16x16x32_bf16 v[56:59], v[180:183], a[136:139], v[56:59]
  ds_read_b64_tr_b16 v[168:169], v13 offset:2048
  v_add_f32 v206, v206, v202
  v_mfma_f32_16x16x32_bf16 v[60:63], v[172:175], a[108:111], v[60:63]
  v_mul_f32 v206, 0x3ae38e39, v206
  v_cvt_pk_bf16_f32 v206, v206, v206
  v_lshlrev_b32 v206, 16, v206
  v_mfma_f32_16x16x32_bf16 v[60:63], v[176:179], a[124:127], v[60:63]
  s_waitcnt lgkmcnt(5) vmcnt(12)
  ds_read_b64_tr_b16 v[170:171], v13 offset:8192
  v_add_f32 v206, 0x3727c5ac, v206
  v_mfma_f32_16x16x32_bf16 v[60:63], v[180:183], a[140:143], v[60:63]
  s_barrier
  v_mfma_f32_16x16x32_bf16 v[64:67], v[184:187], a[96:99], v[64:67]
  ds_read_b64_tr_b16 v[172:173], v12 offset:12288
  ds_read_b128 a[144:147], v220 offset:0
  v_mfma_f32_16x16x32_bf16 v[64:67], v[188:191], a[112:115], v[64:67]
  ds_read_b128 a[160:163], v220 offset:4096
  v_cvt_pk_bf16_f32 v206, v206, v206
  v_mfma_f32_16x16x32_bf16 v[64:67], v[192:195], a[128:131], v[64:67]
  ds_read_b64_tr_b16 v[174:175], v12 offset:18432
  ds_read_b128 a[176:179], v220 offset:8192
  v_mfma_f32_16x16x32_bf16 v[68:71], v[184:187], a[100:103], v[68:71]
  buffer_load_dwordx4 v20, s[16:19], s36 offen offset:2048 sc1 lds
  v_lshlrev_b32 v206, 16, v206
  v_mfma_f32_16x16x32_bf16 v[68:71], v[188:191], a[116:119], v[68:71]
  ds_read_b64_tr_b16 v[176:177], v12 offset:13312
  ds_read_b128 a[148:151], v220 offset:1024
  v_mov_b32 v203, v207
  v_mfma_f32_16x16x32_bf16 v[68:71], v[192:195], a[132:135], v[68:71]
  ds_read_b128 a[164:167], v220 offset:5120
  v_mfma_f32_16x16x32_bf16 v[72:75], v[184:187], a[104:107], v[72:75]
  s_add_u32 m0, s31, 49152
  ds_read_b64_tr_b16 v[178:179], v12 offset:19456
  ds_read_b128 a[180:183], v220 offset:9216
  v_mfma_f32_16x16x32_bf16 v[72:75], v[188:191], a[120:123], v[72:75]
  buffer_load_dwordx4 v3, s[8:11], s35 offen offset:1024 lds
  v_permlane32_swap_b32 v203, v207
  v_mfma_f32_16x16x32_bf16 v[72:75], v[192:195], a[136:139], v[72:75]
  ds_read_b64_tr_b16 v[180:181], v12 offset:14336
  ds_read_b128 a[152:155], v220 offset:2048
  v_mfma_f32_16x16x32_bf16 v[76:79], v[184:187], a[108:111], v[76:79]
  ds_read_b128 a[168:171], v220 offset:6144
  v_add_f32 v207, v207, v203
  v_mfma_f32_16x16x32_bf16 v[76:79], v[188:191], a[124:127], v[76:79]
  ds_read_b64_tr_b16 v[182:183], v12 offset:20480
  ds_read_b128 a[184:187], v220 offset:10240
  v_mov_b32 v203, v207
  v_mfma_f32_16x16x32_bf16 v[76:79], v[192:195], a[140:143], v[76:79]
  s_waitcnt lgkmcnt(15)
  buffer_load_dwordx4 v4, s[8:11], s35 offen offset:2048 lds
  v_mfma_f32_16x16x32_bf16 v[80:83], v[160:163], a[96:99], v[80:83]
  ds_read_b64_tr_b16 v[184:185], v13 offset:12288
  ds_read_b128 a[156:159], v220 offset:3072
  v_mfma_f32_16x16x32_bf16 v[80:83], v[164:167], a[112:115], v[80:83]
  s_add_u32 s35, s32, 4423680
  ds_read_b128 a[172:175], v220 offset:7168
  v_permlane16_swap_b32 v203, v207
  v_mfma_f32_16x16x32_bf16 v[80:83], v[168:171], a[128:131], v[80:83]
  s_add_u32 m0, s31, 61440
  ds_read_b64_tr_b16 v[186:187], v13 offset:18432
  ds_read_b128 a[188:191], v220 offset:11264
  v_mfma_f32_16x16x32_bf16 v[84:87], v[160:163], a[100:103], v[84:87]
  buffer_load_dwordx4 v2, s[4:7], s35 offen offset:0 lds
  v_add_f32 v207, v207, v203
  v_mfma_f32_16x16x32_bf16 v[84:87], v[164:167], a[116:119], v[84:87]
  ds_read_b64_tr_b16 v[188:189], v13 offset:13312
  v_mul_f32 v207, 0x3ae38e39, v207
  v_mfma_f32_16x16x32_bf16 v[84:87], v[168:171], a[132:135], v[84:87]
  v_sqrt_f32 v206, v206
  v_cvt_pk_bf16_f32 v207, v207, v207
  v_mfma_f32_16x16x32_bf16 v[88:91], v[160:163], a[104:107], v[88:91]
  ds_read_b64_tr_b16 v[190:191], v13 offset:19456
  v_lshlrev_b32 v207, 16, v207
  v_mfma_f32_16x16x32_bf16 v[88:91], v[164:167], a[120:123], v[88:91]
  buffer_load_dwordx4 v3, s[4:7], s35 offen offset:1024 lds
  v_cvt_pk_bf16_f32 v206, v206, v206
  v_mfma_f32_16x16x32_bf16 v[88:91], v[168:171], a[136:139], v[88:91]
  ds_read_b64_tr_b16 v[192:193], v13 offset:14336
  v_lshlrev_b32 v206, 16, v206
  v_mfma_f32_16x16x32_bf16 v[92:95], v[160:163], a[108:111], v[92:95]
  v_rcp_f32 v206, v206
  v_mfma_f32_16x16x32_bf16 v[92:95], v[164:167], a[124:127], v[92:95]
  s_waitcnt lgkmcnt(3) vmcnt(14)
  ds_read_b64_tr_b16 v[194:195], v13 offset:20480
  v_add_f32 v207, 0x3727c5ac, v207
  v_mfma_f32_16x16x32_bf16 v[92:95], v[168:171], a[140:143], v[92:95]
  s_barrier
  v_mfma_f32_16x16x32_bf16 v[32:35], v[172:175], a[144:147], v[32:35]
  ds_read_b64_tr_b16 v[160:161], v12 offset:24576
  v_cvt_pk_bf16_f32 v207, v207, v207
  v_lshlrev_b32 v207, 16, v207
  v_mfma_f32_16x16x32_bf16 v[32:35], v[176:179], a[160:163], v[32:35]
  v_sqrt_f32 v207, v207
  v_mfma_f32_16x16x32_bf16 v[32:35], v[180:183], a[176:179], v[32:35]
  ds_read_b64_tr_b16 v[162:163], v12 offset:30720
  v_mfma_f32_16x16x32_bf16 v[36:39], v[172:175], a[148:151], v[36:39]
  buffer_load_dwordx4 v4, s[4:7], s35 offen offset:2048 lds
  v_cvt_pk_bf16_f32 v207, v207, v207
  v_mfma_f32_16x16x32_bf16 v[36:39], v[176:179], a[164:167], v[36:39]
  ds_read_b64_tr_b16 v[164:165], v12 offset:25600
  v_lshlrev_b32 v207, 16, v207
  v_mfma_f32_16x16x32_bf16 v[36:39], v[180:183], a[180:183], v[36:39]
  v_rcp_f32 v207, v207
  v_mfma_f32_16x16x32_bf16 v[40:43], v[172:175], a[152:155], v[40:43]
  s_add_u32 m0, s31, 73728
  ds_read_b64_tr_b16 v[166:167], v12 offset:31744
  v_mfma_f32_16x16x32_bf16 v[40:43], v[176:179], a[168:171], v[40:43]
  buffer_load_dwordx4 v2, s[8:11], s35 offen offset:0 lds
  ds_write_b128 v199, v[204:207]
  v_mfma_f32_16x16x32_bf16 v[40:43], v[180:183], a[184:187], v[40:43]
  ds_read_b64_tr_b16 v[168:169], v12 offset:26624
  v_mfma_f32_16x16x32_bf16 v[44:47], v[172:175], a[156:159], v[44:47]
  ds_read_b32 v208, v198 offset:0
  v_mfma_f32_16x16x32_bf16 v[44:47], v[176:179], a[172:175], v[44:47]
  ds_read_b64_tr_b16 v[170:171], v12 offset:32768
  v_mfma_f32_16x16x32_bf16 v[44:47], v[180:183], a[188:191], v[44:47]
  s_waitcnt lgkmcnt(8)
  buffer_load_dwordx4 v3, s[8:11], s35 offen offset:1024 lds
  ds_read_b32 v209, v198 offset:64
  v_mfma_f32_16x16x32_bf16 v[48:51], v[184:187], a[144:147], v[48:51]
  ds_read_b64_tr_b16 v[172:173], v13 offset:24576
  v_mfma_f32_16x16x32_bf16 v[48:51], v[188:191], a[160:163], v[48:51]
  ds_read_b32 v210, v198 offset:128
  v_mfma_f32_16x16x32_bf16 v[48:51], v[192:195], a[176:179], v[48:51]
  ds_read_b64_tr_b16 v[174:175], v13 offset:30720
  v_mfma_f32_16x16x32_bf16 v[52:55], v[184:187], a[148:151], v[52:55]
  buffer_load_dwordx4 v4, s[8:11], s35 offen offset:2048 lds
  ds_read_b32 v211, v198 offset:192
  v_mfma_f32_16x16x32_bf16 v[52:55], v[188:191], a[164:167], v[52:55]
  ds_read_b64_tr_b16 v[176:177], v13 offset:25600
  v_mfma_f32_16x16x32_bf16 v[52:55], v[192:195], a[180:183], v[52:55]
  s_add_u32 s35, s32, 1769600
  v_mfma_f32_16x16x32_bf16 v[56:59], v[184:187], a[152:155], v[56:59]
  s_add_u32 m0, s31, 0
  ds_read_b64_tr_b16 v[178:179], v13 offset:31744
  v_mfma_f32_16x16x32_bf16 v[56:59], v[188:191], a[168:171], v[56:59]
  buffer_load_dwordx4 v2, s[4:7], s35 offen offset:0 lds
  v_mfma_f32_16x16x32_bf16 v[56:59], v[192:195], a[184:187], v[56:59]
  ds_read_b64_tr_b16 v[180:181], v13 offset:26624
  v_mfma_f32_16x16x32_bf16 v[60:63], v[184:187], a[156:159], v[60:63]
  v_mfma_f32_16x16x32_bf16 v[60:63], v[188:191], a[172:175], v[60:63]
  s_waitcnt lgkmcnt(8) vmcnt(16)
  ds_read_b64_tr_b16 v[182:183], v13 offset:32768
  v_mfma_f32_16x16x32_bf16 v[60:63], v[192:195], a[188:191], v[60:63]
  s_barrier
  v_mfma_f32_16x16x32_bf16 v[64:67], v[160:163], a[144:147], v[64:67]
  ds_read_b64_tr_b16 v[184:185], v12 offset:36864
  ds_read_b128 a[192:195], v220 offset:24576
  v_mfma_f32_16x16x32_bf16 v[64:67], v[164:167], a[160:163], v[64:67]
  ds_read2st64_b64 a[208:211], v0 offset0:56 offset1:57
  v_mfma_f32_16x16x32_bf16 v[64:67], v[168:171], a[176:179], v[64:67]
  ds_read_b64_tr_b16 v[186:187], v12 offset:43008
  ds_read_b128 a[224:227], v220 offset:32768
  v_mfma_f32_16x16x32_bf16 v[68:71], v[160:163], a[148:151], v[68:71]
  buffer_load_dwordx4 v3, s[4:7], s35 offen offset:1024 lds
  v_mfma_f32_16x16x32_bf16 v[68:71], v[164:167], a[164:167], v[68:71]
  ds_read_b64_tr_b16 v[188:189], v12 offset:37888
  ds_read_b128 a[196:199], v220 offset:25600
  v_mfma_f32_16x16x32_bf16 v[68:71], v[168:171], a[180:183], v[68:71]
  ds_read2st64_b64 a[212:215], v0 offset0:58 offset1:59
  v_mfma_f32_16x16x32_bf16 v[72:75], v[160:163], a[152:155], v[72:75]
  ds_read_b64_tr_b16 v[190:191], v12 offset:44032
  ds_read_b128 a[228:231], v220 offset:33792
  v_mfma_f32_16x16x32_bf16 v[72:75], v[164:167], a[168:171], v[72:75]
  buffer_load_dwordx4 v4, s[4:7], s35 offen offset:2048 lds
  v_mfma_f32_16x16x32_bf16 v[72:75], v[168:171], a[184:187], v[72:75]
  ds_read_b64_tr_b16 v[192:193], v12 offset:38912
  ds_read_b128 a[200:203], v220 offset:26624
  v_mfma_f32_16x16x32_bf16 v[76:79], v[160:163], a[156:159], v[76:79]
  s_add_u32 s35, s32, 2654336
  ds_read2st64_b64 a[216:219], v0 offset0:60 offset1:61
  v_mfma_f32_16x16x32_bf16 v[76:79], v[164:167], a[172:175], v[76:79]
  s_add_u32 m0, s31, 86016
  ds_read_b64_tr_b16 v[194:195], v12 offset:45056
  ds_read_b128 a[232:235], v220 offset:34816
  v_mfma_f32_16x16x32_bf16 v[76:79], v[168:171], a[188:191], v[76:79]
  s_waitcnt lgkmcnt(15)
  buffer_load_dwordx4 v2, s[4:7], s35 offen offset:0 lds
  v_mfma_f32_16x16x32_bf16 v[80:83], v[172:175], a[144:147], v[80:83]
  ds_read_b64_tr_b16 v[160:161], v13 offset:36864
  ds_read_b128 a[204:207], v220 offset:27648
  v_mfma_f32_16x16x32_bf16 v[80:83], v[176:179], a[160:163], v[80:83]
  ds_read2st64_b64 a[220:223], v0 offset0:62 offset1:63
  v_mfma_f32_16x16x32_bf16 v[80:83], v[180:183], a[176:179], v[80:83]
  ds_read_b64_tr_b16 v[162:163], v13 offset:43008
  ds_read_b128 a[236:239], v220 offset:35840
  s_waitcnt lgkmcnt(15)
  v_mul_f32 v24, 0xc0135761, v208
  v_mfma_f32_16x16x32_bf16 v[84:87], v[172:175], a[148:151], v[84:87]
  buffer_load_dwordx4 v3, s[4:7], s35 offen offset:1024 lds
  v_mul_f32 v208, v208, v208
  v_mul_f32 v208, 0x3d372713, v208
  v_mfma_f32_16x16x32_bf16 v[84:87], v[176:179], a[164:167], v[84:87]
  ds_read_b64_tr_b16 v[164:165], v13 offset:37888
  v_mul_f32 v28, v24, v208
  v_mul_f32 v25, 0xc0135761, v209
  v_mfma_f32_16x16x32_bf16 v[84:87], v[180:183], a[180:183], v[84:87]
  v_mul_f32 v209, v209, v209
  v_mul_f32 v209, 0x3d372713, v209
  v_mul_f32 v29, v25, v209
  v_mfma_f32_16x16x32_bf16 v[88:91], v[172:175], a[152:155], v[88:91]
  ds_read_b64_tr_b16 v[166:167], v13 offset:44032
  v_mul_f32 v26, 0xc0135761, v210
  v_mul_f32 v210, v210, v210
  v_mfma_f32_16x16x32_bf16 v[88:91], v[176:179], a[168:171], v[88:91]
  buffer_load_dwordx4 v4, s[4:7], s35 offen offset:2048 lds
  v_mul_f32 v210, 0x3d372713, v210
  v_mul_f32 v30, v26, v210
  v_mfma_f32_16x16x32_bf16 v[88:91], v[180:183], a[184:187], v[88:91]
  ds_read_b64_tr_b16 v[168:169], v13 offset:38912
  v_mul_f32 v27, 0xc0135761, v211
  v_mfma_f32_16x16x32_bf16 v[92:95], v[172:175], a[156:159], v[92:95]
  v_mul_f32 v211, v211, v211
  v_mul_f32 v211, 0x3d372713, v211
  v_mfma_f32_16x16x32_bf16 v[92:95], v[176:179], a[172:175], v[92:95]
  s_waitcnt lgkmcnt(3) vmcnt(12)
  ds_read_b64_tr_b16 v[170:171], v13 offset:45056
  v_mul_f32 v31, v27, v211
  v_mfma_f32_16x16x32_bf16 v[92:95], v[180:183], a[188:191], v[92:95]
  s_barrier
  v_mfma_f32_16x16x32_bf16 v[32:35], v[184:187], a[192:195], v[32:35]
  ds_read_b64_tr_b16 v[172:173], v12 offset:49152
  v_mfma_f32_16x16x32_bf16 v[32:35], v[188:191], a[208:211], v[32:35]
  s_add_u32 s35, s32, 3539072
  v_mfma_f32_16x16x32_bf16 v[32:35], v[192:195], a[224:227], v[32:35]
L_st_a000:
  s_cbranch_execz L_st_b000
  s_add_u32 m0, s31, 98304
  ds_read_b64_tr_b16 v[174:175], v12 offset:55296
  v_mfma_f32_16x16x32_bf16 v[36:39], v[184:187], a[196:199], v[36:39]
  buffer_load_dwordx4 v2, s[4:7], s35 offen offset:0 lds
  v_mfma_f32_16x16x32_bf16 v[36:39], v[188:191], a[212:215], v[36:39]
  ds_read_b64_tr_b16 v[176:177], v12 offset:50176
  v_mfma_f32_16x16x32_bf16 v[36:39], v[192:195], a[228:231], v[36:39]
  v_mfma_f32_16x16x32_bf16 v[40:43], v[184:187], a[200:203], v[40:43]
  ds_read_b64_tr_b16 v[178:179], v12 offset:56320
  v_mfma_f32_16x16x32_bf16 v[40:43], v[188:191], a[216:219], v[40:43]
  buffer_load_dwordx4 v3, s[4:7], s35 offen offset:1024 lds
  v_mfma_f32_16x16x32_bf16 v[40:43], v[192:195], a[232:235], v[40:43]
  ds_read_b64_tr_b16 v[180:181], v12 offset:51200
  v_mfma_f32_16x16x32_bf16 v[44:47], v[184:187], a[204:207], v[44:47]
  v_mfma_f32_16x16x32_bf16 v[44:47], v[188:191], a[220:223], v[44:47]
  ds_read_b64_tr_b16 v[182:183], v12 offset:57344
  v_mfma_f32_16x16x32_bf16 v[44:47], v[192:195], a[236:239], v[44:47]
  s_waitcnt lgkmcnt(6)
  buffer_load_dwordx4 v4, s[4:7], s35 offen offset:2048 lds
  v_mfma_f32_16x16x32_bf16 v[48:51], v[160:163], a[192:195], v[48:51]
  ds_read_b64_tr_b16 v[184:185], v13 offset:49152
  v_mfma_f32_16x16x32_bf16 v[48:51], v[164:167], a[208:211], v[48:51]
  s_add_u32 s35, s32, 4423808
  v_mfma_f32_16x16x32_bf16 v[48:51], v[168:171], a[224:227], v[48:51]
  s_add_u32 m0, s31, 12288
  ds_read_b64_tr_b16 v[186:187], v13 offset:55296
  v_mfma_f32_16x16x32_bf16 v[52:55], v[160:163], a[196:199], v[52:55]
  buffer_load_dwordx4 v2, s[4:7], s35 offen offset:0 lds
  v_mfma_f32_16x16x32_bf16 v[52:55], v[164:167], a[212:215], v[52:55]
  ds_read_b64_tr_b16 v[188:189], v13 offset:50176
  v_mfma_f32_16x16x32_bf16 v[52:55], v[168:171], a[228:231], v[52:55]
  v_mfma_f32_16x16x32_bf16 v[56:59], v[160:163], a[200:203], v[56:59]
  ds_read_b64_tr_b16 v[190:191], v13 offset:56320
  v_mfma_f32_16x16x32_bf16 v[56:59], v[164:167], a[216:219], v[56:59]
  buffer_load_dwordx4 v3, s[4:7], s35 offen offset:1024 lds
  v_mfma_f32_16x16x32_bf16 v[56:59], v[168:171], a[232:235], v[56:59]
  ds_read_b64_tr_b16 v[192:193], v13 offset:51200
  v_mfma_f32_16x16x32_bf16 v[60:63], v[160:163], a[204:207], v[60:63]
  v_mfma_f32_16x16x32_bf16 v[60:63], v[164:167], a[220:223], v[60:63]
  s_waitcnt lgkmcnt(5) vmcnt(14)
  ds_read_b64_tr_b16 v[194:195], v13 offset:57344
  v_mfma_f32_16x16x32_bf16 v[60:63], v[168:171], a[236:239], v[60:63]
  s_barrier
  v_mfma_f32_16x16x32_bf16 v[64:67], v[172:175], a[192:195], v[64:67]
  ds_read_b64_tr_b16 v[160:161], v14 offset:0
  ds_read_b128 a[240:243], v220 offset:49152
  v_mfma_f32_16x16x32_bf16 v[64:67], v[176:179], a[208:211], v[64:67]
  ds_read_b128 v[224:227], v220 offset:53248
  v_mfma_f32_16x16x32_bf16 v[64:67], v[180:183], a[224:227], v[64:67]
  ds_read_b64_tr_b16 v[162:163], v14 offset:6144
  ds_read_b128 v[240:243], v220 offset:57344
  v_mfma_f32_16x16x32_bf16 v[68:71], v[172:175], a[196:199], v[68:71]
  buffer_load_dwordx4 v4, s[4:7], s35 offen offset:2048 lds
  v_mfma_f32_16x16x32_bf16 v[68:71], v[176:179], a[212:215], v[68:71]
  ds_read_b64_tr_b16 v[164:165], v14 offset:1024
  ds_read_b128 a[244:247], v220 offset:50176
  v_mfma_f32_16x16x32_bf16 v[68:71], v[180:183], a[228:231], v[68:71]
  s_add_u32 s35, s32, 128
  ds_read_b128 v[228:231], v220 offset:54272
  v_mfma_f32_16x16x32_bf16 v[72:75], v[172:175], a[200:203], v[72:75]
  s_add_u32 m0, s31, 24576
  ds_read_b64_tr_b16 v[166:167], v14 offset:7168
  ds_read_b128 v[244:247], v220 offset:58368
  v_mfma_f32_16x16x32_bf16 v[72:75], v[176:179], a[216:219], v[72:75]
  buffer_load_dwordx4 v2, s[8:11], s35 offen offset:0 lds
  v_mfma_f32_16x16x32_bf16 v[72:75], v[180:183], a[232:235], v[72:75]
  ds_read_b64_tr_b16 v[168:169], v14 offset:2048
  ds_read_b128 a[248:251], v220 offset:51200
  v_mfma_f32_16x16x32_bf16 v[76:79], v[172:175], a[204:207], v[76:79]
  ds_read_b128 v[232:235], v220 offset:55296
  v_mfma_f32_16x16x32_bf16 v[76:79], v[176:179], a[220:223], v[76:79]
  ds_read_b64_tr_b16 v[170:171], v14 offset:8192
  ds_read_b128 v[248:251], v220 offset:59392
  v_mfma_f32_16x16x32_bf16 v[76:79], v[180:183], a[236:239], v[76:79]
  s_waitcnt lgkmcnt(15)
  buffer_load_dwordx4 v3, s[8:11], s35 offen offset:1024 lds
  v_mfma_f32_16x16x32_bf16 v[80:83], v[184:187], a[192:195], v[80:83]
  ds_read_b64_tr_b16 v[172:173], v15 offset:0
  ds_read_b128 a[252:255], v220 offset:52224
  v_mfma_f32_16x16x32_bf16 v[80:83], v[188:191], a[208:211], v[80:83]
  ds_read_b128 v[236:239], v220 offset:56320
  v_mfma_f32_16x16x32_bf16 v[80:83], v[192:195], a[224:227], v[80:83]
  ds_read_b64_tr_b16 v[174:175], v15 offset:6144
  ds_read_b128 v[252:255], v220 offset:60416
  v_mfma_f32_16x16x32_bf16 v[84:87], v[184:187], a[196:199], v[84:87]
  buffer_load_dwordx4 v4, s[8:11], s35 offen offset:2048 lds
  v_mfma_f32_16x16x32_bf16 v[84:87], v[188:191], a[212:215], v[84:87]
  ds_read_b64_tr_b16 v[176:177], v15 offset:1024
  v_mfma_f32_16x16x32_bf16 v[84:87], v[192:195], a[228:231], v[84:87]
  s_add_u32 s35, s32, 884864
  v_mfma_f32_16x16x32_bf16 v[88:91], v[184:187], a[200:203], v[88:91]
  s_add_u32 m0, s31, 110592
  ds_read_b64_tr_b16 v[178:179], v15 offset:7168
  v_mfma_f32_16x16x32_bf16 v[88:91], v[188:191], a[216:219], v[88:91]
  buffer_load_dwordx4 v2, s[8:11], s35 offen offset:0 lds
  v_mfma_f32_16x16x32_bf16 v[88:91], v[192:195], a[232:235], v[88:91]
  ds_read_b64_tr_b16 v[180:181], v15 offset:2048
  v_mfma_f32_16x16x32_bf16 v[92:95], v[184:187], a[204:207], v[92:95]
  v_mfma_f32_16x16x32_bf16 v[92:95], v[188:191], a[220:223], v[92:95]
  s_waitcnt lgkmcnt(3) vmcnt(16)
  ds_read_b64_tr_b16 v[182:183], v15 offset:8192
  v_mfma_f32_16x16x32_bf16 v[92:95], v[192:195], a[236:239], v[92:95]
  s_barrier
  v_mfma_f32_16x16x32_bf16 v[32:35], v[160:163], a[240:243], v[32:35]
  ds_read_b64_tr_b16 v[184:185], v14 offset:12288
  v_mfma_f32_16x16x32_bf16 v[32:35], v[164:167], v[224:227], v[32:35]
  v_mfma_f32_16x16x32_bf16 v[32:35], v[168:171], v[240:243], v[32:35]
  ds_read_b64_tr_b16 v[186:187], v14 offset:18432
  v_mfma_f32_16x16x32_bf16 v[36:39], v[160:163], a[244:247], v[36:39]
  buffer_load_dwordx4 v3, s[8:11], s35 offen offset:1024 lds
  v_mfma_f32_16x16x32_bf16 v[36:39], v[164:167], v[228:231], v[36:39]
  ds_read_b64_tr_b16 v[188:189], v14 offset:13312
  v_mfma_f32_16x16x32_bf16 v[36:39], v[168:171], v[244:247], v[36:39]
  v_mfma_f32_16x16x32_bf16 v[40:43], v[160:163], a[248:251], v[40:43]
  ds_read_b64_tr_b16 v[190:191], v14 offset:19456
  v_mfma_f32_16x16x32_bf16 v[40:43], v[164:167], v[232:235], v[40:43]
  buffer_load_dwordx4 v4, s[8:11], s35 offen offset:2048 lds
  v_mfma_f32_16x16x32_bf16 v[40:43], v[168:171], v[248:251], v[40:43]
  ds_read_b64_tr_b16 v[192:193], v14 offset:14336
  v_mfma_f32_16x16x32_bf16 v[44:47], v[160:163], a[252:255], v[44:47]
  s_add_u32 s35, s32, 1769600
  v_mfma_f32_16x16x32_bf16 v[44:47], v[164:167], v[236:239], v[44:47]
  s_add_u32 m0, s31, 36864
  ds_read_b64_tr_b16 v[194:195], v14 offset:20480
  v_mul_f32 v196, v32, v32
  v_mul_f32 v197, v33, v33
  v_mfma_f32_16x16x32_bf16 v[44:47], v[168:171], v[252:255], v[44:47]
  s_waitcnt lgkmcnt(6)
  buffer_load_dwordx4 v2, s[8:11], s35 offen offset:0 lds
  v_mul_f32 v198, v34, v34
  v_mul_f32 v199, v35, v35
  v_mfma_f32_16x16x32_bf16 v[48:51], v[172:175], a[240:243], v[48:51]
  ds_read_b64_tr_b16 v[160:161], v15 offset:12288
  v_fma_f32 v196, v196, v28, v24
  v_fma_f32 v197, v197, v28, v24
  v_mfma_f32_16x16x32_bf16 v[48:51], v[176:179], v[224:227], v[48:51]
  v_fma_f32 v198, v198, v28, v24
  v_fma_f32 v199, v199, v28, v24
  v_mul_f32 v196, v196, v32
  v_mfma_f32_16x16x32_bf16 v[48:51], v[180:183], v[240:243], v[48:51]
  ds_read_b64_tr_b16 v[162:163], v15 offset:18432
  v_exp_f32 v196, v196
  v_mfma_f32_16x16x32_bf16 v[52:55], v[172:175], a[244:247], v[52:55]
  buffer_load_dwordx4 v3, s[8:11], s35 offen offset:1024 lds
  v_mul_f32 v197, v197, v33
  v_mul_f32 v198, v198, v34
  v_mfma_f32_16x16x32_bf16 v[52:55], v[176:179], v[228:231], v[52:55]
  ds_read_b64_tr_b16 v[164:165], v15 offset:13312
  v_exp_f32 v197, v197
  v_mfma_f32_16x16x32_bf16 v[52:55], v[180:183], v[244:247], v[52:55]
  v_exp_f32 v198, v198
  v_mul_f32 v199, v199, v35
  v_mfma_f32_16x16x32_bf16 v[56:59], v[172:175], a[248:251], v[56:59]
  ds_read_b64_tr_b16 v[166:167], v15 offset:19456
  v_exp_f32 v199, v199
  v_mfma_f32_16x16x32_bf16 v[56:59], v[176:179], v[232:235], v[56:59]
  buffer_load_dwordx4 v4, s[8:11], s35 offen offset:2048 lds
  v_add_f32 v196, 1.0, v196
  v_add_f32 v197, 1.0, v197
  v_mfma_f32_16x16x32_bf16 v[56:59], v[180:183], v[248:251], v[56:59]
  ds_read_b64_tr_b16 v[168:169], v15 offset:14336
  v_rcp_f32 v196, v196
  v_mfma_f32_16x16x32_bf16 v[60:63], v[172:175], a[252:255], v[60:63]
  v_rcp_f32 v197, v197
  v_add_f32 v198, 1.0, v198
  v_mfma_f32_16x16x32_bf16 v[60:63], v[176:179], v[236:239], v[60:63]
  s_waitcnt lgkmcnt(5) vmcnt(18)
  ds_read_b64_tr_b16 v[170:171], v15 offset:20480
  v_rcp_f32 v198, v198
  v_mfma_f32_16x16x32_bf16 v[60:63], v[180:183], v[252:255], v[60:63]
  s_barrier
  v_mfma_f32_16x16x32_bf16 v[64:67], v[184:187], a[240:243], v[64:67]
  ds_read_b64_tr_b16 v[172:173], v12 offset:0
  v_add_f32 v199, 1.0, v199
  v_mul_f32 v32, v32, v196
  v_mfma_f32_16x16x32_bf16 v[64:67], v[188:191], v[224:227], v[64:67]
  s_add_u32 s35, s32, 2654336
  v_rcp_f32 v199, v199
  v_mul_f32 v33, v33, v197
  v_mfma_f32_16x16x32_bf16 v[64:67], v[192:195], v[240:243], v[64:67]
  s_add_u32 m0, s31, 49152
  ds_read_b64_tr_b16 v[174:175], v12 offset:6144
  v_mul_f32 v34, v34, v198
  v_mul_f32 v200, v36, v36
  v_mfma_f32_16x16x32_bf16 v[68:71], v[184:187], a[244:247], v[68:71]
  buffer_load_dwordx4 v2, s[8:11], s35 offen offset:0 lds
  v_mul_f32 v35, v35, v199
  v_mfma_f32_16x16x32_bf16 v[68:71], v[188:191], v[228:231], v[68:71]
  ds_read_b64_tr_b16 v[176:177], v12 offset:1024
  v_mul_f32 v201, v37, v37
  v_mfma_f32_16x16x32_bf16 v[68:71], v[192:195], v[244:247], v[68:71]
  v_mul_f32 v202, v38, v38
  v_mul_f32 v203, v39, v39
  v_fma_f32 v200, v200, v29, v25
  v_mfma_f32_16x16x32_bf16 v[72:75], v[184:187], a[248:251], v[72:75]
  ds_read_b64_tr_b16 v[178:179], v12 offset:7168
  v_fma_f32 v201, v201, v29, v25
  v_mfma_f32_16x16x32_bf16 v[72:75], v[188:191], v[232:235], v[72:75]
  buffer_load_dwordx4 v3, s[8:11], s35 offen offset:1024 lds
  v_fma_f32 v202, v202, v29, v25
  v_mfma_f32_16x16x32_bf16 v[72:75], v[192:195], v[248:251], v[72:75]
  ds_read_b64_tr_b16 v[180:181], v12 offset:2048
  v_fma_f32 v203, v203, v29, v25
  v_mfma_f32_16x16x32_bf16 v[76:79], v[184:187], a[252:255], v[76:79]
  v_mul_f32 v200, v200, v36
  v_exp_f32 v200, v200
  v_mfma_f32_16x16x32_bf16 v[76:79], v[188:191], v[236:239], v[76:79]
  ds_read_b64_tr_b16 v[182:183], v12 offset:8192
  v_mul_f32 v201, v201, v37
  v_mfma_f32_16x16x32_bf16 v[76:79], v[192:195], v[252:255], v[76:79]
  s_waitcnt lgkmcnt(6)
  buffer_load_dwordx4 v4, s[8:11], s35 offen offset:2048 lds
  v_mul_f32 v202, v202, v38
  v_mfma_f32_16x16x32_bf16 v[80:83], v[160:163], a[240:243], v[80:83]
  ds_read_b64_tr_b16 v[184:185], v13 offset:0
  v_mul_f32 v203, v203, v39
  v_mfma_f32_16x16x32_bf16 v[80:83], v[164:167], v[224:227], v[80:83]
  s_add_u32 s35, s32, 3539072
  v_exp_f32 v201, v201
  v_mfma_f32_16x16x32_bf16 v[80:83], v[168:171], v[240:243], v[80:83]
  s_add_u32 m0, s31, 135168
  ds_read_b64_tr_b16 v[186:187], v13 offset:6144
  v_exp_f32 v202, v202
  v_mfma_f32_16x16x32_bf16 v[84:87], v[160:163], a[244:247], v[84:87]
  buffer_load_dwordx4 v2, s[8:11], s35 offen offset:0 lds
  v_add_f32 v200, 1.0, v200
  v_mfma_f32_16x16x32_bf16 v[84:87], v[164:167], v[228:231], v[84:87]
  ds_read_b64_tr_b16 v[188:189], v13 offset:1024
  v_add_f32 v201, 1.0, v201
  v_mfma_f32_16x16x32_bf16 v[84:87], v[168:171], v[244:247], v[84:87]
  v_exp_f32 v203, v203
  v_mfma_f32_16x16x32_bf16 v[88:91], v[160:163], a[248:251], v[88:91]
  ds_read_b64_tr_b16 v[190:191], v13 offset:7168
  v_rcp_f32 v200, v200
  v_mfma_f32_16x16x32_bf16 v[88:91], v[164:167], v[232:235], v[88:91]
  buffer_load_dwordx4 v3, s[8:11], s35 offen offset:1024 lds
  v_add_f32 v202, 1.0, v202
  v_mfma_f32_16x16x32_bf16 v[88:91], v[168:171], v[248:251], v[88:91]
  ds_read_b64_tr_b16 v[192:193], v13 offset:2048
  v_add_f32 v203, 1.0, v203
  v_mfma_f32_16x16x32_bf16 v[92:95], v[160:163], a[252:255], v[92:95]
  v_rcp_f32 v201, v201
  v_mfma_f32_16x16x32_bf16 v[92:95], v[164:167], v[236:239], v[92:95]
  s_waitcnt lgkmcnt(5) vmcnt(17)
  ds_read_b64_tr_b16 v[194:195], v13 offset:8192
  v_mul_f32 v36, v36, v200
  v_mfma_f32_16x16x32_bf16 v[92:95], v[168:171], v[252:255], v[92:95]
  s_barrier
  v_mfma_f32_16x16x32_bf16 v[96:99], v[172:175], a[96:99], v[96:99]
  ds_read_b64_tr_b16 v[160:161], v14 offset:24576
  v_min_u32 v0, 17, v1
  v_mul_f32 v37, v37, v201
  v_mfma_f32_16x16x32_bf16 v[96:99], v[176:179], a[112:115], v[96:99]
  v_rcp_f32 v202, v202
  v_mfma_f32_16x16x32_bf16 v[96:99], v[180:183], a[128:131], v[96:99]
  ds_read_b64_tr_b16 v[162:163], v14 offset:30720
  v_mul_u32_u24 v0, 9216, v0
  v_mfma_f32_16x16x32_bf16 v[100:103], v[172:175], a[100:103], v[100:103]
  v_rcp_f32 v203, v203
  v_mul_f32 v38, v38, v202
  v_mfma_f32_16x16x32_bf16 v[100:103], v[176:179], a[116:119], v[100:103]
  ds_read_b64_tr_b16 v[164:165], v14 offset:25600
  v_mul_f32 v196, v40, v40
  v_mfma_f32_16x16x32_bf16 v[100:103], v[180:183], a[132:135], v[100:103]
  buffer_load_dword v220, v0, s[48:51], s52 offen offset:256 nt
  v_mul_f32 v39, v39, v203
  v_mfma_f32_16x16x32_bf16 v[104:107], v[172:175], a[104:107], v[104:107]
  ds_read_b64_tr_b16 v[166:167], v14 offset:31744
  v_mul_f32 v197, v41, v41
  v_mfma_f32_16x16x32_bf16 v[104:107], v[176:179], a[120:123], v[104:107]
  v_mul_f32 v198, v42, v42
  v_mul_f32 v199, v43, v43
  v_mfma_f32_16x16x32_bf16 v[104:107], v[180:183], a[136:139], v[104:107]
  ds_read_b64_tr_b16 v[168:169], v14 offset:26624
  v_fma_f32 v196, v196, v30, v26
  v_fma_f32 v197, v197, v30, v26
  v_mfma_f32_16x16x32_bf16 v[108:111], v[172:175], a[108:111], v[108:111]
  buffer_load_dword v220, v0, s[48:51], s52 offen offset:256 sc1
  v_fma_f32 v198, v198, v30, v26
  v_mfma_f32_16x16x32_bf16 v[108:111], v[176:179], a[124:127], v[108:111]
  ds_read_b64_tr_b16 v[170:171], v14 offset:32768
  v_fma_f32 v199, v199, v30, v26
  v_mfma_f32_16x16x32_bf16 v[108:111], v[180:183], a[140:143], v[108:111]
  s_waitcnt lgkmcnt(6)
  v_mul_f32 v196, v196, v40
  v_mul_f32 v197, v197, v41
  v_mfma_f32_16x16x32_bf16 v[112:115], v[184:187], a[96:99], v[112:115]
  ds_read_b64_tr_b16 v[172:173], v15 offset:24576
  v_exp_f32 v196, v196
  v_mfma_f32_16x16x32_bf16 v[112:115], v[188:191], a[112:115], v[112:115]
  buffer_load_dword v220, v0, s[48:51], s52 offen offset:384 nt
  v_mul_f32 v198, v198, v42
  v_mfma_f32_16x16x32_bf16 v[112:115], v[192:195], a[128:131], v[112:115]
  ds_read_b64_tr_b16 v[174:175], v15 offset:30720
  v_mul_f32 v199, v199, v43
  v_mfma_f32_16x16x32_bf16 v[116:119], v[184:187], a[100:103], v[116:119]
  v_exp_f32 v197, v197
  v_mfma_f32_16x16x32_bf16 v[116:119], v[188:191], a[116:119], v[116:119]
  ds_read_b64_tr_b16 v[176:177], v15 offset:25600
  v_add_f32 v196, 1.0, v196
  v_mfma_f32_16x16x32_bf16 v[116:119], v[192:195], a[132:135], v[116:119]
  buffer_load_dword v220, v0, s[48:51], s52 offen offset:384 sc1
  v_exp_f32 v198, v198
  v_mfma_f32_16x16x32_bf16 v[120:123], v[184:187], a[104:107], v[120:123]
  ds_read_b64_tr_b16 v[178:179], v15 offset:31744
  v_add_f32 v197, 1.0, v197
  v_mfma_f32_16x16x32_bf16 v[120:123], v[188:191], a[120:123], v[120:123]
  v_exp_f32 v199, v199
  v_mfma_f32_16x16x32_bf16 v[120:123], v[192:195], a[136:139], v[120:123]
  ds_read_b64_tr_b16 v[180:181], v15 offset:26624
  v_add_f32 v198, 1.0, v198
  v_mfma_f32_16x16x32_bf16 v[124:127], v[184:187], a[108:111], v[124:127]
  buffer_load_dword v220, v0, s[48:51], s52 offen offset:512 nt
  v_rcp_f32 v196, v196
  v_mfma_f32_16x16x32_bf16 v[124:127], v[188:191], a[124:127], v[124:127]
  s_waitcnt lgkmcnt(5)
  ds_read_b64_tr_b16 v[182:183], v15 offset:32768
  v_add_f32 v199, 1.0, v199
  v_mfma_f32_16x16x32_bf16 v[124:127], v[192:195], a[140:143], v[124:127]
  v_rcp_f32 v197, v197
  v_mfma_f32_16x16x32_bf16 v[96:99], v[160:163], a[144:147], v[96:99]
  ds_read_b64_tr_b16 v[184:185], v14 offset:36864
  v_mul_f32 v40, v40, v196
  v_mfma_f32_16x16x32_bf16 v[96:99], v[164:167], a[160:163], v[96:99]
  buffer_load_dword v220, v0, s[48:51], s52 offen offset:512 sc1
  v_mul_f32 v41, v41, v197
  v_mfma_f32_16x16x32_bf16 v[96:99], v[168:171], a[176:179], v[96:99]
  ds_read_b64_tr_b16 v[186:187], v14 offset:43008
  v_rcp_f32 v198, v198
  v_mfma_f32_16x16x32_bf16 v[100:103], v[160:163], a[148:151], v[100:103]
  v_rcp_f32 v199, v199
  v_mfma_f32_16x16x32_bf16 v[100:103], v[164:167], a[164:167], v[100:103]
  ds_read_b64_tr_b16 v[188:189], v14 offset:37888
  v_mul_f32 v42, v42, v198
  v_mfma_f32_16x16x32_bf16 v[100:103], v[168:171], a[180:183], v[100:103]
  v_mul_f32 v43, v43, v199
  v_mul_f32 v200, v44, v44
  v_mfma_f32_16x16x32_bf16 v[104:107], v[160:163], a[152:155], v[104:107]
  ds_read_b64_tr_b16 v[190:191], v14 offset:44032
  v_mul_f32 v201, v45, v45
  v_mfma_f32_16x16x32_bf16 v[104:107], v[164:167], a[168:171], v[104:107]
  v_mul_f32 v202, v46, v46
  v_mul_f32 v203, v47, v47
  v_fma_f32 v200, v200, v31, v27
  v_mfma_f32_16x16x32_bf16 v[104:107], v[168:171], a[184:187], v[104:107]
  ds_read_b64_tr_b16 v[192:193], v14 offset:38912
  v_fma_f32 v201, v201, v31, v27
  v_mfma_f32_16x16x32_bf16 v[108:111], v[160:163], a[156:159], v[108:111]
  v_fma_f32 v202, v202, v31, v27
  v_fma_f32 v203, v203, v31, v27
  v_mfma_f32_16x16x32_bf16 v[108:111], v[164:167], a[172:175], v[108:111]
  ds_read_b64_tr_b16 v[194:195], v14 offset:45056
  v_mul_f32 v200, v200, v44
  v_mfma_f32_16x16x32_bf16 v[108:111], v[168:171], a[188:191], v[108:111]
  s_waitcnt lgkmcnt(6)
  v_exp_f32 v200, v200
  v_mul_f32 v201, v201, v45
  v_mfma_f32_16x16x32_bf16 v[112:115], v[172:175], a[144:147], v[112:115]
  ds_read_b64_tr_b16 v[160:161], v15 offset:36864
  v_mul_f32 v202, v202, v46
  v_mfma_f32_16x16x32_bf16 v[112:115], v[176:179], a[160:163], v[112:115]
  v_exp_f32 v201, v201
  v_mfma_f32_16x16x32_bf16 v[112:115], v[180:183], a[176:179], v[112:115]
  ds_read_b64_tr_b16 v[162:163], v15 offset:43008
  v_mul_f32 v203, v203, v47
  v_mfma_f32_16x16x32_bf16 v[116:119], v[172:175], a[148:151], v[116:119]
  v_exp_f32 v202, v202
  v_mfma_f32_16x16x32_bf16 v[116:119], v[176:179], a[164:167], v[116:119]
  ds_read_b64_tr_b16 v[164:165], v15 offset:37888
  v_exp_f32 v203, v203
  v_mfma_f32_16x16x32_bf16 v[116:119], v[180:183], a[180:183], v[116:119]
  v_add_f32 v200, 1.0, v200
  v_add_f32 v201, 1.0, v201
  v_mfma_f32_16x16x32_bf16 v[120:123], v[172:175], a[152:155], v[120:123]
  ds_read_b64_tr_b16 v[166:167], v15 offset:44032
  v_add_f32 v202, 1.0, v202
  v_mfma_f32_16x16x32_bf16 v[120:123], v[176:179], a[168:171], v[120:123]
  v_rcp_f32 v200, v200
  v_mfma_f32_16x16x32_bf16 v[120:123], v[180:183], a[184:187], v[120:123]
  ds_read_b64_tr_b16 v[168:169], v15 offset:38912
  v_rcp_f32 v201, v201
  v_mfma_f32_16x16x32_bf16 v[124:127], v[172:175], a[156:159], v[124:127]
  v_rcp_f32 v202, v202
  v_mfma_f32_16x16x32_bf16 v[124:127], v[176:179], a[172:175], v[124:127]
  s_waitcnt lgkmcnt(5) vmcnt(17)
  ds_read_b64_tr_b16 v[170:171], v15 offset:45056
  v_add_f32 v203, 1.0, v203
  v_mfma_f32_16x16x32_bf16 v[124:127], v[180:183], a[188:191], v[124:127]
  s_barrier
  v_mfma_f32_16x16x32_bf16 v[96:99], v[184:187], a[192:195], v[96:99]
  ds_read_b64_tr_b16 v[172:173], v12 offset:12288
  v_mul_f32 v44, v44, v200
  v_mfma_f32_16x16x32_bf16 v[96:99], v[188:191], a[208:211], v[96:99]
  v_rcp_f32 v203, v203
  v_mul_f32 v45, v45, v201
  v_mfma_f32_16x16x32_bf16 v[96:99], v[192:195], a[224:227], v[96:99]
  ds_read_b64_tr_b16 v[174:175], v12 offset:18432
  v_mul_f32 v46, v46, v202
  v_mfma_f32_16x16x32_bf16 v[100:103], v[184:187], a[196:199], v[100:103]
  v_mul_f32 v47, v47, v203
  v_mul_f32 v196, v48, v48
  v_mfma_f32_16x16x32_bf16 v[100:103], v[188:191], a[212:215], v[100:103]
  ds_read_b64_tr_b16 v[176:177], v12 offset:13312
  v_mul_f32 v197, v49, v49
  v_mfma_f32_16x16x32_bf16 v[100:103], v[192:195], a[228:231], v[100:103]
  v_mul_f32 v198, v50, v50
  v_mul_f32 v199, v51, v51
  v_mfma_f32_16x16x32_bf16 v[104:107], v[184:187], a[200:203], v[104:107]
  ds_read_b64_tr_b16 v[178:179], v12 offset:19456
  v_fma_f32 v196, v196, v28, v24
  v_fma_f32 v197, v197, v28, v24
  v_mfma_f32_16x16x32_bf16 v[104:107], v[188:191], a[216:219], v[104:107]
  v_fma_f32 v198, v198, v28, v24
  v_fma_f32 v199, v199, v28, v24
  v_mfma_f32_16x16x32_bf16 v[104:107], v[192:195], a[232:235], v[104:107]
  ds_read_b64_tr_b16 v[180:181], v12 offset:14336
  v_mul_f32 v196, v196, v48
  v_mfma_f32_16x16x32_bf16 v[108:111], v[184:187], a[204:207], v[108:111]
  v_exp_f32 v196, v196
  v_mfma_f32_16x16x32_bf16 v[108:111], v[188:191], a[220:223], v[108:111]
  ds_read_b64_tr_b16 v[182:183], v12 offset:20480
  v_mul_f32 v197, v197, v49
  v_mul_f32 v198, v198, v50
  v_mfma_f32_16x16x32_bf16 v[108:111], v[192:195], a[236:239], v[108:111]
  s_waitcnt lgkmcnt(6)
  v_exp_f32 v197, v197
  v_mfma_f32_16x16x32_bf16 v[112:115], v[160:163], a[192:195], v[112:115]
  ds_read_b64_tr_b16 v[184:185], v13 offset:12288
  v_mul_f32 v199, v199, v51
  v_mfma_f32_16x16x32_bf16 v[112:115], v[164:167], a[208:211], v[112:115]
  v_exp_f32 v198, v198
  v_mfma_f32_16x16x32_bf16 v[112:115], v[168:171], a[224:227], v[112:115]
  ds_read_b64_tr_b16 v[186:187], v13 offset:18432
  v_add_f32 v196, 1.0, v196
  v_mfma_f32_16x16x32_bf16 v[116:119], v[160:163], a[196:199], v[116:119]
  v_exp_f32 v199, v199
  v_add_f32 v197, 1.0, v197
  v_mfma_f32_16x16x32_bf16 v[116:119], v[164:167], a[212:215], v[116:119]
  ds_read_b64_tr_b16 v[188:189], v13 offset:13312
  v_add_f32 v198, 1.0, v198
  v_mfma_f32_16x16x32_bf16 v[116:119], v[168:171], a[228:231], v[116:119]
  v_rcp_f32 v196, v196
  v_mfma_f32_16x16x32_bf16 v[120:123], v[160:163], a[200:203], v[120:123]
  ds_read_b64_tr_b16 v[190:191], v13 offset:19456
  v_add_f32 v199, 1.0, v199
  v_mfma_f32_16x16x32_bf16 v[120:123], v[164:167], a[216:219], v[120:123]
  v_rcp_f32 v197, v197
  v_mul_f32 v48, v48, v196
  v_mfma_f32_16x16x32_bf16 v[120:123], v[168:171], a[232:235], v[120:123]
  ds_read_b64_tr_b16 v[192:193], v13 offset:14336
  v_mul_f32 v200, v52, v52
  v_mfma_f32_16x16x32_bf16 v[124:127], v[160:163], a[204:207], v[124:127]
  v_rcp_f32 v198, v198
  v_mfma_f32_16x16x32_bf16 v[124:127], v[164:167], a[220:223], v[124:127]
  s_waitcnt lgkmcnt(5)
  ds_read_b64_tr_b16 v[194:195], v13 offset:20480
  v_mul_f32 v49, v49, v197
  v_mfma_f32_16x16x32_bf16 v[124:127], v[168:171], a[236:239], v[124:127]
  v_rcp_f32 v199, v199
  v_mfma_f32_16x16x32_bf16 v[96:99], v[172:175], a[240:243], v[96:99]
  ds_read_b64_tr_b16 v[160:161], v12 offset:24576
  v_mul_f32 v50, v50, v198
  v_mul_f32 v201, v53, v53
  v_mfma_f32_16x16x32_bf16 v[96:99], v[176:179], v[224:227], v[96:99]
  v_mul_f32 v51, v51, v199
  v_mul_f32 v202, v54, v54
  v_mfma_f32_16x16x32_bf16 v[96:99], v[180:183], v[240:243], v[96:99]
  ds_read_b64_tr_b16 v[162:163], v12 offset:30720
  v_mul_f32 v203, v55, v55
  v_mfma_f32_16x16x32_bf16 v[100:103], v[172:175], a[244:247], v[100:103]
  v_fma_f32 v200, v200, v29, v25
  v_fma_f32 v201, v201, v29, v25
  v_mfma_f32_16x16x32_bf16 v[100:103], v[176:179], v[228:231], v[100:103]
  ds_read_b64_tr_b16 v[164:165], v12 offset:25600
  v_fma_f32 v202, v202, v29, v25
  v_mfma_f32_16x16x32_bf16 v[100:103], v[180:183], v[244:247], v[100:103]
  v_fma_f32 v203, v203, v29, v25
  v_mul_f32 v200, v200, v52
  v_mul_f32 v201, v201, v53
  v_mfma_f32_16x16x32_bf16 v[104:107], v[172:175], a[248:251], v[104:107]
  ds_read_b64_tr_b16 v[166:167], v12 offset:31744
  v_mul_f32 v202, v202, v54
  v_mfma_f32_16x16x32_bf16 v[104:107], v[176:179], v[232:235], v[104:107]
  v_exp_f32 v200, v200
  v_mfma_f32_16x16x32_bf16 v[104:107], v[180:183], v[248:251], v[104:107]
  ds_read_b64_tr_b16 v[168:169], v12 offset:26624
  v_mul_f32 v203, v203, v55
  v_mfma_f32_16x16x32_bf16 v[108:111], v[172:175], a[252:255], v[108:111]
  v_exp_f32 v201, v201
  v_add_f32 v200, 1.0, v200
  v_mfma_f32_16x16x32_bf16 v[108:111], v[176:179], v[236:239], v[108:111]
  ds_read_b64_tr_b16 v[170:171], v12 offset:32768
  v_mul_f32 v196, v56, v56
  v_mfma_f32_16x16x32_bf16 v[108:111], v[180:183], v[252:255], v[108:111]
  s_waitcnt lgkmcnt(6)
  v_exp_f32 v202, v202
  v_mfma_f32_16x16x32_bf16 v[112:115], v[184:187], a[240:243], v[112:115]
  ds_read_b64_tr_b16 v[172:173], v13 offset:24576
  v_add_f32 v201, 1.0, v201
  v_mfma_f32_16x16x32_bf16 v[112:115], v[188:191], v[224:227], v[112:115]
  v_exp_f32 v203, v203
  v_mfma_f32_16x16x32_bf16 v[112:115], v[192:195], v[240:243], v[112:115]
  ds_read_b64_tr_b16 v[174:175], v13 offset:30720
  v_rcp_f32 v200, v200
  v_mfma_f32_16x16x32_bf16 v[116:119], v[184:187], a[244:247], v[116:119]
  v_rcp_f32 v201, v201
  v_mfma_f32_16x16x32_bf16 v[116:119], v[188:191], v[228:231], v[116:119]
  ds_read_b64_tr_b16 v[176:177], v13 offset:25600
  v_add_f32 v202, 1.0, v202
  v_mfma_f32_16x16x32_bf16 v[116:119], v[192:195], v[244:247], v[116:119]
  v_rcp_f32 v202, v202
  v_mfma_f32_16x16x32_bf16 v[120:123], v[184:187], a[248:251], v[120:123]
  ds_read_b64_tr_b16 v[178:179], v13 offset:31744
  v_add_f32 v203, 1.0, v203
  v_mul_f32 v52, v52, v200
  v_mfma_f32_16x16x32_bf16 v[120:123], v[188:191], v[232:235], v[120:123]
  v_rcp_f32 v203, v203
  v_mfma_f32_16x16x32_bf16 v[120:123], v[192:195], v[248:251], v[120:123]
  ds_read_b64_tr_b16 v[180:181], v13 offset:26624
  v_mul_f32 v53, v53, v201
  v_mfma_f32_16x16x32_bf16 v[124:127], v[184:187], a[252:255], v[124:127]
  v_mul_f32 v54, v54, v202
  v_mul_f32 v55, v55, v203
  v_mfma_f32_16x16x32_bf16 v[124:127], v[188:191], v[236:239], v[124:127]
  s_waitcnt lgkmcnt(5) vmcnt(11)
  ds_read_b64_tr_b16 v[182:183], v13 offset:32768
  v_mul_f32 v197, v57, v57
  v_mfma_f32_16x16x32_bf16 v[124:127], v[192:195], v[252:255], v[124:127]
  s_barrier
  v_mfma_f32_16x16x32_bf16 v[128:131], v[160:163], a[0:3], 0
  ds_read_b64_tr_b16 v[184:185], v14 offset:49152
  v_mul_f32 v198, v58, v58
  v_mul_f32 v199, v59, v59
  v_mfma_f32_16x16x32_bf16 v[128:131], v[164:167], a[16:19], v[128:131]
  v_fma_f32 v196, v196, v30, v26
  v_fma_f32 v197, v197, v30, v26
  v_mfma_f32_16x16x32_bf16 v[128:131], v[168:171], a[32:35], v[128:131]
  ds_read_b64_tr_b16 v[186:187], v14 offset:55296
  v_fma_f32 v198, v198, v30, v26
  v_mfma_f32_16x16x32_bf16 v[132:135], v[160:163], a[4:7], 0
  buffer_load_dwordx4 v4, s[8:11], s35 offen offset:2048 lds
  v_fma_f32 v199, v199, v30, v26
  v_mfma_f32_16x16x32_bf16 v[132:135], v[164:167], a[20:23], v[132:135]
  ds_read_b64_tr_b16 v[188:189], v14 offset:50176
  v_mul_f32 v196, v196, v56
  v_mul_f32 v197, v197, v57
  v_mfma_f32_16x16x32_bf16 v[132:135], v[168:171], a[36:39], v[132:135]
  s_add_u32 s35, s32, 4423808
  v_exp_f32 v196, v196
  v_mfma_f32_16x16x32_bf16 v[136:139], v[160:163], a[8:11], 0
  s_add_u32 m0, s31, 147456
  ds_read_b64_tr_b16 v[190:191], v14 offset:56320
  v_mul_f32 v198, v198, v58
  v_mfma_f32_16x16x32_bf16 v[136:139], v[164:167], a[24:27], v[136:139]
  buffer_load_dwordx4 v2, s[8:11], s35 offen offset:0 lds
  v_mul_f32 v199, v199, v59
  v_mfma_f32_16x16x32_bf16 v[136:139], v[168:171], a[40:43], v[136:139]
  ds_read_b64_tr_b16 v[192:193], v14 offset:51200
  v_exp_f32 v197, v197
  v_mfma_f32_16x16x32_bf16 v[140:143], v[160:163], a[12:15], 0
  v_exp_f32 v198, v198
  v_mfma_f32_16x16x32_bf16 v[140:143], v[164:167], a[28:31], v[140:143]
  ds_read_b64_tr_b16 v[194:195], v14 offset:57344
  v_add_f32 v196, 1.0, v196
  v_mfma_f32_16x16x32_bf16 v[140:143], v[168:171], a[44:47], v[140:143]
  s_waitcnt lgkmcnt(6)
  buffer_load_dwordx4 v3, s[8:11], s35 offen offset:1024 lds
  v_add_f32 v197, 1.0, v197
  v_mfma_f32_16x16x32_bf16 v[144:147], v[172:175], a[0:3], 0
  ds_read_b64_tr_b16 v[160:161], v15 offset:49152
  v_add_f32 v198, 1.0, v198
  v_mfma_f32_16x16x32_bf16 v[144:147], v[176:179], a[16:19], v[144:147]
  v_exp_f32 v199, v199
  v_mul_f32 v200, v60, v60
  v_mfma_f32_16x16x32_bf16 v[144:147], v[180:183], a[32:35], v[144:147]
  ds_read_b64_tr_b16 v[162:163], v15 offset:55296
  v_mul_f32 v201, v61, v61
  v_mfma_f32_16x16x32_bf16 v[148:151], v[172:175], a[4:7], 0
  buffer_load_dwordx4 v4, s[8:11], s35 offen offset:2048 lds
  v_add_f32 v199, 1.0, v199
  v_mfma_f32_16x16x32_bf16 v[148:151], v[176:179], a[20:23], v[148:151]
  ds_read_b64_tr_b16 v[164:165], v15 offset:50176
  v_mul_f32 v202, v62, v62
  v_mfma_f32_16x16x32_bf16 v[148:151], v[180:183], a[36:39], v[148:151]
  s_add_u32 s35, s32, 256
  v_rcp_f32 v196, v196
  v_mfma_f32_16x16x32_bf16 v[152:155], v[172:175], a[8:11], 0
  s_add_u32 m0, s31, 61440
  ds_read_b64_tr_b16 v[166:167], v15 offset:56320
  v_rcp_f32 v197, v197
  v_mfma_f32_16x16x32_bf16 v[152:155], v[176:179], a[24:27], v[152:155]
  buffer_load_dwordx4 v2, s[4:7], s35 offen offset:0 lds
  v_mul_f32 v56, v56, v196
  v_mfma_f32_16x16x32_bf16 v[152:155], v[180:183], a[40:43], v[152:155]
  ds_read_b64_tr_b16 v[168:169], v15 offset:51200
  v_mul_f32 v57, v57, v197
  v_mfma_f32_16x16x32_bf16 v[156:159], v[172:175], a[12:15], 0
  v_rcp_f32 v198, v198
  v_mfma_f32_16x16x32_bf16 v[156:159], v[176:179], a[28:31], v[156:159]
  s_waitcnt lgkmcnt(5)
  ds_read_b64_tr_b16 v[170:171], v15 offset:57344
  v_rcp_f32 v199, v199
  v_mfma_f32_16x16x32_bf16 v[156:159], v[180:183], a[44:47], v[156:159]
  v_mul_f32 v58, v58, v198
  v_mul_f32 v203, v63, v63
  v_mfma_f32_16x16x32_bf16 v[128:131], v[184:187], a[48:51], v[128:131]
  ds_read_b64_tr_b16 v[172:173], v12 offset:36864
  v_mul_f32 v59, v59, v199
  v_mfma_f32_16x16x32_bf16 v[128:131], v[188:191], a[64:67], v[128:131]
L_st_b000:
  s_cbranch_execz L_st_c000
  v_fma_f32 v200, v200, v31, v27
  v_fma_f32 v201, v201, v31, v27
  v_mfma_f32_16x16x32_bf16 v[128:131], v[192:195], a[80:83], v[128:131]
  ds_read_b64_tr_b16 v[174:175], v12 offset:43008
  v_fma_f32 v202, v202, v31, v27
  v_mfma_f32_16x16x32_bf16 v[132:135], v[184:187], a[52:55], v[132:135]
  buffer_load_dwordx4 v3, s[4:7], s35 offen offset:1024 lds
  v_fma_f32 v203, v203, v31, v27
  v_mul_f32 v200, v200, v60
  v_mfma_f32_16x16x32_bf16 v[132:135], v[188:191], a[68:71], v[132:135]
  ds_read_b64_tr_b16 v[176:177], v12 offset:37888
  v_mul_f32 v201, v201, v61
  v_mfma_f32_16x16x32_bf16 v[132:135], v[192:195], a[84:87], v[132:135]
  v_exp_f32 v200, v200
  v_mfma_f32_16x16x32_bf16 v[136:139], v[184:187], a[56:59], v[136:139]
  ds_read_b64_tr_b16 v[178:179], v12 offset:44032
  v_mul_f32 v202, v202, v62
  v_mfma_f32_16x16x32_bf16 v[136:139], v[188:191], a[72:75], v[136:139]
  buffer_load_dwordx4 v4, s[4:7], s35 offen offset:2048 lds
  v_mul_f32 v203, v203, v63
  v_mfma_f32_16x16x32_bf16 v[136:139], v[192:195], a[88:91], v[136:139]
  ds_read_b64_tr_b16 v[180:181], v12 offset:38912
  v_exp_f32 v201, v201
  v_mfma_f32_16x16x32_bf16 v[140:143], v[184:187], a[60:63], v[140:143]
  s_add_u32 s35, s32, 884992
  v_exp_f32 v202, v202
  v_mfma_f32_16x16x32_bf16 v[140:143], v[188:191], a[76:79], v[140:143]
  s_add_u32 m0, s31, 73728
  ds_read_b64_tr_b16 v[182:183], v12 offset:45056
  v_add_f32 v200, 1.0, v200
  v_mfma_f32_16x16x32_bf16 v[140:143], v[192:195], a[92:95], v[140:143]
  s_waitcnt lgkmcnt(6)
  buffer_load_dwordx4 v2, s[4:7], s35 offen offset:0 lds
  v_add_f32 v201, 1.0, v201
  v_mfma_f32_16x16x32_bf16 v[144:147], v[160:163], a[48:51], v[144:147]
  ds_read_b64_tr_b16 v[184:185], v13 offset:36864
  v_add_f32 v202, 1.0, v202
  v_mfma_f32_16x16x32_bf16 v[144:147], v[164:167], a[64:67], v[144:147]
  v_exp_f32 v203, v203
  v_mul_f32 v64, v64, v32
  v_mfma_f32_16x16x32_bf16 v[144:147], v[168:171], a[80:83], v[144:147]
  ds_read_b64_tr_b16 v[186:187], v13 offset:43008
  v_mul_f32 v65, v65, v33
  v_mfma_f32_16x16x32_bf16 v[148:151], v[160:163], a[52:55], v[148:151]
  buffer_load_dwordx4 v3, s[4:7], s35 offen offset:1024 lds
  v_add_f32 v203, 1.0, v203
  v_mfma_f32_16x16x32_bf16 v[148:151], v[164:167], a[68:71], v[148:151]
  ds_read_b64_tr_b16 v[188:189], v13 offset:37888
  v_mul_f32 v66, v66, v34
  v_mfma_f32_16x16x32_bf16 v[148:151], v[168:171], a[84:87], v[148:151]
  v_rcp_f32 v200, v200
  v_mul_f32 v67, v67, v35
  v_mfma_f32_16x16x32_bf16 v[152:155], v[160:163], a[56:59], v[152:155]
  ds_read_b64_tr_b16 v[190:191], v13 offset:44032
  v_cvt_pk_bf16_f32 v204, v64, v65
  v_mfma_f32_16x16x32_bf16 v[152:155], v[164:167], a[72:75], v[152:155]
  buffer_load_dwordx4 v4, s[4:7], s35 offen offset:2048 lds
  v_mul_f32 v60, v60, v200
  v_mfma_f32_16x16x32_bf16 v[152:155], v[168:171], a[88:91], v[152:155]
  ds_read_b64_tr_b16 v[192:193], v13 offset:38912
  v_cvt_pk_bf16_f32 v205, v66, v67
  v_mfma_f32_16x16x32_bf16 v[156:159], v[160:163], a[60:63], v[156:159]
  v_rcp_f32 v201, v201
  v_mfma_f32_16x16x32_bf16 v[156:159], v[164:167], a[76:79], v[156:159]
  s_waitcnt lgkmcnt(5) vmcnt(9)
  ds_read_b64_tr_b16 v[194:195], v13 offset:45056
  v_rcp_f32 v202, v202
  v_mfma_f32_16x16x32_bf16 v[156:159], v[168:171], a[92:95], v[156:159]
  s_barrier
  v_mfma_f32_16x16x32_bf16 v[128:131], v[172:175], a[96:99], v[128:131]
  ds_read_b64_tr_b16 v[160:161], v12 offset:49152
  v_mul_f32 v61, v61, v201
  v_mfma_f32_16x16x32_bf16 v[128:131], v[176:179], a[112:115], v[128:131]
  s_add_u32 s35, s32, 1769728
  v_rcp_f32 v203, v203
  v_mfma_f32_16x16x32_bf16 v[128:131], v[180:183], a[128:131], v[128:131]
  s_add_u32 m0, s31, 0
  ds_read_b64_tr_b16 v[162:163], v12 offset:55296
  v_mul_f32 v62, v62, v202
  v_mfma_f32_16x16x32_bf16 v[132:135], v[172:175], a[100:103], v[132:135]
  buffer_load_dwordx4 v2, s[4:7], s35 offen offset:0 lds
  v_mul_f32 v63, v63, v203
  v_mul_f32 v80, v80, v48
  v_mfma_f32_16x16x32_bf16 v[132:135], v[176:179], a[116:119], v[132:135]
  ds_read_b64_tr_b16 v[164:165], v12 offset:50176
  v_mul_f32 v81, v81, v49
  v_mfma_f32_16x16x32_bf16 v[132:135], v[180:183], a[132:135], v[132:135]
  v_mul_f32 v82, v82, v50
  v_mul_f32 v83, v83, v51
  v_mfma_f32_16x16x32_bf16 v[136:139], v[172:175], a[104:107], v[136:139]
  ds_read_b64_tr_b16 v[166:167], v12 offset:56320
  v_cvt_pk_bf16_f32 v206, v80, v81
  v_mfma_f32_16x16x32_bf16 v[136:139], v[176:179], a[120:123], v[136:139]
  buffer_load_dwordx4 v3, s[4:7], s35 offen offset:1024 lds
  v_cvt_pk_bf16_f32 v207, v82, v83
  v_mul_f32 v68, v68, v36
  v_mfma_f32_16x16x32_bf16 v[136:139], v[180:183], a[136:139], v[136:139]
  ds_read_b64_tr_b16 v[168:169], v12 offset:51200
  v_mul_f32 v69, v69, v37
  v_mfma_f32_16x16x32_bf16 v[140:143], v[172:175], a[108:111], v[140:143]
  ds_write_b128 v21, v[204:207] offset:0
  v_mfma_f32_16x16x32_bf16 v[140:143], v[176:179], a[124:127], v[140:143]
  ds_read_b64_tr_b16 v[170:171], v12 offset:57344
  v_mul_f32 v70, v70, v38
  v_mfma_f32_16x16x32_bf16 v[140:143], v[180:183], a[140:143], v[140:143]
  s_waitcnt lgkmcnt(7)
  buffer_load_dwordx4 v4, s[4:7], s35 offen offset:2048 lds
  v_mul_f32 v71, v71, v39
  v_mfma_f32_16x16x32_bf16 v[144:147], v[184:187], a[96:99], v[144:147]
  ds_read_b64_tr_b16 v[172:173], v13 offset:49152
  v_cvt_pk_bf16_f32 v208, v68, v69
  v_cvt_pk_bf16_f32 v209, v70, v71
  v_mfma_f32_16x16x32_bf16 v[144:147], v[188:191], a[112:115], v[144:147]
  s_add_u32 s35, s32, 2654464
  v_mul_f32 v84, v84, v52
  v_mul_f32 v85, v85, v53
  v_mfma_f32_16x16x32_bf16 v[144:147], v[192:195], a[128:131], v[144:147]
  s_add_u32 m0, s31, 12288
  ds_read_b64_tr_b16 v[174:175], v13 offset:55296
  v_mul_f32 v86, v86, v54
  v_mfma_f32_16x16x32_bf16 v[148:151], v[184:187], a[100:103], v[148:151]
  buffer_load_dwordx4 v2, s[4:7], s35 offen offset:0 lds
  v_mul_f32 v87, v87, v55
  v_mfma_f32_16x16x32_bf16 v[148:151], v[188:191], a[116:119], v[148:151]
  ds_read_b64_tr_b16 v[176:177], v13 offset:50176
  v_cvt_pk_bf16_f32 v210, v84, v85
  v_mfma_f32_16x16x32_bf16 v[148:151], v[192:195], a[132:135], v[148:151]
  v_cvt_pk_bf16_f32 v211, v86, v87
  ds_write_b128 v21, v[208:211] offset:1024
  v_mfma_f32_16x16x32_bf16 v[152:155], v[184:187], a[104:107], v[152:155]
  ds_read_b64_tr_b16 v[178:179], v13 offset:56320
  v_mul_f32 v72, v72, v40
  v_mfma_f32_16x16x32_bf16 v[152:155], v[188:191], a[120:123], v[152:155]
  buffer_load_dwordx4 v3, s[4:7], s35 offen offset:1024 lds
  v_mul_f32 v73, v73, v41
  v_mfma_f32_16x16x32_bf16 v[152:155], v[192:195], a[136:139], v[152:155]
  ds_read_b64_tr_b16 v[180:181], v13 offset:51200
  v_mul_f32 v74, v74, v42
  v_mfma_f32_16x16x32_bf16 v[156:159], v[184:187], a[108:111], v[156:159]
  v_mul_f32 v75, v75, v43
  v_cvt_pk_bf16_f32 v212, v72, v73
  v_mfma_f32_16x16x32_bf16 v[156:159], v[188:191], a[124:127], v[156:159]
  s_waitcnt lgkmcnt(6)
  ds_read_b64_tr_b16 v[182:183], v13 offset:57344
  v_cvt_pk_bf16_f32 v213, v74, v75
  v_mul_f32 v88, v88, v56
  v_mfma_f32_16x16x32_bf16 v[156:159], v[192:195], a[140:143], v[156:159]
  v_mul_f32 v89, v89, v57
  v_mul_f32 v90, v90, v58
  v_mfma_f32_16x16x32_bf16 v[128:131], v[160:163], a[144:147], v[128:131]
  ds_read_b64_tr_b16 v[184:185], v11 offset:12288
  v_mul_f32 v91, v91, v59
  v_mfma_f32_16x16x32_bf16 v[128:131], v[164:167], a[160:163], v[128:131]
  v_cvt_pk_bf16_f32 v214, v88, v89
  v_cvt_pk_bf16_f32 v215, v90, v91
  v_mfma_f32_16x16x32_bf16 v[128:131], v[168:171], a[176:179], v[128:131]
  ds_read_b64_tr_b16 v[186:187], v11 offset:18432
  v_mul_f32 v76, v76, v44
  v_mfma_f32_16x16x32_bf16 v[132:135], v[160:163], a[148:151], v[132:135]
  buffer_load_dwordx4 v4, s[4:7], s35 offen offset:2048 lds
  ds_write_b128 v21, v[212:215] offset:2048
  v_mfma_f32_16x16x32_bf16 v[132:135], v[164:167], a[164:167], v[132:135]
  ds_read_b64_tr_b16 v[188:189], v11 offset:13312
  v_mul_f32 v77, v77, v45
  v_mfma_f32_16x16x32_bf16 v[132:135], v[168:171], a[180:183], v[132:135]
  s_add_u32 s35, s32, 3539200
  v_mul_f32 v78, v78, v46
  v_mul_f32 v79, v79, v47
  v_mfma_f32_16x16x32_bf16 v[136:139], v[160:163], a[152:155], v[136:139]
  s_add_u32 m0, s31, 98304
  ds_read_b64_tr_b16 v[190:191], v11 offset:19456
  v_cvt_pk_bf16_f32 v216, v76, v77
  v_mfma_f32_16x16x32_bf16 v[136:139], v[164:167], a[168:171], v[136:139]
  buffer_load_dwordx4 v2, s[4:7], s35 offen offset:0 lds
  v_cvt_pk_bf16_f32 v217, v78, v79
  v_mul_f32 v92, v92, v60
  v_mfma_f32_16x16x32_bf16 v[136:139], v[168:171], a[184:187], v[136:139]
  ds_read_b64_tr_b16 v[192:193], v11 offset:14336
  v_mul_f32 v93, v93, v61
  v_mfma_f32_16x16x32_bf16 v[140:143], v[160:163], a[156:159], v[140:143]
  v_mul_f32 v94, v94, v62
  v_mul_f32 v95, v95, v63
  v_mfma_f32_16x16x32_bf16 v[140:143], v[164:167], a[172:175], v[140:143]
  ds_read_b64_tr_b16 v[194:195], v11 offset:20480
  v_cvt_pk_bf16_f32 v218, v92, v93
  v_mfma_f32_16x16x32_bf16 v[140:143], v[168:171], a[188:191], v[140:143]
  s_waitcnt lgkmcnt(7)
  buffer_load_dwordx4 v3, s[4:7], s35 offen offset:1024 lds
  v_cvt_pk_bf16_f32 v219, v94, v95
  v_mfma_f32_16x16x32_bf16 v[144:147], v[172:175], a[144:147], v[144:147]
  ds_read_b64_tr_b16 v[160:161], v221 offset:12288
  v_mul_f32 v196, v96, v96
  v_mul_f32 v197, v97, v97
  v_mfma_f32_16x16x32_bf16 v[144:147], v[176:179], a[160:163], v[144:147]
  ds_write_b128 v21, v[216:219] offset:3072
  v_mfma_f32_16x16x32_bf16 v[144:147], v[180:183], a[176:179], v[144:147]
  ds_read_b64_tr_b16 v[162:163], v221 offset:18432
  v_mul_f32 v198, v98, v98
  v_mfma_f32_16x16x32_bf16 v[148:151], v[172:175], a[148:151], v[148:151]
  buffer_load_dwordx4 v4, s[4:7], s35 offen offset:2048 lds
  v_mul_f32 v199, v99, v99
  v_mfma_f32_16x16x32_bf16 v[148:151], v[176:179], a[164:167], v[148:151]
  ds_read_b64_tr_b16 v[164:165], v221 offset:13312
  v_fma_f32 v196, v196, v28, v24
  v_mfma_f32_16x16x32_bf16 v[148:151], v[180:183], a[180:183], v[148:151]
  s_add_u32 s35, s32, 4423936
  v_fma_f32 v197, v197, v28, v24
  v_fma_f32 v198, v198, v28, v24
  v_fma_f32 v199, v199, v28, v24
  v_mfma_f32_16x16x32_bf16 v[152:155], v[172:175], a[152:155], v[152:155]
  s_add_u32 m0, s31, 24576
  ds_read_b64_tr_b16 v[166:167], v221 offset:19456
  v_mul_f32 v196, v196, v96
  v_mfma_f32_16x16x32_bf16 v[152:155], v[176:179], a[168:171], v[152:155]
  buffer_load_dwordx4 v2, s[4:7], s35 offen offset:0 lds
  v_mul_f32 v197, v197, v97
  v_mfma_f32_16x16x32_bf16 v[152:155], v[180:183], a[184:187], v[152:155]
  ds_read_b64_tr_b16 v[168:169], v221 offset:14336
  v_mul_f32 v198, v198, v98
  v_mfma_f32_16x16x32_bf16 v[156:159], v[172:175], a[156:159], v[156:159]
  v_exp_f32 v196, v196
  v_mfma_f32_16x16x32_bf16 v[156:159], v[176:179], a[172:175], v[156:159]
  s_waitcnt lgkmcnt(6) vmcnt(13)
  ds_read_b64_tr_b16 v[170:171], v221 offset:20480
  v_exp_f32 v197, v197
  v_mfma_f32_16x16x32_bf16 v[156:159], v[180:183], a[188:191], v[156:159]
  s_barrier
  v_mfma_f32_16x16x32_bf16 v[128:131], v[184:187], a[192:195], v[128:131]
  ds_read_b64_tr_b16 v[172:173], v11 offset:24576
  v_mul_f32 v199, v199, v99
  v_mfma_f32_16x16x32_bf16 v[128:131], v[188:191], a[208:211], v[128:131]
  v_exp_f32 v198, v198
  v_mfma_f32_16x16x32_bf16 v[128:131], v[192:195], a[224:227], v[128:131]
  ds_read_b64_tr_b16 v[174:175], v11 offset:30720
  v_add_f32 v196, 1.0, v196
  v_mfma_f32_16x16x32_bf16 v[132:135], v[184:187], a[196:199], v[132:135]
  buffer_load_dwordx4 v3, s[4:7], s35 offen offset:1024 lds
  v_exp_f32 v199, v199
  v_mfma_f32_16x16x32_bf16 v[132:135], v[188:191], a[212:215], v[132:135]
  ds_read_b64_tr_b16 v[176:177], v11 offset:25600
  v_add_f32 v197, 1.0, v197
  v_mfma_f32_16x16x32_bf16 v[132:135], v[192:195], a[228:231], v[132:135]
  v_rcp_f32 v196, v196
  v_mfma_f32_16x16x32_bf16 v[136:139], v[184:187], a[200:203], v[136:139]
  ds_read_b64_tr_b16 v[178:179], v11 offset:31744
  v_add_f32 v198, 1.0, v198
  v_mfma_f32_16x16x32_bf16 v[136:139], v[188:191], a[216:219], v[136:139]
  buffer_load_dwordx4 v4, s[4:7], s35 offen offset:2048 lds
  v_add_f32 v199, 1.0, v199
  v_mfma_f32_16x16x32_bf16 v[136:139], v[192:195], a[232:235], v[136:139]
  ds_read_b64_tr_b16 v[180:181], v11 offset:26624
  v_rcp_f32 v197, v197
  v_mfma_f32_16x16x32_bf16 v[140:143], v[184:187], a[204:207], v[140:143]
  s_add_u32 s35, s32, 256
  v_rcp_f32 v198, v198
  v_mfma_f32_16x16x32_bf16 v[140:143], v[188:191], a[220:223], v[140:143]
  s_add_u32 m0, s31, 110592
  ds_read_b64_tr_b16 v[182:183], v11 offset:32768
  v_mul_f32 v96, v96, v196
  v_mfma_f32_16x16x32_bf16 v[140:143], v[192:195], a[236:239], v[140:143]
  s_waitcnt lgkmcnt(6)
  buffer_load_dwordx4 v2, s[8:11], s35 offen offset:0 lds
  v_mul_f32 v97, v97, v197
  v_mfma_f32_16x16x32_bf16 v[144:147], v[160:163], a[192:195], v[144:147]
  ds_read_b64_tr_b16 v[184:185], v221 offset:24576
  v_mul_f32 v98, v98, v198
  v_mfma_f32_16x16x32_bf16 v[144:147], v[164:167], a[208:211], v[144:147]
  v_rcp_f32 v199, v199
  v_mul_f32 v200, v100, v100
  v_mfma_f32_16x16x32_bf16 v[144:147], v[168:171], a[224:227], v[144:147]
  ds_read_b64_tr_b16 v[186:187], v221 offset:30720
  v_mul_f32 v201, v101, v101
  v_mfma_f32_16x16x32_bf16 v[148:151], v[160:163], a[196:199], v[148:151]
  buffer_load_dwordx4 v3, s[8:11], s35 offen offset:1024 lds
  v_mul_f32 v99, v99, v199
  v_mfma_f32_16x16x32_bf16 v[148:151], v[164:167], a[212:215], v[148:151]
  ds_read_b64_tr_b16 v[188:189], v221 offset:25600
  v_mul_f32 v202, v102, v102
  v_mfma_f32_16x16x32_bf16 v[148:151], v[168:171], a[228:231], v[148:151]
  v_mul_f32 v203, v103, v103
  v_fma_f32 v200, v200, v29, v25
  v_mfma_f32_16x16x32_bf16 v[152:155], v[160:163], a[200:203], v[152:155]
  ds_read_b64_tr_b16 v[190:191], v221 offset:31744
  v_fma_f32 v201, v201, v29, v25
  v_fma_f32 v202, v202, v29, v25
  v_mfma_f32_16x16x32_bf16 v[152:155], v[164:167], a[216:219], v[152:155]
  buffer_load_dwordx4 v4, s[8:11], s35 offen offset:2048 lds
  v_fma_f32 v203, v203, v29, v25
  v_mfma_f32_16x16x32_bf16 v[152:155], v[168:171], a[232:235], v[152:155]
  ds_read_b64_tr_b16 v[192:193], v221 offset:26624
  v_mul_f32 v200, v200, v100
  v_mfma_f32_16x16x32_bf16 v[156:159], v[160:163], a[204:207], v[156:159]
  v_exp_f32 v200, v200
  v_mfma_f32_16x16x32_bf16 v[156:159], v[164:167], a[220:223], v[156:159]
  s_waitcnt lgkmcnt(5)
  ds_read_b64_tr_b16 v[194:195], v221 offset:32768
  v_mul_f32 v201, v201, v101
  v_mfma_f32_16x16x32_bf16 v[156:159], v[168:171], a[236:239], v[156:159]
  v_exp_f32 v201, v201
  v_mul_f32 v202, v202, v102
  v_mfma_f32_16x16x32_bf16 v[128:131], v[172:175], a[240:243], v[128:131]
  s_add_u32 s3, s42, 0
  buffer_store_dwordx4 v[204:207], v21, s[16:19], s3 offen offset:0 sc1
  ds_read_b64_tr_b16 v[160:161], v14 offset:0
  v_mfma_f32_16x16x32_bf16 v[128:131], v[176:179], v[224:227], v[128:131]
  s_add_u32 s35, s32, 884992
  v_exp_f32 v202, v202
  v_mfma_f32_16x16x32_bf16 v[128:131], v[180:183], v[240:243], v[128:131]
  s_add_u32 m0, s31, 36864
  ds_read_b64_tr_b16 v[162:163], v14 offset:6144
  v_mul_f32 v203, v203, v103
  v_mfma_f32_16x16x32_bf16 v[132:135], v[172:175], a[244:247], v[132:135]
  buffer_load_dwordx4 v2, s[8:11], s35 offen offset:0 lds
  v_add_f32 v200, 1.0, v200
  v_mfma_f32_16x16x32_bf16 v[132:135], v[176:179], v[228:231], v[132:135]
  ds_read_b64_tr_b16 v[164:165], v14 offset:1024
  v_exp_f32 v203, v203
  v_mfma_f32_16x16x32_bf16 v[132:135], v[180:183], v[244:247], v[132:135]
  v_rcp_f32 v200, v200
  v_mfma_f32_16x16x32_bf16 v[136:139], v[172:175], a[248:251], v[136:139]
  ds_read_b64_tr_b16 v[166:167], v14 offset:7168
  v_add_f32 v201, 1.0, v201
  v_mfma_f32_16x16x32_bf16 v[136:139], v[176:179], v[232:235], v[136:139]
  buffer_load_dwordx4 v3, s[8:11], s35 offen offset:1024 lds
  v_add_f32 v202, 1.0, v202
  v_mfma_f32_16x16x32_bf16 v[136:139], v[180:183], v[248:251], v[136:139]
  ds_read_b64_tr_b16 v[168:169], v14 offset:2048
  v_add_f32 v203, 1.0, v203
  v_mfma_f32_16x16x32_bf16 v[140:143], v[172:175], a[252:255], v[140:143]
  v_rcp_f32 v201, v201
  v_mul_f32 v100, v100, v200
  v_mfma_f32_16x16x32_bf16 v[140:143], v[176:179], v[236:239], v[140:143]
  ds_read_b64_tr_b16 v[170:171], v14 offset:8192
  v_mul_f32 v196, v104, v104
  v_mfma_f32_16x16x32_bf16 v[140:143], v[180:183], v[252:255], v[140:143]
  s_waitcnt lgkmcnt(6)
  buffer_load_dwordx4 v4, s[8:11], s35 offen offset:2048 lds
  v_mul_f32 v101, v101, v201
  v_mfma_f32_16x16x32_bf16 v[144:147], v[184:187], a[240:243], v[144:147]
  ds_read_b64_tr_b16 v[172:173], v15 offset:0
  v_mul_f32 v197, v105, v105
  v_mfma_f32_16x16x32_bf16 v[144:147], v[188:191], v[224:227], v[144:147]
  s_add_u32 s35, s32, 1769728
  v_rcp_f32 v202, v202
  v_mfma_f32_16x16x32_bf16 v[144:147], v[192:195], v[240:243], v[144:147]
  s_add_u32 m0, s31, 49152
  ds_read_b64_tr_b16 v[174:175], v15 offset:6144
  v_rcp_f32 v203, v203
  v_mfma_f32_16x16x32_bf16 v[148:151], v[184:187], a[244:247], v[148:151]
  buffer_load_dwordx4 v2, s[8:11], s35 offen offset:0 lds
  v_mul_f32 v102, v102, v202
  v_mfma_f32_16x16x32_bf16 v[148:151], v[188:191], v[228:231], v[148:151]
  ds_read_b64_tr_b16 v[176:177], v15 offset:1024
  v_mul_f32 v103, v103, v203
  v_mfma_f32_16x16x32_bf16 v[148:151], v[192:195], v[244:247], v[148:151]
  buffer_store_dwordx4 v[208:211], v21, s[16:19], s3 offen offset:1024 sc1
  v_mfma_f32_16x16x32_bf16 v[152:155], v[184:187], a[248:251], v[152:155]
  ds_read_b64_tr_b16 v[178:179], v15 offset:7168
  v_mul_f32 v198, v106, v106
  v_mfma_f32_16x16x32_bf16 v[152:155], v[188:191], v[232:235], v[152:155]
  buffer_load_dwordx4 v3, s[8:11], s35 offen offset:1024 lds
  v_mul_f32 v199, v107, v107
  v_fma_f32 v196, v196, v30, v26
  v_mfma_f32_16x16x32_bf16 v[152:155], v[192:195], v[248:251], v[152:155]
  ds_read_b64_tr_b16 v[180:181], v15 offset:2048
  v_fma_f32 v197, v197, v30, v26
  v_mfma_f32_16x16x32_bf16 v[156:159], v[184:187], a[252:255], v[156:159]
  v_fma_f32 v198, v198, v30, v26
  v_fma_f32 v199, v199, v30, v26
  v_mfma_f32_16x16x32_bf16 v[156:159], v[188:191], v[236:239], v[156:159]
  s_waitcnt lgkmcnt(5) vmcnt(19)
  ds_read_b64_tr_b16 v[182:183], v15 offset:8192
  v_mul_f32 v196, v196, v104
  v_mfma_f32_16x16x32_bf16 v[156:159], v[192:195], v[252:255], v[156:159]
  s_barrier
  v_mfma_f32_16x16x32_bf16 v[32:35], v[160:163], a[0:3], 0
  ds_read_b64_tr_b16 v[184:185], v14 offset:12288
  v_exp_f32 v196, v196
  v_mfma_f32_16x16x32_bf16 v[32:35], v[164:167], a[16:19], v[32:35]
  v_mul_f32 v197, v197, v105
  v_mul_f32 v198, v198, v106
  v_mfma_f32_16x16x32_bf16 v[32:35], v[168:171], a[32:35], v[32:35]
  ds_read_b64_tr_b16 v[186:187], v14 offset:18432
  v_mul_f32 v199, v199, v107
  v_mfma_f32_16x16x32_bf16 v[36:39], v[160:163], a[4:7], 0
  buffer_load_dwordx4 v4, s[8:11], s35 offen offset:2048 lds
  v_add_f32 v196, 1.0, v196
  v_mfma_f32_16x16x32_bf16 v[36:39], v[164:167], a[20:23], v[36:39]
  ds_read_b64_tr_b16 v[188:189], v14 offset:13312
  v_mul_f32 v200, v108, v108
  v_mfma_f32_16x16x32_bf16 v[36:39], v[168:171], a[36:39], v[36:39]
  s_add_u32 s35, s32, 2654464
  v_exp_f32 v197, v197
  v_mul_f32 v201, v109, v109
  v_mfma_f32_16x16x32_bf16 v[40:43], v[160:163], a[8:11], 0
  s_add_u32 m0, s31, 147456
  ds_read_b64_tr_b16 v[190:191], v14 offset:19456
  v_mul_f32 v202, v110, v110
  v_mfma_f32_16x16x32_bf16 v[40:43], v[164:167], a[24:27], v[40:43]
  buffer_load_dwordx4 v2, s[8:11], s35 offen offset:0 lds
  v_add_f32 v197, 1.0, v197
  v_mfma_f32_16x16x32_bf16 v[40:43], v[168:171], a[40:43], v[40:43]
  ds_read_b64_tr_b16 v[192:193], v14 offset:14336
  v_mul_f32 v203, v111, v111
  v_mfma_f32_16x16x32_bf16 v[44:47], v[160:163], a[12:15], 0
  buffer_store_dwordx4 v[212:215], v21, s[16:19], s3 offen offset:2048 sc1
  v_mfma_f32_16x16x32_bf16 v[44:47], v[164:167], a[28:31], v[44:47]
  ds_read_b64_tr_b16 v[194:195], v14 offset:20480
  v_exp_f32 v198, v198
  v_mfma_f32_16x16x32_bf16 v[44:47], v[168:171], a[44:47], v[44:47]
  s_waitcnt lgkmcnt(6)
  buffer_load_dwordx4 v3, s[8:11], s35 offen offset:1024 lds
  v_fma_f32 v200, v200, v31, v27
  v_mfma_f32_16x16x32_bf16 v[48:51], v[172:175], a[0:3], 0
  ds_read_b64_tr_b16 v[160:161], v15 offset:12288
  v_add_f32 v198, 1.0, v198
  v_mfma_f32_16x16x32_bf16 v[48:51], v[176:179], a[16:19], v[48:51]
  v_exp_f32 v199, v199
  v_mfma_f32_16x16x32_bf16 v[48:51], v[180:183], a[32:35], v[48:51]
  ds_read_b64_tr_b16 v[162:163], v15 offset:18432
  v_fma_f32 v201, v201, v31, v27
  v_mfma_f32_16x16x32_bf16 v[52:55], v[172:175], a[4:7], 0
  buffer_load_dwordx4 v4, s[8:11], s35 offen offset:2048 lds
  v_rcp_f32 v196, v196
  v_mfma_f32_16x16x32_bf16 v[52:55], v[176:179], a[20:23], v[52:55]
  ds_read_b64_tr_b16 v[164:165], v15 offset:13312
  v_add_f32 v199, 1.0, v199
  v_mfma_f32_16x16x32_bf16 v[52:55], v[180:183], a[36:39], v[52:55]
  v_rcp_f32 v197, v197
  v_mfma_f32_16x16x32_bf16 v[56:59], v[172:175], a[8:11], 0
  ds_read_b64_tr_b16 v[166:167], v15 offset:19456
  v_mul_f32 v104, v104, v196
  v_mfma_f32_16x16x32_bf16 v[56:59], v[176:179], a[24:27], v[56:59]
  v_rcp_f32 v198, v198
  v_mfma_f32_16x16x32_bf16 v[56:59], v[180:183], a[40:43], v[56:59]
  ds_read_b64_tr_b16 v[168:169], v15 offset:14336
  v_rcp_f32 v199, v199
  v_mfma_f32_16x16x32_bf16 v[60:63], v[172:175], a[12:15], 0
  v_mul_f32 v105, v105, v197
  v_mul_f32 v106, v106, v198
  v_mfma_f32_16x16x32_bf16 v[60:63], v[176:179], a[28:31], v[60:63]
  s_waitcnt lgkmcnt(5)
  ds_read_b64_tr_b16 v[170:171], v15 offset:20480
  v_mul_f32 v107, v107, v199
  v_mfma_f32_16x16x32_bf16 v[60:63], v[180:183], a[44:47], v[60:63]
  v_fma_f32 v202, v202, v31, v27
  v_fma_f32 v203, v203, v31, v27
  v_mfma_f32_16x16x32_bf16 v[32:35], v[184:187], a[48:51], v[32:35]
  ds_read_b64_tr_b16 v[172:173], v12 offset:0
  v_mul_f32 v200, v200, v108
  v_mfma_f32_16x16x32_bf16 v[32:35], v[188:191], a[64:67], v[32:35]
  buffer_store_dwordx4 v[216:219], v21, s[16:19], s3 offen offset:3072 sc1
  v_mul_f32 v201, v201, v109
  v_mfma_f32_16x16x32_bf16 v[32:35], v[192:195], a[80:83], v[32:35]
  ds_read_b64_tr_b16 v[174:175], v12 offset:6144
  v_mul_f32 v202, v202, v110
  v_mfma_f32_16x16x32_bf16 v[36:39], v[184:187], a[52:55], v[36:39]
  v_exp_f32 v200, v200
  v_mfma_f32_16x16x32_bf16 v[36:39], v[188:191], a[68:71], v[36:39]
  ds_read_b64_tr_b16 v[176:177], v12 offset:1024
  v_mul_f32 v203, v203, v111
  v_mfma_f32_16x16x32_bf16 v[36:39], v[192:195], a[84:87], v[36:39]
  v_exp_f32 v201, v201
  v_mfma_f32_16x16x32_bf16 v[40:43], v[184:187], a[56:59], v[40:43]
  ds_read_b64_tr_b16 v[178:179], v12 offset:7168
  v_exp_f32 v202, v202
  v_mfma_f32_16x16x32_bf16 v[40:43], v[188:191], a[72:75], v[40:43]
  v_exp_f32 v203, v203
  v_mfma_f32_16x16x32_bf16 v[40:43], v[192:195], a[88:91], v[40:43]
  ds_read_b64_tr_b16 v[180:181], v12 offset:2048
  v_add_f32 v200, 1.0, v200
  v_mfma_f32_16x16x32_bf16 v[44:47], v[184:187], a[60:63], v[44:47]
  v_rcp_f32 v200, v200
  v_mfma_f32_16x16x32_bf16 v[44:47], v[188:191], a[76:79], v[44:47]
  ds_read_b64_tr_b16 v[182:183], v12 offset:8192
  v_add_f32 v201, 1.0, v201
  v_mfma_f32_16x16x32_bf16 v[44:47], v[192:195], a[92:95], v[44:47]
  s_waitcnt lgkmcnt(6)
  v_rcp_f32 v201, v201
  v_add_f32 v202, 1.0, v202
  v_mfma_f32_16x16x32_bf16 v[48:51], v[160:163], a[48:51], v[48:51]
  ds_read_b64_tr_b16 v[184:185], v13 offset:0
  v_add_f32 v203, 1.0, v203
  v_mfma_f32_16x16x32_bf16 v[48:51], v[164:167], a[64:67], v[48:51]
  v_rcp_f32 v202, v202
  v_mfma_f32_16x16x32_bf16 v[48:51], v[168:171], a[80:83], v[48:51]
  ds_read_b64_tr_b16 v[186:187], v13 offset:6144
  v_mul_f32 v108, v108, v200
  v_mfma_f32_16x16x32_bf16 v[52:55], v[160:163], a[52:55], v[52:55]
  v_rcp_f32 v203, v203
  v_mfma_f32_16x16x32_bf16 v[52:55], v[164:167], a[68:71], v[52:55]
  ds_read_b64_tr_b16 v[188:189], v13 offset:1024
  v_mul_f32 v109, v109, v201
  v_mul_f32 v110, v110, v202
  v_mfma_f32_16x16x32_bf16 v[52:55], v[168:171], a[84:87], v[52:55]
  v_mul_f32 v111, v111, v203
  v_mul_f32 v196, v112, v112
  v_mfma_f32_16x16x32_bf16 v[56:59], v[160:163], a[56:59], v[56:59]
  ds_read_b64_tr_b16 v[190:191], v13 offset:7168
  v_mul_f32 v197, v113, v113
  v_mfma_f32_16x16x32_bf16 v[56:59], v[164:167], a[72:75], v[56:59]
  v_mul_f32 v198, v114, v114
  v_mul_f32 v199, v115, v115
  v_mfma_f32_16x16x32_bf16 v[56:59], v[168:171], a[88:91], v[56:59]
  ds_read_b64_tr_b16 v[192:193], v13 offset:2048
  v_fma_f32 v196, v196, v28, v24
  v_mfma_f32_16x16x32_bf16 v[60:63], v[160:163], a[60:63], v[60:63]
  v_fma_f32 v197, v197, v28, v24
  v_fma_f32 v198, v198, v28, v24
  v_fma_f32 v199, v199, v28, v24
  v_mfma_f32_16x16x32_bf16 v[60:63], v[164:167], a[76:79], v[60:63]
  s_waitcnt lgkmcnt(5) vmcnt(19)
  ds_read_b64_tr_b16 v[194:195], v13 offset:8192
  v_mul_f32 v196, v196, v112
  v_mfma_f32_16x16x32_bf16 v[60:63], v[168:171], a[92:95], v[60:63]
  s_barrier
  v_mfma_f32_16x16x32_bf16 v[32:35], v[172:175], a[96:99], v[32:35]
  ds_read_b64_tr_b16 v[160:161], v12 offset:12288
  v_mul_f32 v197, v197, v113
  v_mfma_f32_16x16x32_bf16 v[32:35], v[176:179], a[112:115], v[32:35]
  s_add_u32 s35, s32, 3539200
  v_exp_f32 v196, v196
  v_mfma_f32_16x16x32_bf16 v[32:35], v[180:183], a[128:131], v[32:35]
  s_add_u32 m0, s31, 61440
  ds_read_b64_tr_b16 v[162:163], v12 offset:18432
  v_exp_f32 v197, v197
  v_mfma_f32_16x16x32_bf16 v[36:39], v[172:175], a[100:103], v[36:39]
  buffer_load_dwordx4 v2, s[8:11], s35 offen offset:0 lds
  v_mul_f32 v198, v198, v114
  v_mfma_f32_16x16x32_bf16 v[36:39], v[176:179], a[116:119], v[36:39]
  ds_read_b64_tr_b16 v[164:165], v12 offset:13312
  v_mul_f32 v199, v199, v115
  v_mfma_f32_16x16x32_bf16 v[36:39], v[180:183], a[132:135], v[36:39]
  v_exp_f32 v198, v198
  v_mfma_f32_16x16x32_bf16 v[40:43], v[172:175], a[104:107], v[40:43]
  ds_read_b64_tr_b16 v[166:167], v12 offset:19456
  v_add_f32 v196, 1.0, v196
  v_mfma_f32_16x16x32_bf16 v[40:43], v[176:179], a[120:123], v[40:43]
  buffer_load_dwordx4 v3, s[8:11], s35 offen offset:1024 lds
  v_exp_f32 v199, v199
  v_mfma_f32_16x16x32_bf16 v[40:43], v[180:183], a[136:139], v[40:43]
  ds_read_b64_tr_b16 v[168:169], v12 offset:14336
  v_add_f32 v197, 1.0, v197
  v_mfma_f32_16x16x32_bf16 v[44:47], v[172:175], a[108:111], v[44:47]
  v_rcp_f32 v196, v196
  v_mfma_f32_16x16x32_bf16 v[44:47], v[176:179], a[124:127], v[44:47]
  ds_read_b64_tr_b16 v[170:171], v12 offset:20480
  v_add_f32 v198, 1.0, v198
  v_mfma_f32_16x16x32_bf16 v[44:47], v[180:183], a[140:143], v[44:47]
  s_waitcnt lgkmcnt(6)
  buffer_load_dwordx4 v4, s[8:11], s35 offen offset:2048 lds
  v_rcp_f32 v197, v197
  v_mfma_f32_16x16x32_bf16 v[48:51], v[184:187], a[96:99], v[48:51]
  ds_read_b64_tr_b16 v[172:173], v13 offset:12288
  v_add_f32 v199, 1.0, v199
  v_mfma_f32_16x16x32_bf16 v[48:51], v[188:191], a[112:115], v[48:51]
  s_add_u32 s35, s32, 4423936
  v_rcp_f32 v198, v198
  v_mfma_f32_16x16x32_bf16 v[48:51], v[192:195], a[128:131], v[48:51]
  s_add_u32 m0, s31, 73728
  ds_read_b64_tr_b16 v[174:175], v13 offset:18432
  v_mul_f32 v112, v112, v196
  v_mfma_f32_16x16x32_bf16 v[52:55], v[184:187], a[100:103], v[52:55]
  buffer_load_dwordx4 v2, s[8:11], s35 offen offset:0 lds
  v_mul_f32 v113, v113, v197
  v_mfma_f32_16x16x32_bf16 v[52:55], v[188:191], a[116:119], v[52:55]
  ds_read_b64_tr_b16 v[176:177], v13 offset:13312
  v_rcp_f32 v199, v199
  v_mfma_f32_16x16x32_bf16 v[52:55], v[192:195], a[132:135], v[52:55]
  v_mul_f32 v114, v114, v198
  v_mul_f32 v200, v116, v116
  v_mfma_f32_16x16x32_bf16 v[56:59], v[184:187], a[104:107], v[56:59]
  ds_read_b64_tr_b16 v[178:179], v13 offset:19456
  v_mul_f32 v115, v115, v199
  v_mfma_f32_16x16x32_bf16 v[56:59], v[188:191], a[120:123], v[56:59]
  buffer_load_dwordx4 v3, s[8:11], s35 offen offset:1024 lds
  v_mul_f32 v201, v117, v117
  v_mfma_f32_16x16x32_bf16 v[56:59], v[192:195], a[136:139], v[56:59]
  ds_read_b64_tr_b16 v[180:181], v13 offset:14336
  v_mul_f32 v202, v118, v118
  v_mfma_f32_16x16x32_bf16 v[60:63], v[184:187], a[108:111], v[60:63]
  v_mul_f32 v203, v119, v119
  v_fma_f32 v200, v200, v29, v25
  v_fma_f32 v201, v201, v29, v25
  v_mfma_f32_16x16x32_bf16 v[60:63], v[188:191], a[124:127], v[60:63]
  s_waitcnt lgkmcnt(5)
  ds_read_b64_tr_b16 v[182:183], v13 offset:20480
  v_fma_f32 v202, v202, v29, v25
  v_mfma_f32_16x16x32_bf16 v[60:63], v[192:195], a[140:143], v[60:63]
  v_fma_f32 v203, v203, v29, v25
  v_mul_f32 v200, v200, v116
  v_mfma_f32_16x16x32_bf16 v[32:35], v[160:163], a[144:147], v[32:35]
  ds_read_b64_tr_b16 v[184:185], v14 offset:36864
  v_min_u32 v0, 17, v1
  v_mfma_f32_16x16x32_bf16 v[32:35], v[164:167], a[160:163], v[32:35]
  v_exp_f32 v200, v200
  v_mfma_f32_16x16x32_bf16 v[32:35], v[168:171], a[176:179], v[32:35]
  ds_read_b64_tr_b16 v[186:187], v14 offset:43008
  v_mul_u32_u24 v0, 1152, v0
  v_mul_f32 v201, v201, v117
  v_mfma_f32_16x16x32_bf16 v[36:39], v[160:163], a[148:151], v[36:39]
  v_exp_f32 v201, v201
  v_mfma_f32_16x16x32_bf16 v[36:39], v[164:167], a[164:167], v[36:39]
  ds_read_b64_tr_b16 v[188:189], v14 offset:37888
  v_mul_f32 v202, v202, v118
  v_mfma_f32_16x16x32_bf16 v[36:39], v[168:171], a[180:183], v[36:39]
  buffer_load_dword v220, v0, s[12:15], s53 offen offset:0
  v_mul_f32 v203, v203, v119
  v_mfma_f32_16x16x32_bf16 v[40:43], v[160:163], a[152:155], v[40:43]
  ds_read_b64_tr_b16 v[190:191], v14 offset:44032
  v_add_f32 v200, 1.0, v200
  v_mfma_f32_16x16x32_bf16 v[40:43], v[164:167], a[168:171], v[40:43]
  v_exp_f32 v202, v202
  v_add_f32 v201, 1.0, v201
  v_mfma_f32_16x16x32_bf16 v[40:43], v[168:171], a[184:187], v[40:43]
L_st_c000:
  s_cbranch_execz L_wuret_s2
  ds_read_b64_tr_b16 v[192:193], v14 offset:38912
  v_mul_f32 v196, v120, v120
  v_mfma_f32_16x16x32_bf16 v[44:47], v[160:163], a[156:159], v[44:47]
  buffer_load_dword v220, v0, s[12:15], s53 offen offset:256
  v_add_f32 v202, 1.0, v202
  v_mfma_f32_16x16x32_bf16 v[44:47], v[164:167], a[172:175], v[44:47]
  ds_read_b64_tr_b16 v[194:195], v14 offset:45056
  v_mul_f32 v197, v121, v121
  v_mfma_f32_16x16x32_bf16 v[44:47], v[168:171], a[188:191], v[44:47]
  s_waitcnt lgkmcnt(6)
  v_exp_f32 v203, v203
  v_mfma_f32_16x16x32_bf16 v[48:51], v[172:175], a[144:147], v[48:51]
  ds_read_b64_tr_b16 v[160:161], v15 offset:36864
  v_rcp_f32 v200, v200
  v_mfma_f32_16x16x32_bf16 v[48:51], v[176:179], a[160:163], v[48:51]
  buffer_load_dword v220, v0, s[12:15], s53 offen offset:512
  v_add_f32 v203, 1.0, v203
  v_mfma_f32_16x16x32_bf16 v[48:51], v[180:183], a[176:179], v[48:51]
  ds_read_b64_tr_b16 v[162:163], v15 offset:43008
  v_mul_f32 v116, v116, v200
  v_mfma_f32_16x16x32_bf16 v[52:55], v[172:175], a[148:151], v[52:55]
  v_rcp_f32 v201, v201
  v_mfma_f32_16x16x32_bf16 v[52:55], v[176:179], a[164:167], v[52:55]
  ds_read_b64_tr_b16 v[164:165], v15 offset:37888
  v_mul_f32 v198, v122, v122
  v_mfma_f32_16x16x32_bf16 v[52:55], v[180:183], a[180:183], v[52:55]
  v_rcp_f32 v202, v202
  v_mul_f32 v117, v117, v201
  v_mfma_f32_16x16x32_bf16 v[56:59], v[172:175], a[152:155], v[56:59]
  ds_read_b64_tr_b16 v[166:167], v15 offset:44032
  v_mul_f32 v199, v123, v123
  v_mfma_f32_16x16x32_bf16 v[56:59], v[176:179], a[168:171], v[56:59]
  v_rcp_f32 v203, v203
  v_mfma_f32_16x16x32_bf16 v[56:59], v[180:183], a[184:187], v[56:59]
  ds_read_b64_tr_b16 v[168:169], v15 offset:38912
  v_mul_f32 v118, v118, v202
  v_mfma_f32_16x16x32_bf16 v[60:63], v[172:175], a[156:159], v[60:63]
  v_mul_f32 v119, v119, v203
  v_fma_f32 v196, v196, v30, v26
  v_mfma_f32_16x16x32_bf16 v[60:63], v[176:179], a[172:175], v[60:63]
  s_waitcnt lgkmcnt(5) vmcnt(21)
  ds_read_b64_tr_b16 v[170:171], v15 offset:45056
  v_fma_f32 v197, v197, v30, v26
  v_fma_f32 v198, v198, v30, v26
  v_mfma_f32_16x16x32_bf16 v[60:63], v[180:183], a[188:191], v[60:63]
  s_barrier
  v_mfma_f32_16x16x32_bf16 v[32:35], v[184:187], a[192:195], v[32:35]
  ds_read_b64_tr_b16 v[172:173], v12 offset:24576
  v_fma_f32 v199, v199, v30, v26
  v_mfma_f32_16x16x32_bf16 v[32:35], v[188:191], a[208:211], v[32:35]
  v_mul_f32 v196, v196, v120
  v_mul_f32 v197, v197, v121
  v_mfma_f32_16x16x32_bf16 v[32:35], v[192:195], a[224:227], v[32:35]
  ds_read_b64_tr_b16 v[174:175], v12 offset:30720
  v_mul_f32 v198, v198, v122
  v_mfma_f32_16x16x32_bf16 v[36:39], v[184:187], a[196:199], v[36:39]
  v_exp_f32 v196, v196
  v_mul_f32 v199, v199, v123
  v_mfma_f32_16x16x32_bf16 v[36:39], v[188:191], a[212:215], v[36:39]
  ds_read_b64_tr_b16 v[176:177], v12 offset:25600
  v_mul_f32 v200, v124, v124
  v_mfma_f32_16x16x32_bf16 v[36:39], v[192:195], a[228:231], v[36:39]
  v_exp_f32 v197, v197
  v_mfma_f32_16x16x32_bf16 v[40:43], v[184:187], a[200:203], v[40:43]
  ds_read_b64_tr_b16 v[178:179], v12 offset:31744
  v_add_f32 v196, 1.0, v196
  v_mfma_f32_16x16x32_bf16 v[40:43], v[188:191], a[216:219], v[40:43]
  v_exp_f32 v198, v198
  v_mfma_f32_16x16x32_bf16 v[40:43], v[192:195], a[232:235], v[40:43]
  ds_read_b64_tr_b16 v[180:181], v12 offset:26624
  v_exp_f32 v199, v199
  v_mfma_f32_16x16x32_bf16 v[44:47], v[184:187], a[204:207], v[44:47]
  v_rcp_f32 v196, v196
  v_mfma_f32_16x16x32_bf16 v[44:47], v[188:191], a[220:223], v[44:47]
  ds_read_b64_tr_b16 v[182:183], v12 offset:32768
  v_add_f32 v197, 1.0, v197
  v_mfma_f32_16x16x32_bf16 v[44:47], v[192:195], a[236:239], v[44:47]
  s_waitcnt lgkmcnt(6)
  v_rcp_f32 v197, v197
  v_mfma_f32_16x16x32_bf16 v[48:51], v[160:163], a[192:195], v[48:51]
  ds_read_b64_tr_b16 v[184:185], v13 offset:24576
  v_add_f32 v198, 1.0, v198
  v_mfma_f32_16x16x32_bf16 v[48:51], v[164:167], a[208:211], v[48:51]
  v_rcp_f32 v198, v198
  v_add_f32 v199, 1.0, v199
  v_mfma_f32_16x16x32_bf16 v[48:51], v[168:171], a[224:227], v[48:51]
  ds_read_b64_tr_b16 v[186:187], v13 offset:30720
  v_mul_f32 v120, v120, v196
  v_mfma_f32_16x16x32_bf16 v[52:55], v[160:163], a[196:199], v[52:55]
  v_rcp_f32 v199, v199
  v_mfma_f32_16x16x32_bf16 v[52:55], v[164:167], a[212:215], v[52:55]
  ds_read_b64_tr_b16 v[188:189], v13 offset:25600
  v_mul_f32 v121, v121, v197
  v_mfma_f32_16x16x32_bf16 v[52:55], v[168:171], a[228:231], v[52:55]
  v_mul_f32 v122, v122, v198
  v_mul_f32 v123, v123, v199
  v_mfma_f32_16x16x32_bf16 v[56:59], v[160:163], a[200:203], v[56:59]
  ds_read_b64_tr_b16 v[190:191], v13 offset:31744
  v_mul_f32 v201, v125, v125
  v_mul_f32 v202, v126, v126
  v_mfma_f32_16x16x32_bf16 v[56:59], v[164:167], a[216:219], v[56:59]
  v_mul_f32 v203, v127, v127
  v_fma_f32 v200, v200, v31, v27
  v_mfma_f32_16x16x32_bf16 v[56:59], v[168:171], a[232:235], v[56:59]
  ds_read_b64_tr_b16 v[192:193], v13 offset:26624
  v_fma_f32 v201, v201, v31, v27
  v_mfma_f32_16x16x32_bf16 v[60:63], v[160:163], a[204:207], v[60:63]
  v_fma_f32 v202, v202, v31, v27
  v_fma_f32 v203, v203, v31, v27
  v_mfma_f32_16x16x32_bf16 v[60:63], v[164:167], a[220:223], v[60:63]
  s_waitcnt lgkmcnt(5)
  ds_read_b64_tr_b16 v[194:195], v13 offset:32768
  v_mul_f32 v200, v200, v124
  v_mfma_f32_16x16x32_bf16 v[60:63], v[168:171], a[236:239], v[60:63]
  v_exp_f32 v200, v200
  v_mul_f32 v201, v201, v125
  v_mfma_f32_16x16x32_bf16 v[32:35], v[172:175], a[240:243], v[32:35]
  ds_read_b64_tr_b16 v[160:161], v14 offset:49152
  v_mul_f32 v202, v202, v126
  v_mfma_f32_16x16x32_bf16 v[32:35], v[176:179], v[224:227], v[32:35]
  v_exp_f32 v201, v201
  v_mfma_f32_16x16x32_bf16 v[32:35], v[180:183], v[240:243], v[32:35]
  ds_read_b64_tr_b16 v[162:163], v14 offset:55296
  v_mul_f32 v203, v203, v127
  v_mfma_f32_16x16x32_bf16 v[36:39], v[172:175], a[244:247], v[36:39]
  v_exp_f32 v202, v202
  v_mfma_f32_16x16x32_bf16 v[36:39], v[176:179], v[228:231], v[36:39]
  ds_read_b64_tr_b16 v[164:165], v14 offset:50176
  v_add_f32 v200, 1.0, v200
  v_mfma_f32_16x16x32_bf16 v[36:39], v[180:183], v[244:247], v[36:39]
  v_exp_f32 v203, v203
  v_add_f32 v201, 1.0, v201
  v_mfma_f32_16x16x32_bf16 v[40:43], v[172:175], a[248:251], v[40:43]
  ds_read_b64_tr_b16 v[166:167], v14 offset:56320
  v_add_f32 v202, 1.0, v202
  v_mfma_f32_16x16x32_bf16 v[40:43], v[176:179], v[232:235], v[40:43]
  v_rcp_f32 v200, v200
  v_mfma_f32_16x16x32_bf16 v[40:43], v[180:183], v[248:251], v[40:43]
  ds_read_b64_tr_b16 v[168:169], v14 offset:51200
  v_add_f32 v203, 1.0, v203
  v_mfma_f32_16x16x32_bf16 v[44:47], v[172:175], a[252:255], v[44:47]
  v_rcp_f32 v201, v201
  v_mfma_f32_16x16x32_bf16 v[44:47], v[176:179], v[236:239], v[44:47]
  ds_read_b64_tr_b16 v[170:171], v14 offset:57344
  v_rcp_f32 v202, v202
  v_mfma_f32_16x16x32_bf16 v[44:47], v[180:183], v[252:255], v[44:47]
  s_waitcnt lgkmcnt(6)
  v_rcp_f32 v203, v203
  v_mfma_f32_16x16x32_bf16 v[48:51], v[184:187], a[240:243], v[48:51]
  ds_read_b64_tr_b16 v[172:173], v15 offset:49152
  v_mul_f32 v124, v124, v200
  v_mfma_f32_16x16x32_bf16 v[48:51], v[188:191], v[224:227], v[48:51]
  v_mul_f32 v125, v125, v201
  v_mul_f32 v126, v126, v202
  v_mfma_f32_16x16x32_bf16 v[48:51], v[192:195], v[240:243], v[48:51]
  ds_read_b64_tr_b16 v[174:175], v15 offset:55296
  v_mul_f32 v127, v127, v203
  v_mfma_f32_16x16x32_bf16 v[52:55], v[184:187], a[244:247], v[52:55]
  v_mul_f32 v128, v128, v96
  v_mul_f32 v129, v129, v97
  v_mul_f32 v130, v130, v98
  v_mfma_f32_16x16x32_bf16 v[52:55], v[188:191], v[228:231], v[52:55]
  ds_read_b64_tr_b16 v[176:177], v15 offset:50176
  v_mul_f32 v131, v131, v99
  v_mfma_f32_16x16x32_bf16 v[52:55], v[192:195], v[244:247], v[52:55]
  v_cvt_pk_bf16_f32 v204, v128, v129
  v_cvt_pk_bf16_f32 v205, v130, v131
  v_mfma_f32_16x16x32_bf16 v[56:59], v[184:187], a[248:251], v[56:59]
  ds_read_b64_tr_b16 v[178:179], v15 offset:56320
  v_mul_f32 v144, v144, v112
  v_mfma_f32_16x16x32_bf16 v[56:59], v[188:191], v[232:235], v[56:59]
  v_mul_f32 v145, v145, v113
  v_mul_f32 v146, v146, v114
  v_mfma_f32_16x16x32_bf16 v[56:59], v[192:195], v[248:251], v[56:59]
  ds_read_b64_tr_b16 v[180:181], v15 offset:51200
  v_mul_f32 v147, v147, v115
  v_cvt_pk_bf16_f32 v206, v144, v145
  v_mfma_f32_16x16x32_bf16 v[60:63], v[184:187], a[252:255], v[60:63]
  v_cvt_pk_bf16_f32 v207, v146, v147
  v_mul_f32 v132, v132, v100
  v_mfma_f32_16x16x32_bf16 v[60:63], v[188:191], v[236:239], v[60:63]
  s_waitcnt lgkmcnt(5) vmcnt(13)
  ds_read_b64_tr_b16 v[182:183], v15 offset:57344
  v_mul_f32 v133, v133, v101
  v_mfma_f32_16x16x32_bf16 v[60:63], v[192:195], v[252:255], v[60:63]
  s_barrier
  v_mfma_f32_16x16x32_bf16 v[64:67], v[160:163], a[0:3], 0
  ds_read_b64_tr_b16 v[184:185], v12 offset:36864
  v_mul_f32 v134, v134, v102
  v_mfma_f32_16x16x32_bf16 v[64:67], v[164:167], a[16:19], v[64:67]
  ds_write_b128 v21, v[204:207] offset:8192
  v_mul_f32 v135, v135, v103
  v_mfma_f32_16x16x32_bf16 v[64:67], v[168:171], a[32:35], v[64:67]
  ds_read_b64_tr_b16 v[186:187], v12 offset:43008
  v_cvt_pk_bf16_f32 v208, v132, v133
  v_mfma_f32_16x16x32_bf16 v[68:71], v[160:163], a[4:7], 0
  v_cvt_pk_bf16_f32 v209, v134, v135
  v_mul_f32 v148, v148, v116
  v_mfma_f32_16x16x32_bf16 v[68:71], v[164:167], a[20:23], v[68:71]
  ds_read_b64_tr_b16 v[188:189], v12 offset:37888
  v_mul_f32 v149, v149, v117
  v_mfma_f32_16x16x32_bf16 v[68:71], v[168:171], a[36:39], v[68:71]
  v_mul_f32 v150, v150, v118
  v_mul_f32 v151, v151, v119
  v_mfma_f32_16x16x32_bf16 v[72:75], v[160:163], a[8:11], 0
  ds_read_b64_tr_b16 v[190:191], v12 offset:44032
  v_cvt_pk_bf16_f32 v210, v148, v149
  v_cvt_pk_bf16_f32 v211, v150, v151
  v_mfma_f32_16x16x32_bf16 v[72:75], v[164:167], a[24:27], v[72:75]
  v_mul_f32 v136, v136, v104
  v_mul_f32 v137, v137, v105
  v_mfma_f32_16x16x32_bf16 v[72:75], v[168:171], a[40:43], v[72:75]
  ds_read_b64_tr_b16 v[192:193], v12 offset:38912
  v_mul_f32 v138, v138, v106
  v_mfma_f32_16x16x32_bf16 v[76:79], v[160:163], a[12:15], 0
  v_mul_f32 v139, v139, v107
  v_cvt_pk_bf16_f32 v212, v136, v137
  v_mfma_f32_16x16x32_bf16 v[76:79], v[164:167], a[28:31], v[76:79]
  ds_read_b64_tr_b16 v[194:195], v12 offset:45056
  v_cvt_pk_bf16_f32 v213, v138, v139
  v_mfma_f32_16x16x32_bf16 v[76:79], v[168:171], a[44:47], v[76:79]
  s_waitcnt lgkmcnt(7)
  v_mul_f32 v152, v152, v120
  v_mul_f32 v153, v153, v121
  v_mul_f32 v154, v154, v122
  v_mfma_f32_16x16x32_bf16 v[80:83], v[172:175], a[0:3], 0
  ds_read_b64_tr_b16 v[160:161], v13 offset:36864
  v_mul_f32 v155, v155, v123
  v_mfma_f32_16x16x32_bf16 v[80:83], v[176:179], a[16:19], v[80:83]
  ds_write_b128 v21, v[208:211] offset:9216
  v_mfma_f32_16x16x32_bf16 v[80:83], v[180:183], a[32:35], v[80:83]
  ds_read_b64_tr_b16 v[162:163], v13 offset:43008
  v_cvt_pk_bf16_f32 v214, v152, v153
  v_mfma_f32_16x16x32_bf16 v[84:87], v[172:175], a[4:7], 0
  v_cvt_pk_bf16_f32 v215, v154, v155
  v_mul_f32 v140, v140, v108
  v_mfma_f32_16x16x32_bf16 v[84:87], v[176:179], a[20:23], v[84:87]
  ds_read_b64_tr_b16 v[164:165], v13 offset:37888
  v_mul_f32 v141, v141, v109
  v_mfma_f32_16x16x32_bf16 v[84:87], v[180:183], a[36:39], v[84:87]
  v_mul_f32 v142, v142, v110
  v_mul_f32 v143, v143, v111
  v_cvt_pk_bf16_f32 v216, v140, v141
  v_mfma_f32_16x16x32_bf16 v[88:91], v[172:175], a[8:11], 0
  ds_read_b64_tr_b16 v[166:167], v13 offset:44032
  v_cvt_pk_bf16_f32 v217, v142, v143
  v_mfma_f32_16x16x32_bf16 v[88:91], v[176:179], a[24:27], v[88:91]
  v_mul_f32 v156, v156, v124
  v_mul_f32 v157, v157, v125
  v_mfma_f32_16x16x32_bf16 v[88:91], v[180:183], a[40:43], v[88:91]
  ds_read_b64_tr_b16 v[168:169], v13 offset:38912
  v_mul_f32 v158, v158, v126
  v_mfma_f32_16x16x32_bf16 v[92:95], v[172:175], a[12:15], 0
  v_mul_f32 v159, v159, v127
  v_cvt_pk_bf16_f32 v218, v156, v157
  v_mfma_f32_16x16x32_bf16 v[92:95], v[176:179], a[28:31], v[92:95]
  s_waitcnt lgkmcnt(6)
  ds_read_b64_tr_b16 v[170:171], v13 offset:45056
  v_cvt_pk_bf16_f32 v219, v158, v159
  v_mul_f32 v196, v32, v32
  v_mfma_f32_16x16x32_bf16 v[92:95], v[180:183], a[44:47], v[92:95]
  v_mul_f32 v197, v33, v33
  v_mul_f32 v198, v34, v34
  v_mfma_f32_16x16x32_bf16 v[64:67], v[184:187], a[48:51], v[64:67]
  ds_read_b64_tr_b16 v[172:173], v12 offset:49152
  v_mul_f32 v199, v35, v35
  v_mfma_f32_16x16x32_bf16 v[64:67], v[188:191], a[64:67], v[64:67]
  ds_write_b128 v21, v[212:215] offset:10240
  v_mfma_f32_16x16x32_bf16 v[64:67], v[192:195], a[80:83], v[64:67]
  ds_read_b64_tr_b16 v[174:175], v12 offset:55296
  v_fma_f32 v196, v196, v28, v24
  v_mfma_f32_16x16x32_bf16 v[68:71], v[184:187], a[52:55], v[68:71]
  buffer_load_dwordx4 v4, s[8:11], s35 offen offset:2048 lds
  v_fma_f32 v197, v197, v28, v24
  v_mfma_f32_16x16x32_bf16 v[68:71], v[188:191], a[68:71], v[68:71]
  ds_read_b64_tr_b16 v[176:177], v12 offset:50176
  v_fma_f32 v198, v198, v28, v24
  v_fma_f32 v199, v199, v28, v24
  v_mfma_f32_16x16x32_bf16 v[68:71], v[192:195], a[84:87], v[68:71]
  s_add_u32 s35, s32, 384
  v_mul_f32 v196, v196, v32
  v_mul_f32 v197, v197, v33
  v_mfma_f32_16x16x32_bf16 v[72:75], v[184:187], a[56:59], v[72:75]
  s_add_u32 m0, s31, 0
  ds_read_b64_tr_b16 v[178:179], v12 offset:56320
  v_mul_f32 v198, v198, v34
  v_mfma_f32_16x16x32_bf16 v[72:75], v[188:191], a[72:75], v[72:75]
  buffer_load_dwordx4 v2, s[4:7], s35 offen offset:0 lds
  v_mul_f32 v199, v199, v35
  v_mfma_f32_16x16x32_bf16 v[72:75], v[192:195], a[88:91], v[72:75]
  ds_read_b64_tr_b16 v[180:181], v12 offset:51200
  v_mul_f32 v200, v36, v36
  v_mfma_f32_16x16x32_bf16 v[76:79], v[184:187], a[60:63], v[76:79]
  v_exp_f32 v196, v196
  v_mul_f32 v201, v37, v37
  v_mfma_f32_16x16x32_bf16 v[76:79], v[188:191], a[76:79], v[76:79]
  ds_read_b64_tr_b16 v[182:183], v12 offset:57344
  v_mul_f32 v202, v38, v38
  v_mfma_f32_16x16x32_bf16 v[76:79], v[192:195], a[92:95], v[76:79]
  s_waitcnt lgkmcnt(7)
  buffer_load_dwordx4 v3, s[4:7], s35 offen offset:1024 lds
  v_add_f32 v196, 1.0, v196
  v_mfma_f32_16x16x32_bf16 v[80:83], v[160:163], a[48:51], v[80:83]
  ds_read_b64_tr_b16 v[184:185], v13 offset:49152
  v_mul_f32 v203, v39, v39
  v_mfma_f32_16x16x32_bf16 v[80:83], v[164:167], a[64:67], v[80:83]
  ds_write_b128 v21, v[216:219] offset:11264
  v_mfma_f32_16x16x32_bf16 v[80:83], v[168:171], a[80:83], v[80:83]
  ds_read_b64_tr_b16 v[186:187], v13 offset:55296
  v_fma_f32 v200, v200, v29, v25
  v_mfma_f32_16x16x32_bf16 v[84:87], v[160:163], a[52:55], v[84:87]
  buffer_load_dwordx4 v4, s[4:7], s35 offen offset:2048 lds
  v_exp_f32 v197, v197
  v_mfma_f32_16x16x32_bf16 v[84:87], v[164:167], a[68:71], v[84:87]
  ds_read_b64_tr_b16 v[188:189], v13 offset:50176
  v_fma_f32 v201, v201, v29, v25
  v_mfma_f32_16x16x32_bf16 v[84:87], v[168:171], a[84:87], v[84:87]
  s_add_u32 s35, s32, 885120
  v_exp_f32 v198, v198
  v_mfma_f32_16x16x32_bf16 v[88:91], v[160:163], a[56:59], v[88:91]
  s_add_u32 m0, s31, 12288
  ds_read_b64_tr_b16 v[190:191], v13 offset:56320
  v_add_f32 v197, 1.0, v197
  v_mfma_f32_16x16x32_bf16 v[88:91], v[164:167], a[72:75], v[88:91]
  buffer_load_dwordx4 v2, s[4:7], s35 offen offset:0 lds
  v_add_f32 v198, 1.0, v198
  v_mfma_f32_16x16x32_bf16 v[88:91], v[168:171], a[88:91], v[88:91]
  ds_read_b64_tr_b16 v[192:193], v13 offset:51200
  v_exp_f32 v199, v199
  v_mfma_f32_16x16x32_bf16 v[92:95], v[160:163], a[60:63], v[92:95]
  v_rcp_f32 v196, v196
  v_mfma_f32_16x16x32_bf16 v[92:95], v[164:167], a[76:79], v[92:95]
  s_waitcnt lgkmcnt(6) vmcnt(10)
  ds_read_b64_tr_b16 v[194:195], v13 offset:57344
  v_add_f32 v199, 1.0, v199
  v_mfma_f32_16x16x32_bf16 v[92:95], v[168:171], a[92:95], v[92:95]
  s_barrier
  v_mfma_f32_16x16x32_bf16 v[64:67], v[172:175], a[96:99], v[64:67]
  ds_read_b64_tr_b16 v[160:161], v11 offset:24576
  v_mul_f32 v32, v32, v196
  v_mfma_f32_16x16x32_bf16 v[64:67], v[176:179], a[112:115], v[64:67]
  v_rcp_f32 v197, v197
  v_mfma_f32_16x16x32_bf16 v[64:67], v[180:183], a[128:131], v[64:67]
  ds_read_b64_tr_b16 v[162:163], v11 offset:30720
  v_rcp_f32 v198, v198
  v_mfma_f32_16x16x32_bf16 v[68:71], v[172:175], a[100:103], v[68:71]
  buffer_load_dwordx4 v3, s[4:7], s35 offen offset:1024 lds
  v_mul_f32 v33, v33, v197
  v_mfma_f32_16x16x32_bf16 v[68:71], v[176:179], a[116:119], v[68:71]
  ds_read_b64_tr_b16 v[164:165], v11 offset:25600
  v_mul_f32 v34, v34, v198
  v_mfma_f32_16x16x32_bf16 v[68:71], v[180:183], a[132:135], v[68:71]
  v_rcp_f32 v199, v199
  v_mfma_f32_16x16x32_bf16 v[72:75], v[172:175], a[104:107], v[72:75]
  ds_read_b64_tr_b16 v[166:167], v11 offset:31744
  v_fma_f32 v202, v202, v29, v25
  v_mfma_f32_16x16x32_bf16 v[72:75], v[176:179], a[120:123], v[72:75]
  buffer_load_dwordx4 v4, s[4:7], s35 offen offset:2048 lds
  v_mul_f32 v35, v35, v199
  v_fma_f32 v203, v203, v29, v25
  v_mfma_f32_16x16x32_bf16 v[72:75], v[180:183], a[136:139], v[72:75]
  ds_read_b64_tr_b16 v[168:169], v11 offset:26624
  v_mul_f32 v200, v200, v36
  v_mfma_f32_16x16x32_bf16 v[76:79], v[172:175], a[108:111], v[76:79]
  s_add_u32 s35, s32, 1769856
  v_exp_f32 v200, v200
  v_mfma_f32_16x16x32_bf16 v[76:79], v[176:179], a[124:127], v[76:79]
  s_add_u32 m0, s31, 24576
  ds_read_b64_tr_b16 v[170:171], v11 offset:32768
  v_mul_f32 v201, v201, v37
  v_mfma_f32_16x16x32_bf16 v[76:79], v[180:183], a[140:143], v[76:79]
  s_waitcnt lgkmcnt(6)
  buffer_load_dwordx4 v2, s[4:7], s35 offen offset:0 lds
  v_mul_f32 v202, v202, v38
  v_mfma_f32_16x16x32_bf16 v[80:83], v[184:187], a[96:99], v[80:83]
  ds_read_b64_tr_b16 v[172:173], v221 offset:24576
  v_mul_f32 v203, v203, v39
  v_mfma_f32_16x16x32_bf16 v[80:83], v[188:191], a[112:115], v[80:83]
  v_exp_f32 v201, v201
  v_add_f32 v200, 1.0, v200
  v_mfma_f32_16x16x32_bf16 v[80:83], v[192:195], a[128:131], v[80:83]
  ds_read_b64_tr_b16 v[174:175], v221 offset:30720
  v_mul_f32 v196, v40, v40
  v_mfma_f32_16x16x32_bf16 v[84:87], v[184:187], a[100:103], v[84:87]
  buffer_load_dwordx4 v3, s[4:7], s35 offen offset:1024 lds
  v_add_f32 v201, 1.0, v201
  v_mfma_f32_16x16x32_bf16 v[84:87], v[188:191], a[116:119], v[84:87]
  ds_read_b64_tr_b16 v[176:177], v221 offset:25600
  v_mul_f32 v197, v41, v41
  v_mfma_f32_16x16x32_bf16 v[84:87], v[192:195], a[132:135], v[84:87]
  v_exp_f32 v202, v202
  v_mfma_f32_16x16x32_bf16 v[88:91], v[184:187], a[104:107], v[88:91]
  ds_read_b64_tr_b16 v[178:179], v221 offset:31744
  v_mul_f32 v198, v42, v42
  v_mfma_f32_16x16x32_bf16 v[88:91], v[188:191], a[120:123], v[88:91]
  buffer_load_dwordx4 v4, s[4:7], s35 offen offset:2048 lds
  v_exp_f32 v203, v203
  v_mfma_f32_16x16x32_bf16 v[88:91], v[192:195], a[136:139], v[88:91]
  ds_read_b64_tr_b16 v[180:181], v221 offset:26624
  v_add_f32 v202, 1.0, v202
  v_mfma_f32_16x16x32_bf16 v[92:95], v[184:187], a[108:111], v[92:95]
  v_rcp_f32 v200, v200
  v_mfma_f32_16x16x32_bf16 v[92:95], v[188:191], a[124:127], v[92:95]
  s_waitcnt lgkmcnt(5)
  ds_read_b64_tr_b16 v[182:183], v221 offset:32768
  v_add_f32 v203, 1.0, v203
  v_mfma_f32_16x16x32_bf16 v[92:95], v[192:195], a[140:143], v[92:95]
  v_rcp_f32 v201, v201
  v_mfma_f32_16x16x32_bf16 v[64:67], v[160:163], a[144:147], v[64:67]
  ds_read_b64_tr_b16 v[184:185], v14 offset:0
  v_rcp_f32 v202, v202
  v_mfma_f32_16x16x32_bf16 v[64:67], v[164:167], a[160:163], v[64:67]
  s_add_u32 s35, s32, 2654592
  v_rcp_f32 v203, v203
  v_mfma_f32_16x16x32_bf16 v[64:67], v[168:171], a[176:179], v[64:67]
  s_add_u32 m0, s31, 36864
  ds_read_b64_tr_b16 v[186:187], v14 offset:6144
  v_mul_f32 v36, v36, v200
  v_mfma_f32_16x16x32_bf16 v[68:71], v[160:163], a[148:151], v[68:71]
  buffer_load_dwordx4 v2, s[4:7], s35 offen offset:0 lds
  v_mul_f32 v37, v37, v201
  v_mfma_f32_16x16x32_bf16 v[68:71], v[164:167], a[164:167], v[68:71]
  ds_read_b64_tr_b16 v[188:189], v14 offset:1024
  v_mul_f32 v38, v38, v202
  v_mfma_f32_16x16x32_bf16 v[68:71], v[168:171], a[180:183], v[68:71]
  v_mul_f32 v39, v39, v203
  v_mul_f32 v199, v43, v43
  v_mfma_f32_16x16x32_bf16 v[72:75], v[160:163], a[152:155], v[72:75]
  ds_read_b64_tr_b16 v[190:191], v14 offset:7168
  v_fma_f32 v196, v196, v30, v26
  v_fma_f32 v197, v197, v30, v26
  v_mfma_f32_16x16x32_bf16 v[72:75], v[164:167], a[168:171], v[72:75]
  buffer_load_dwordx4 v3, s[4:7], s35 offen offset:1024 lds
  v_fma_f32 v198, v198, v30, v26
  v_mfma_f32_16x16x32_bf16 v[72:75], v[168:171], a[184:187], v[72:75]
  ds_read_b64_tr_b16 v[192:193], v14 offset:2048
  v_fma_f32 v199, v199, v30, v26
  v_mfma_f32_16x16x32_bf16 v[76:79], v[160:163], a[156:159], v[76:79]
  v_mul_f32 v196, v196, v40
  v_mul_f32 v197, v197, v41
  v_mfma_f32_16x16x32_bf16 v[76:79], v[164:167], a[172:175], v[76:79]
  ds_read_b64_tr_b16 v[194:195], v14 offset:8192
  v_mul_f32 v198, v198, v42
  v_mfma_f32_16x16x32_bf16 v[76:79], v[168:171], a[188:191], v[76:79]
  s_waitcnt lgkmcnt(6)
  buffer_load_dwordx4 v4, s[4:7], s35 offen offset:2048 lds
  v_exp_f32 v196, v196
  v_mfma_f32_16x16x32_bf16 v[80:83], v[172:175], a[144:147], v[80:83]
  ds_read_b64_tr_b16 v[160:161], v15 offset:0
  v_mul_f32 v199, v199, v43
  v_mfma_f32_16x16x32_bf16 v[80:83], v[176:179], a[160:163], v[80:83]
  s_add_u32 s35, s32, 3539328
  v_exp_f32 v197, v197
  v_mfma_f32_16x16x32_bf16 v[80:83], v[180:183], a[176:179], v[80:83]
  s_add_u32 m0, s31, 110592
  ds_read_b64_tr_b16 v[162:163], v15 offset:6144
  v_add_f32 v196, 1.0, v196
  v_mfma_f32_16x16x32_bf16 v[84:87], v[172:175], a[148:151], v[84:87]
  buffer_load_dwordx4 v2, s[4:7], s35 offen offset:0 lds
  v_add_f32 v197, 1.0, v197
  v_mfma_f32_16x16x32_bf16 v[84:87], v[176:179], a[164:167], v[84:87]
  ds_read_b64_tr_b16 v[164:165], v15 offset:1024
  v_mul_f32 v200, v44, v44
  v_mfma_f32_16x16x32_bf16 v[84:87], v[180:183], a[180:183], v[84:87]
  v_exp_f32 v198, v198
  v_mul_f32 v201, v45, v45
  v_mfma_f32_16x16x32_bf16 v[88:91], v[172:175], a[152:155], v[88:91]
  ds_read_b64_tr_b16 v[166:167], v15 offset:7168
  v_mul_f32 v202, v46, v46
  v_mfma_f32_16x16x32_bf16 v[88:91], v[176:179], a[168:171], v[88:91]
  buffer_load_dwordx4 v3, s[4:7], s35 offen offset:1024 lds
  v_add_f32 v198, 1.0, v198
  v_mfma_f32_16x16x32_bf16 v[88:91], v[180:183], a[184:187], v[88:91]
  ds_read_b64_tr_b16 v[168:169], v15 offset:2048
  v_mul_f32 v203, v47, v47
  v_mfma_f32_16x16x32_bf16 v[92:95], v[172:175], a[156:159], v[92:95]
  v_exp_f32 v199, v199
  v_mfma_f32_16x16x32_bf16 v[92:95], v[176:179], a[172:175], v[92:95]
  s_waitcnt lgkmcnt(5) vmcnt(11)
  ds_read_b64_tr_b16 v[170:171], v15 offset:8192
  v_fma_f32 v200, v200, v31, v27
  v_mfma_f32_16x16x32_bf16 v[92:95], v[180:183], a[188:191], v[92:95]
  s_barrier
  v_mfma_f32_16x16x32_bf16 v[64:67], v[184:187], a[192:195], v[64:67]
  s_add_u32 s3, s42, 8192
  buffer_store_dwordx4 v[204:207], v21, s[16:19], s3 offen offset:0 sc1
  ds_read_b64_tr_b16 v[172:173], v14 offset:12288
  v_add_f32 v199, 1.0, v199
  v_mfma_f32_16x16x32_bf16 v[64:67], v[188:191], a[208:211], v[64:67]
  v_rcp_f32 v196, v196
  v_mfma_f32_16x16x32_bf16 v[64:67], v[192:195], a[224:227], v[64:67]
  ds_read_b64_tr_b16 v[174:175], v14 offset:18432
  v_fma_f32 v201, v201, v31, v27
  v_mfma_f32_16x16x32_bf16 v[68:71], v[184:187], a[196:199], v[68:71]
  buffer_load_dwordx4 v4, s[4:7], s35 offen offset:2048 lds
  v_mul_f32 v40, v40, v196
  v_mfma_f32_16x16x32_bf16 v[68:71], v[188:191], a[212:215], v[68:71]
  ds_read_b64_tr_b16 v[176:177], v14 offset:13312
  v_rcp_f32 v197, v197
  v_mfma_f32_16x16x32_bf16 v[68:71], v[192:195], a[228:231], v[68:71]
  v_rcp_f32 v198, v198
  v_mfma_f32_16x16x32_bf16 v[72:75], v[184:187], a[200:203], v[72:75]
  ds_read_b64_tr_b16 v[178:179], v14 offset:19456
  v_mul_f32 v41, v41, v197
  v_mfma_f32_16x16x32_bf16 v[72:75], v[188:191], a[216:219], v[72:75]
  v_rcp_f32 v199, v199
  v_mfma_f32_16x16x32_bf16 v[72:75], v[192:195], a[232:235], v[72:75]
  ds_read_b64_tr_b16 v[180:181], v14 offset:14336
  v_mul_f32 v42, v42, v198
  v_mfma_f32_16x16x32_bf16 v[76:79], v[184:187], a[204:207], v[76:79]
  s_add_u32 s35, s32, 4424064
  v_mul_f32 v43, v43, v199
  v_fma_f32 v202, v202, v31, v27
  v_mfma_f32_16x16x32_bf16 v[76:79], v[188:191], a[220:223], v[76:79]
  s_add_u32 m0, s31, 49152
  ds_read_b64_tr_b16 v[182:183], v14 offset:20480
  v_fma_f32 v203, v203, v31, v27
  v_mul_f32 v200, v200, v44
  v_mfma_f32_16x16x32_bf16 v[76:79], v[192:195], a[236:239], v[76:79]
  s_waitcnt lgkmcnt(6)
  buffer_load_dwordx4 v2, s[4:7], s35 offen offset:0 lds
  v_mul_f32 v201, v201, v45
  v_mfma_f32_16x16x32_bf16 v[80:83], v[160:163], a[192:195], v[80:83]
  ds_read_b64_tr_b16 v[184:185], v15 offset:12288
  v_mul_f32 v202, v202, v46
  v_mfma_f32_16x16x32_bf16 v[80:83], v[164:167], a[208:211], v[80:83]
  v_exp_f32 v200, v200
  v_mfma_f32_16x16x32_bf16 v[80:83], v[168:171], a[224:227], v[80:83]
  ds_read_b64_tr_b16 v[186:187], v15 offset:18432
  v_mul_f32 v203, v203, v47
  v_mfma_f32_16x16x32_bf16 v[84:87], v[160:163], a[196:199], v[84:87]
  v_exp_f32 v201, v201
  v_mfma_f32_16x16x32_bf16 v[84:87], v[164:167], a[212:215], v[84:87]
  ds_read_b64_tr_b16 v[188:189], v15 offset:13312
  v_exp_f32 v202, v202
  v_mfma_f32_16x16x32_bf16 v[84:87], v[168:171], a[228:231], v[84:87]
  buffer_store_dwordx4 v[208:211], v21, s[16:19], s3 offen offset:1024 sc1
  v_mfma_f32_16x16x32_bf16 v[88:91], v[160:163], a[200:203], v[88:91]
  ds_read_b64_tr_b16 v[190:191], v15 offset:19456
  v_add_f32 v200, 1.0, v200
  v_mfma_f32_16x16x32_bf16 v[88:91], v[164:167], a[216:219], v[88:91]
  buffer_load_dwordx4 v3, s[4:7], s35 offen offset:1024 lds
  v_add_f32 v201, 1.0, v201
  v_mfma_f32_16x16x32_bf16 v[88:91], v[168:171], a[232:235], v[88:91]
  ds_read_b64_tr_b16 v[192:193], v15 offset:14336
  v_add_f32 v202, 1.0, v202
  v_mfma_f32_16x16x32_bf16 v[92:95], v[160:163], a[204:207], v[92:95]
  v_exp_f32 v203, v203
  v_mul_f32 v196, v48, v48
  v_mfma_f32_16x16x32_bf16 v[92:95], v[164:167], a[220:223], v[92:95]
  s_waitcnt lgkmcnt(5)
  ds_read_b64_tr_b16 v[194:195], v15 offset:20480
  v_mul_f32 v197, v49, v49
  v_mfma_f32_16x16x32_bf16 v[92:95], v[168:171], a[236:239], v[92:95]
  v_rcp_f32 v200, v200
  v_mfma_f32_16x16x32_bf16 v[64:67], v[172:175], a[240:243], v[64:67]
  ds_read_b64_tr_b16 v[160:161], v12 offset:0
  v_min_u32 v0, 2, v1
  v_mfma_f32_16x16x32_bf16 v[64:67], v[176:179], v[224:227], v[64:67]
  v_rcp_f32 v201, v201
  v_mfma_f32_16x16x32_bf16 v[64:67], v[180:183], v[240:243], v[64:67]
  ds_read_b64_tr_b16 v[162:163], v12 offset:6144
  v_lshl_add_u32 v0, v0, 7, s101
  v_mfma_f32_16x16x32_bf16 v[68:71], v[172:175], a[244:247], v[68:71]
  buffer_load_dwordx4 v4, s[4:7], s35 offen offset:2048 lds
  v_rcp_f32 v202, v202
  v_mfma_f32_16x16x32_bf16 v[68:71], v[176:179], v[228:231], v[68:71]
  ds_read_b64_tr_b16 v[164:165], v12 offset:1024
  v_min_u32 v0, L_end-L_pcbase, v0
  v_mfma_f32_16x16x32_bf16 v[68:71], v[180:183], v[244:247], v[68:71]
  global_load_dword v220, v0, s[0:1] sc1
  v_add_f32 v203, 1.0, v203
  v_mfma_f32_16x16x32_bf16 v[72:75], v[172:175], a[248:251], v[72:75]
  ds_read_b64_tr_b16 v[166:167], v12 offset:7168
  v_mul_f32 v44, v44, v200
  v_mfma_f32_16x16x32_bf16 v[72:75], v[176:179], v[232:235], v[72:75]
  v_rcp_f32 v203, v203
  v_mfma_f32_16x16x32_bf16 v[72:75], v[180:183], v[248:251], v[72:75]
  ds_read_b64_tr_b16 v[168:169], v12 offset:2048
  v_mul_f32 v45, v45, v201
  v_mfma_f32_16x16x32_bf16 v[76:79], v[172:175], a[252:255], v[76:79]
  s_add_u32 s35, s32, 384
  buffer_store_dwordx4 v[212:215], v21, s[16:19], s3 offen offset:2048 sc1
  v_mul_f32 v46, v46, v202
  v_mfma_f32_16x16x32_bf16 v[76:79], v[176:179], v[236:239], v[76:79]
  s_add_u32 m0, s31, 147456
  ds_read_b64_tr_b16 v[170:171], v12 offset:8192
  v_mul_f32 v47, v47, v203
  v_mfma_f32_16x16x32_bf16 v[76:79], v[180:183], v[252:255], v[76:79]
  s_waitcnt lgkmcnt(6)
  buffer_load_dwordx4 v2, s[8:11], s35 offen offset:0 lds
  v_mul_f32 v198, v50, v50
  v_mfma_f32_16x16x32_bf16 v[80:83], v[184:187], a[240:243], v[80:83]
  ds_read_b64_tr_b16 v[172:173], v13 offset:0
  v_mul_f32 v199, v51, v51
  v_mfma_f32_16x16x32_bf16 v[80:83], v[188:191], v[224:227], v[80:83]
  v_fma_f32 v196, v196, v28, v24
  v_fma_f32 v197, v197, v28, v24
  v_mfma_f32_16x16x32_bf16 v[80:83], v[192:195], v[240:243], v[80:83]
  ds_read_b64_tr_b16 v[174:175], v13 offset:6144
  v_fma_f32 v198, v198, v28, v24
  v_fma_f32 v199, v199, v28, v24
  v_mfma_f32_16x16x32_bf16 v[84:87], v[184:187], a[244:247], v[84:87]
  v_mul_f32 v196, v196, v48
  v_mul_f32 v197, v197, v49
  v_mfma_f32_16x16x32_bf16 v[84:87], v[188:191], v[228:231], v[84:87]
  ds_read_b64_tr_b16 v[176:177], v13 offset:1024
  v_mul_f32 v198, v198, v50
  v_mfma_f32_16x16x32_bf16 v[84:87], v[192:195], v[244:247], v[84:87]
  v_exp_f32 v196, v196
  v_mfma_f32_16x16x32_bf16 v[88:91], v[184:187], a[248:251], v[88:91]
  ds_read_b64_tr_b16 v[178:179], v13 offset:7168
  v_mul_f32 v199, v199, v51
  v_mfma_f32_16x16x32_bf16 v[88:91], v[188:191], v[232:235], v[88:91]
  buffer_load_dwordx4 v3, s[8:11], s35 offen offset:1024 lds
  v_add_f32 v196, 1.0, v196
  v_mfma_f32_16x16x32_bf16 v[88:91], v[192:195], v[248:251], v[88:91]
  ds_read_b64_tr_b16 v[180:181], v13 offset:2048
  v_exp_f32 v197, v197
  v_mfma_f32_16x16x32_bf16 v[92:95], v[184:187], a[252:255], v[92:95]
  v_exp_f32 v198, v198
  v_mfma_f32_16x16x32_bf16 v[92:95], v[188:191], v[236:239], v[92:95]
  s_waitcnt lgkmcnt(5) vmcnt(15)
  ds_read_b64_tr_b16 v[182:183], v13 offset:8192
  v_add_f32 v197, 1.0, v197
  v_mfma_f32_16x16x32_bf16 v[92:95], v[192:195], v[252:255], v[92:95]
L_wu_s2_1:
L_st_d000:
  s_cbranch_execz L_st_e000
  s_barrier
  v_mfma_f32_16x16x32_bf16 v[96:99], v[160:163], a[0:3], 0
  ds_read_b64_tr_b16 v[184:185], v12 offset:12288
  v_add_f32 v198, 1.0, v198
  v_mfma_f32_16x16x32_bf16 v[96:99], v[164:167], a[16:19], v[96:99]
  buffer_store_dwordx4 v[216:219], v21, s[16:19], s3 offen offset:3072 sc1
  v_mul_f32 v200, v52, v52
  v_mfma_f32_16x16x32_bf16 v[96:99], v[168:171], a[32:35], v[96:99]
  ds_read_b64_tr_b16 v[186:187], v12 offset:18432
  v_mul_f32 v201, v53, v53
  v_mfma_f32_16x16x32_bf16 v[100:103], v[160:163], a[4:7], 0
  buffer_load_dwordx4 v4, s[8:11], s35 offen offset:2048 lds
  v_mul_f32 v202, v54, v54
  v_mfma_f32_16x16x32_bf16 v[100:103], v[164:167], a[20:23], v[100:103]
  ds_read_b64_tr_b16 v[188:189], v12 offset:13312
  v_mul_f32 v203, v55, v55
  v_mfma_f32_16x16x32_bf16 v[100:103], v[168:171], a[36:39], v[100:103]
  v_exp_f32 v199, v199
  v_mfma_f32_16x16x32_bf16 v[104:107], v[160:163], a[8:11], 0
  ds_read_b64_tr_b16 v[190:191], v12 offset:19456
  v_fma_f32 v200, v200, v29, v25
  v_mfma_f32_16x16x32_bf16 v[104:107], v[164:167], a[24:27], v[104:107]
  v_rcp_f32 v196, v196
  v_add_f32 v199, 1.0, v199
  v_mfma_f32_16x16x32_bf16 v[104:107], v[168:171], a[40:43], v[104:107]
  ds_read_b64_tr_b16 v[192:193], v12 offset:14336
  v_fma_f32 v201, v201, v29, v25
  v_mfma_f32_16x16x32_bf16 v[108:111], v[160:163], a[12:15], 0
  s_add_u32 s35, s32, 885120
  v_rcp_f32 v197, v197
  v_mfma_f32_16x16x32_bf16 v[108:111], v[164:167], a[28:31], v[108:111]
  s_add_u32 m0, s31, 61440
  ds_read_b64_tr_b16 v[194:195], v12 offset:20480
  v_mul_f32 v48, v48, v196
  v_mfma_f32_16x16x32_bf16 v[108:111], v[168:171], a[44:47], v[108:111]
  s_waitcnt lgkmcnt(6)
  buffer_load_dwordx4 v2, s[8:11], s35 offen offset:0 lds
  v_mul_f32 v49, v49, v197
  v_mfma_f32_16x16x32_bf16 v[112:115], v[172:175], a[0:3], 0
  ds_read_b64_tr_b16 v[160:161], v13 offset:12288
  v_rcp_f32 v198, v198
  v_mfma_f32_16x16x32_bf16 v[112:115], v[176:179], a[16:19], v[112:115]
  v_rcp_f32 v199, v199
  v_mfma_f32_16x16x32_bf16 v[112:115], v[180:183], a[32:35], v[112:115]
  ds_read_b64_tr_b16 v[162:163], v13 offset:18432
  v_mul_f32 v50, v50, v198
  v_mfma_f32_16x16x32_bf16 v[116:119], v[172:175], a[4:7], 0
  v_mul_f32 v51, v51, v199
  v_fma_f32 v202, v202, v29, v25
  v_mfma_f32_16x16x32_bf16 v[116:119], v[176:179], a[20:23], v[116:119]
  ds_read_b64_tr_b16 v[164:165], v13 offset:13312
  v_fma_f32 v203, v203, v29, v25
  v_mfma_f32_16x16x32_bf16 v[116:119], v[180:183], a[36:39], v[116:119]
  v_mul_f32 v200, v200, v52
  v_mul_f32 v201, v201, v53
  v_mfma_f32_16x16x32_bf16 v[120:123], v[172:175], a[8:11], 0
  ds_read_b64_tr_b16 v[166:167], v13 offset:19456
  v_exp_f32 v200, v200
  v_mfma_f32_16x16x32_bf16 v[120:123], v[176:179], a[24:27], v[120:123]
  buffer_load_dwordx4 v3, s[8:11], s35 offen offset:1024 lds
  v_mul_f32 v202, v202, v54
  v_mfma_f32_16x16x32_bf16 v[120:123], v[180:183], a[40:43], v[120:123]
  ds_read_b64_tr_b16 v[168:169], v13 offset:14336
  v_mul_f32 v203, v203, v55
  v_mfma_f32_16x16x32_bf16 v[124:127], v[172:175], a[12:15], 0
  v_exp_f32 v201, v201
  v_mfma_f32_16x16x32_bf16 v[124:127], v[176:179], a[28:31], v[124:127]
  s_waitcnt lgkmcnt(5)
  ds_read_b64_tr_b16 v[170:171], v13 offset:20480
  v_add_f32 v200, 1.0, v200
  v_mfma_f32_16x16x32_bf16 v[124:127], v[180:183], a[44:47], v[124:127]
  v_exp_f32 v202, v202
  v_add_f32 v201, 1.0, v201
  v_mfma_f32_16x16x32_bf16 v[96:99], v[184:187], a[48:51], v[96:99]
  ds_read_b64_tr_b16 v[172:173], v12 offset:24576
  v_mul_f32 v196, v56, v56
  v_mfma_f32_16x16x32_bf16 v[96:99], v[188:191], a[64:67], v[96:99]
  v_exp_f32 v203, v203
  v_mfma_f32_16x16x32_bf16 v[96:99], v[192:195], a[80:83], v[96:99]
  ds_read_b64_tr_b16 v[174:175], v12 offset:30720
  v_add_f32 v202, 1.0, v202
  v_mfma_f32_16x16x32_bf16 v[100:103], v[184:187], a[52:55], v[100:103]
  buffer_load_dwordx4 v4, s[8:11], s35 offen offset:2048 lds
  v_add_f32 v203, 1.0, v203
  v_mfma_f32_16x16x32_bf16 v[100:103], v[188:191], a[68:71], v[100:103]
  ds_read_b64_tr_b16 v[176:177], v12 offset:25600
  v_mul_f32 v197, v57, v57
  v_mfma_f32_16x16x32_bf16 v[100:103], v[192:195], a[84:87], v[100:103]
  v_rcp_f32 v200, v200
  v_mul_f32 v198, v58, v58
  v_mfma_f32_16x16x32_bf16 v[104:107], v[184:187], a[56:59], v[104:107]
  ds_read_b64_tr_b16 v[178:179], v12 offset:31744
  v_mul_f32 v199, v59, v59
  v_mfma_f32_16x16x32_bf16 v[104:107], v[188:191], a[72:75], v[104:107]
  v_rcp_f32 v201, v201
  v_mfma_f32_16x16x32_bf16 v[104:107], v[192:195], a[88:91], v[104:107]
  ds_read_b64_tr_b16 v[180:181], v12 offset:26624
  v_mul_f32 v52, v52, v200
  v_mfma_f32_16x16x32_bf16 v[108:111], v[184:187], a[60:63], v[108:111]
  s_add_u32 s35, s32, 1769856
  v_rcp_f32 v202, v202
  v_mfma_f32_16x16x32_bf16 v[108:111], v[188:191], a[76:79], v[108:111]
  s_add_u32 m0, s31, 73728
  ds_read_b64_tr_b16 v[182:183], v12 offset:32768
  v_rcp_f32 v203, v203
  v_mfma_f32_16x16x32_bf16 v[108:111], v[192:195], a[92:95], v[108:111]
  s_waitcnt lgkmcnt(6)
  buffer_load_dwordx4 v2, s[8:11], s35 offen offset:0 lds
  v_mul_f32 v53, v53, v201
  v_mfma_f32_16x16x32_bf16 v[112:115], v[160:163], a[48:51], v[112:115]
  ds_read_b64_tr_b16 v[184:185], v13 offset:24576
  v_mul_f32 v54, v54, v202
  v_mfma_f32_16x16x32_bf16 v[112:115], v[164:167], a[64:67], v[112:115]
  v_mul_f32 v55, v55, v203
  v_fma_f32 v196, v196, v30, v26
  v_mfma_f32_16x16x32_bf16 v[112:115], v[168:171], a[80:83], v[112:115]
  ds_read_b64_tr_b16 v[186:187], v13 offset:30720
  v_fma_f32 v197, v197, v30, v26
  v_mfma_f32_16x16x32_bf16 v[116:119], v[160:163], a[52:55], v[116:119]
  v_fma_f32 v198, v198, v30, v26
  v_fma_f32 v199, v199, v30, v26
  v_mfma_f32_16x16x32_bf16 v[116:119], v[164:167], a[68:71], v[116:119]
  ds_read_b64_tr_b16 v[188:189], v13 offset:25600
  v_mul_f32 v196, v196, v56
  v_mul_f32 v197, v197, v57
  v_mfma_f32_16x16x32_bf16 v[116:119], v[168:171], a[84:87], v[116:119]
  v_exp_f32 v196, v196
  v_mfma_f32_16x16x32_bf16 v[120:123], v[160:163], a[56:59], v[120:123]
  ds_read_b64_tr_b16 v[190:191], v13 offset:31744
  v_mul_f32 v198, v198, v58
  v_mfma_f32_16x16x32_bf16 v[120:123], v[164:167], a[72:75], v[120:123]
  buffer_load_dwordx4 v3, s[8:11], s35 offen offset:1024 lds
  v_mul_f32 v199, v199, v59
  v_mfma_f32_16x16x32_bf16 v[120:123], v[168:171], a[88:91], v[120:123]
  ds_read_b64_tr_b16 v[192:193], v13 offset:26624
  v_add_f32 v196, 1.0, v196
  v_mfma_f32_16x16x32_bf16 v[124:127], v[160:163], a[60:63], v[124:127]
  v_exp_f32 v197, v197
  v_mul_f32 v200, v60, v60
  v_mfma_f32_16x16x32_bf16 v[124:127], v[164:167], a[76:79], v[124:127]
  s_waitcnt lgkmcnt(5) vmcnt(15)
  ds_read_b64_tr_b16 v[194:195], v13 offset:32768
  v_mul_f32 v201, v61, v61
  v_mfma_f32_16x16x32_bf16 v[124:127], v[168:171], a[92:95], v[124:127]
  s_barrier
  v_mfma_f32_16x16x32_bf16 v[96:99], v[172:175], a[96:99], v[96:99]
  ds_read_b64_tr_b16 v[160:161], v12 offset:36864
  v_add_f32 v197, 1.0, v197
  v_mfma_f32_16x16x32_bf16 v[96:99], v[176:179], a[112:115], v[96:99]
  v_exp_f32 v198, v198
  v_mfma_f32_16x16x32_bf16 v[96:99], v[180:183], a[128:131], v[96:99]
  ds_read_b64_tr_b16 v[162:163], v12 offset:43008
  v_mul_f32 v202, v62, v62
  v_mfma_f32_16x16x32_bf16 v[100:103], v[172:175], a[100:103], v[100:103]
  buffer_load_dwordx4 v4, s[8:11], s35 offen offset:2048 lds
  v_exp_f32 v199, v199
  v_mfma_f32_16x16x32_bf16 v[100:103], v[176:179], a[116:119], v[100:103]
  ds_read_b64_tr_b16 v[164:165], v12 offset:37888
  v_add_f32 v198, 1.0, v198
  v_mfma_f32_16x16x32_bf16 v[100:103], v[180:183], a[132:135], v[100:103]
  v_rcp_f32 v196, v196
  v_mfma_f32_16x16x32_bf16 v[104:107], v[172:175], a[104:107], v[104:107]
  ds_read_b64_tr_b16 v[166:167], v12 offset:44032
  v_add_f32 v199, 1.0, v199
  v_mfma_f32_16x16x32_bf16 v[104:107], v[176:179], a[120:123], v[104:107]
  v_rcp_f32 v197, v197
  v_mfma_f32_16x16x32_bf16 v[104:107], v[180:183], a[136:139], v[104:107]
  ds_read_b64_tr_b16 v[168:169], v12 offset:38912
  v_rcp_f32 v198, v198
  v_mfma_f32_16x16x32_bf16 v[108:111], v[172:175], a[108:111], v[108:111]
  s_add_u32 s35, s32, 2654592
  v_rcp_f32 v199, v199
  v_mfma_f32_16x16x32_bf16 v[108:111], v[176:179], a[124:127], v[108:111]
  s_add_u32 m0, s31, 0
  ds_read_b64_tr_b16 v[170:171], v12 offset:45056
  v_mul_f32 v56, v56, v196
  v_mfma_f32_16x16x32_bf16 v[108:111], v[180:183], a[140:143], v[108:111]
  s_waitcnt lgkmcnt(6)
  buffer_load_dwordx4 v2, s[8:11], s35 offen offset:0 lds
  v_mul_f32 v57, v57, v197
  v_mfma_f32_16x16x32_bf16 v[112:115], v[184:187], a[96:99], v[112:115]
  ds_read_b64_tr_b16 v[172:173], v13 offset:36864
  v_mul_f32 v58, v58, v198
  v_mfma_f32_16x16x32_bf16 v[112:115], v[188:191], a[112:115], v[112:115]
  v_mul_f32 v59, v59, v199
  v_mul_f32 v203, v63, v63
  v_mfma_f32_16x16x32_bf16 v[112:115], v[192:195], a[128:131], v[112:115]
  ds_read_b64_tr_b16 v[174:175], v13 offset:43008
  v_fma_f32 v200, v200, v31, v27
  v_fma_f32 v201, v201, v31, v27
  v_mfma_f32_16x16x32_bf16 v[116:119], v[184:187], a[100:103], v[116:119]
  v_fma_f32 v202, v202, v31, v27
  v_fma_f32 v203, v203, v31, v27
  v_mfma_f32_16x16x32_bf16 v[116:119], v[188:191], a[116:119], v[116:119]
  ds_read_b64_tr_b16 v[176:177], v13 offset:37888
  v_mul_f32 v200, v200, v60
  v_mfma_f32_16x16x32_bf16 v[116:119], v[192:195], a[132:135], v[116:119]
  v_exp_f32 v200, v200
  v_mfma_f32_16x16x32_bf16 v[120:123], v[184:187], a[104:107], v[120:123]
  ds_read_b64_tr_b16 v[178:179], v13 offset:44032
  v_mul_f32 v201, v201, v61
  v_mfma_f32_16x16x32_bf16 v[120:123], v[188:191], a[120:123], v[120:123]
  buffer_load_dwordx4 v3, s[8:11], s35 offen offset:1024 lds
  v_mul_f32 v202, v202, v62
  v_mfma_f32_16x16x32_bf16 v[120:123], v[192:195], a[136:139], v[120:123]
  ds_read_b64_tr_b16 v[180:181], v13 offset:38912
  v_exp_f32 v201, v201
  v_mfma_f32_16x16x32_bf16 v[124:127], v[184:187], a[108:111], v[124:127]
  v_exp_f32 v202, v202
  v_mfma_f32_16x16x32_bf16 v[124:127], v[188:191], a[124:127], v[124:127]
  s_waitcnt lgkmcnt(5)
  ds_read_b64_tr_b16 v[182:183], v13 offset:45056
  v_mul_f32 v203, v203, v63
  v_mfma_f32_16x16x32_bf16 v[124:127], v[192:195], a[140:143], v[124:127]
  v_exp_f32 v203, v203
  v_mfma_f32_16x16x32_bf16 v[96:99], v[160:163], a[144:147], v[96:99]
  ds_read_b64_tr_b16 v[184:185], v14 offset:49152
  v_add_f32 v200, 1.0, v200
  v_mfma_f32_16x16x32_bf16 v[96:99], v[164:167], a[160:163], v[96:99]
  v_rcp_f32 v200, v200
  v_add_f32 v201, 1.0, v201
  v_mfma_f32_16x16x32_bf16 v[96:99], v[168:171], a[176:179], v[96:99]
  ds_read_b64_tr_b16 v[186:187], v14 offset:55296
  v_add_f32 v202, 1.0, v202
  v_mfma_f32_16x16x32_bf16 v[100:103], v[160:163], a[148:151], v[100:103]
  buffer_load_dwordx4 v4, s[8:11], s35 offen offset:2048 lds
  v_add_f32 v203, 1.0, v203
  v_mfma_f32_16x16x32_bf16 v[100:103], v[164:167], a[164:167], v[100:103]
  ds_read_b64_tr_b16 v[188:189], v14 offset:50176
  v_mul_f32 v60, v60, v200
  v_mfma_f32_16x16x32_bf16 v[100:103], v[168:171], a[180:183], v[100:103]
  v_rcp_f32 v201, v201
  v_mfma_f32_16x16x32_bf16 v[104:107], v[160:163], a[152:155], v[104:107]
  ds_read_b64_tr_b16 v[190:191], v14 offset:56320
  v_mul_f32 v64, v64, v32
  v_mfma_f32_16x16x32_bf16 v[104:107], v[164:167], a[168:171], v[104:107]
  v_rcp_f32 v202, v202
  v_mul_f32 v61, v61, v201
  v_mfma_f32_16x16x32_bf16 v[104:107], v[168:171], a[184:187], v[104:107]
  ds_read_b64_tr_b16 v[192:193], v14 offset:51200
  v_mul_f32 v65, v65, v33
  v_mfma_f32_16x16x32_bf16 v[108:111], v[160:163], a[156:159], v[108:111]
  s_add_u32 s35, s32, 3539328
  v_rcp_f32 v203, v203
  v_mfma_f32_16x16x32_bf16 v[108:111], v[164:167], a[172:175], v[108:111]
  s_add_u32 m0, s31, 12288
  ds_read_b64_tr_b16 v[194:195], v14 offset:57344
  v_mul_f32 v62, v62, v202
  v_mfma_f32_16x16x32_bf16 v[108:111], v[168:171], a[188:191], v[108:111]
  s_waitcnt lgkmcnt(6)
  buffer_load_dwordx4 v2, s[8:11], s35 offen offset:0 lds
  v_mul_f32 v63, v63, v203
  v_mfma_f32_16x16x32_bf16 v[112:115], v[172:175], a[144:147], v[112:115]
  ds_read_b64_tr_b16 v[160:161], v15 offset:49152
  v_mul_f32 v66, v66, v34
  v_mfma_f32_16x16x32_bf16 v[112:115], v[176:179], a[160:163], v[112:115]
  v_mul_f32 v67, v67, v35
  v_cvt_pk_bf16_f32 v204, v64, v65
  v_cvt_pk_bf16_f32 v205, v66, v67
  v_mfma_f32_16x16x32_bf16 v[112:115], v[180:183], a[176:179], v[112:115]
  ds_read_b64_tr_b16 v[162:163], v15 offset:55296
  v_mul_f32 v80, v80, v48
  v_mfma_f32_16x16x32_bf16 v[116:119], v[172:175], a[148:151], v[116:119]
  v_mul_f32 v81, v81, v49
  v_mul_f32 v82, v82, v50
  v_mfma_f32_16x16x32_bf16 v[116:119], v[176:179], a[164:167], v[116:119]
  ds_read_b64_tr_b16 v[164:165], v15 offset:50176
  v_mul_f32 v83, v83, v51
  v_mfma_f32_16x16x32_bf16 v[116:119], v[180:183], a[180:183], v[116:119]
  v_cvt_pk_bf16_f32 v206, v80, v81
  v_cvt_pk_bf16_f32 v207, v82, v83
  v_mfma_f32_16x16x32_bf16 v[120:123], v[172:175], a[152:155], v[120:123]
  ds_read_b64_tr_b16 v[166:167], v15 offset:56320
  v_mul_f32 v68, v68, v36
  v_mfma_f32_16x16x32_bf16 v[120:123], v[176:179], a[168:171], v[120:123]
  buffer_load_dwordx4 v3, s[8:11], s35 offen offset:1024 lds
  ds_write_b128 v21, v[204:207] offset:16384
  v_mfma_f32_16x16x32_bf16 v[120:123], v[180:183], a[184:187], v[120:123]
  ds_read_b64_tr_b16 v[168:169], v15 offset:51200
  v_mul_f32 v69, v69, v37
  v_mfma_f32_16x16x32_bf16 v[124:127], v[172:175], a[156:159], v[124:127]
  v_mul_f32 v70, v70, v38
  v_mul_f32 v71, v71, v39
  v_mfma_f32_16x16x32_bf16 v[124:127], v[176:179], a[172:175], v[124:127]
  s_waitcnt lgkmcnt(6) vmcnt(11)
  ds_read_b64_tr_b16 v[170:171], v15 offset:57344
  v_cvt_pk_bf16_f32 v208, v68, v69
  v_mfma_f32_16x16x32_bf16 v[124:127], v[180:183], a[188:191], v[124:127]
  s_barrier
  v_mfma_f32_16x16x32_bf16 v[96:99], v[184:187], a[192:195], v[96:99]
  ds_read_b64_tr_b16 v[172:173], v12 offset:49152
  v_cvt_pk_bf16_f32 v209, v70, v71
  v_mul_f32 v84, v84, v52
  v_mfma_f32_16x16x32_bf16 v[96:99], v[188:191], a[208:211], v[96:99]
  v_mul_f32 v85, v85, v53
  v_mul_f32 v86, v86, v54
  v_mfma_f32_16x16x32_bf16 v[96:99], v[192:195], a[224:227], v[96:99]
  ds_read_b64_tr_b16 v[174:175], v12 offset:55296
  v_mul_f32 v87, v87, v55
  v_mfma_f32_16x16x32_bf16 v[100:103], v[184:187], a[196:199], v[100:103]
  buffer_load_dwordx4 v4, s[8:11], s35 offen offset:2048 lds
  v_cvt_pk_bf16_f32 v210, v84, v85
  v_mfma_f32_16x16x32_bf16 v[100:103], v[188:191], a[212:215], v[100:103]
  ds_read_b64_tr_b16 v[176:177], v12 offset:50176
  v_cvt_pk_bf16_f32 v211, v86, v87
  v_mfma_f32_16x16x32_bf16 v[100:103], v[192:195], a[228:231], v[100:103]
  ds_write_b128 v21, v[208:211] offset:17408
  v_mfma_f32_16x16x32_bf16 v[104:107], v[184:187], a[200:203], v[104:107]
  ds_read_b64_tr_b16 v[178:179], v12 offset:56320
  v_mul_f32 v72, v72, v40
  v_mul_f32 v73, v73, v41
  v_mfma_f32_16x16x32_bf16 v[104:107], v[188:191], a[216:219], v[104:107]
  v_mul_f32 v74, v74, v42
  v_mul_f32 v75, v75, v43
  v_mfma_f32_16x16x32_bf16 v[104:107], v[192:195], a[232:235], v[104:107]
  ds_read_b64_tr_b16 v[180:181], v12 offset:51200
  v_cvt_pk_bf16_f32 v212, v72, v73
  v_mfma_f32_16x16x32_bf16 v[108:111], v[184:187], a[204:207], v[108:111]
  s_add_u32 s35, s32, 4424064
  v_cvt_pk_bf16_f32 v213, v74, v75
  v_mul_f32 v88, v88, v56
  v_mfma_f32_16x16x32_bf16 v[108:111], v[188:191], a[220:223], v[108:111]
  s_add_u32 m0, s31, 24576
  ds_read_b64_tr_b16 v[182:183], v12 offset:57344
  v_mul_f32 v89, v89, v57
  v_mfma_f32_16x16x32_bf16 v[108:111], v[192:195], a[236:239], v[108:111]
  s_waitcnt lgkmcnt(7)
  buffer_load_dwordx4 v2, s[8:11], s35 offen offset:0 lds
  v_mul_f32 v90, v90, v58
  v_mfma_f32_16x16x32_bf16 v[112:115], v[160:163], a[192:195], v[112:115]
  ds_read_b64_tr_b16 v[184:185], v13 offset:49152
  v_mul_f32 v91, v91, v59
  v_mfma_f32_16x16x32_bf16 v[112:115], v[164:167], a[208:211], v[112:115]
  v_cvt_pk_bf16_f32 v214, v88, v89
  v_cvt_pk_bf16_f32 v215, v90, v91
  v_mul_f32 v76, v76, v44
  v_mfma_f32_16x16x32_bf16 v[112:115], v[168:171], a[224:227], v[112:115]
  ds_read_b64_tr_b16 v[186:187], v13 offset:55296
  v_mul_f32 v77, v77, v45
  v_mfma_f32_16x16x32_bf16 v[116:119], v[160:163], a[196:199], v[116:119]
  ds_write_b128 v21, v[212:215] offset:18432
  v_mfma_f32_16x16x32_bf16 v[116:119], v[164:167], a[212:215], v[116:119]
  ds_read_b64_tr_b16 v[188:189], v13 offset:50176
  v_mul_f32 v78, v78, v46
  v_mfma_f32_16x16x32_bf16 v[116:119], v[168:171], a[228:231], v[116:119]
  v_mul_f32 v79, v79, v47
  v_cvt_pk_bf16_f32 v216, v76, v77
  v_mfma_f32_16x16x32_bf16 v[120:123], v[160:163], a[200:203], v[120:123]
  ds_read_b64_tr_b16 v[190:191], v13 offset:56320
  v_cvt_pk_bf16_f32 v217, v78, v79
  v_mfma_f32_16x16x32_bf16 v[120:123], v[164:167], a[216:219], v[120:123]
  buffer_load_dwordx4 v3, s[8:11], s35 offen offset:1024 lds
  v_mul_f32 v92, v92, v60
  v_mul_f32 v93, v93, v61
  v_mfma_f32_16x16x32_bf16 v[120:123], v[168:171], a[232:235], v[120:123]
  ds_read_b64_tr_b16 v[192:193], v13 offset:51200
  v_mul_f32 v94, v94, v62
  v_mfma_f32_16x16x32_bf16 v[124:127], v[160:163], a[204:207], v[124:127]
  v_mul_f32 v95, v95, v63
  v_cvt_pk_bf16_f32 v218, v92, v93
  v_mfma_f32_16x16x32_bf16 v[124:127], v[164:167], a[220:223], v[124:127]
  s_waitcnt lgkmcnt(6)
  ds_read_b64_tr_b16 v[194:195], v13 offset:57344
  v_cvt_pk_bf16_f32 v219, v94, v95
  v_mfma_f32_16x16x32_bf16 v[124:127], v[168:171], a[236:239], v[124:127]
  ds_write_b128 v21, v[216:219] offset:19456
  v_mfma_f32_16x16x32_bf16 v[96:99], v[172:175], a[240:243], v[96:99]
  ds_read_b64_tr_b16 v[160:161], v11 offset:24576
  v_mfma_f32_16x16x32_bf16 v[96:99], v[176:179], v[224:227], v[96:99]
  v_mfma_f32_16x16x32_bf16 v[96:99], v[180:183], v[240:243], v[96:99]
  ds_read_b64_tr_b16 v[162:163], v11 offset:30720
  v_mfma_f32_16x16x32_bf16 v[100:103], v[172:175], a[244:247], v[100:103]
  buffer_load_dwordx4 v4, s[8:11], s35 offen offset:2048 lds
  v_mfma_f32_16x16x32_bf16 v[100:103], v[176:179], v[228:231], v[100:103]
  ds_read_b64_tr_b16 v[164:165], v11 offset:25600
  v_mfma_f32_16x16x32_bf16 v[100:103], v[180:183], v[244:247], v[100:103]
  v_mfma_f32_16x16x32_bf16 v[104:107], v[172:175], a[248:251], v[104:107]
  ds_read_b64_tr_b16 v[166:167], v11 offset:31744
  v_mfma_f32_16x16x32_bf16 v[104:107], v[176:179], v[232:235], v[104:107]
  v_mfma_f32_16x16x32_bf16 v[104:107], v[180:183], v[248:251], v[104:107]
  ds_read_b64_tr_b16 v[168:169], v11 offset:26624
  v_mfma_f32_16x16x32_bf16 v[108:111], v[172:175], a[252:255], v[108:111]
  s_add_u32 s35, s33, 0
  v_mfma_f32_16x16x32_bf16 v[108:111], v[176:179], v[236:239], v[108:111]
  s_add_u32 m0, s31, 36864
  ds_read_b64_tr_b16 v[170:171], v11 offset:32768
  v_mul_f32 v196, v96, v96
  v_mul_f32 v197, v97, v97
  v_mfma_f32_16x16x32_bf16 v[108:111], v[180:183], v[252:255], v[108:111]
  s_waitcnt lgkmcnt(7)
  buffer_load_dwordx4 v5, s[4:7], s35 offen offset:0 lds
  v_mul_f32 v198, v98, v98
  v_mul_f32 v199, v99, v99
  v_mfma_f32_16x16x32_bf16 v[112:115], v[184:187], a[240:243], v[112:115]
  ds_read_b64_tr_b16 v[172:173], v221 offset:24576
  v_fma_f32 v196, v196, v28, v24
  v_mfma_f32_16x16x32_bf16 v[112:115], v[188:191], v[224:227], v[112:115]
  v_fma_f32 v197, v197, v28, v24
  v_fma_f32 v198, v198, v28, v24
  v_fma_f32 v199, v199, v28, v24
  v_mfma_f32_16x16x32_bf16 v[112:115], v[192:195], v[240:243], v[112:115]
  ds_read_b64_tr_b16 v[174:175], v221 offset:30720
  v_mul_f32 v196, v196, v96
  v_mfma_f32_16x16x32_bf16 v[116:119], v[184:187], a[244:247], v[116:119]
  v_exp_f32 v196, v196
  v_mfma_f32_16x16x32_bf16 v[116:119], v[188:191], v[228:231], v[116:119]
  ds_read_b64_tr_b16 v[176:177], v221 offset:25600
  v_mul_f32 v197, v197, v97
  v_mfma_f32_16x16x32_bf16 v[116:119], v[192:195], v[244:247], v[116:119]
  v_exp_f32 v197, v197
  v_mfma_f32_16x16x32_bf16 v[120:123], v[184:187], a[248:251], v[120:123]
  ds_read_b64_tr_b16 v[178:179], v221 offset:31744
  v_mul_f32 v198, v198, v98
  v_mul_f32 v199, v199, v99
  v_mfma_f32_16x16x32_bf16 v[120:123], v[188:191], v[232:235], v[120:123]
  buffer_load_dwordx4 v6, s[4:7], s35 offen offset:1024 lds
  v_add_f32 v196, 1.0, v196
  v_mfma_f32_16x16x32_bf16 v[120:123], v[192:195], v[248:251], v[120:123]
  ds_read_b64_tr_b16 v[180:181], v221 offset:26624
  v_add_f32 v197, 1.0, v197
  v_mfma_f32_16x16x32_bf16 v[124:127], v[184:187], a[252:255], v[124:127]
  v_exp_f32 v198, v198
  v_mfma_f32_16x16x32_bf16 v[124:127], v[188:191], v[236:239], v[124:127]
  s_waitcnt lgkmcnt(5) vmcnt(11)
  ds_read_b64_tr_b16 v[182:183], v221 offset:32768
  v_mul_f32 v200, v100, v100
  v_mfma_f32_16x16x32_bf16 v[124:127], v[192:195], v[252:255], v[124:127]
  s_barrier
  v_mfma_f32_16x16x32_bf16 v[128:131], v[160:163], a[0:3], 0
  ds_read_b64_tr_b16 v[184:185], v14 offset:0
  v_exp_f32 v199, v199
  v_mfma_f32_16x16x32_bf16 v[128:131], v[164:167], a[16:19], v[128:131]
  v_rcp_f32 v196, v196
  v_mfma_f32_16x16x32_bf16 v[128:131], v[168:171], a[32:35], v[128:131]
  ds_read_b64_tr_b16 v[186:187], v14 offset:6144
  v_add_f32 v198, 1.0, v198
  v_mfma_f32_16x16x32_bf16 v[132:135], v[160:163], a[4:7], 0
  buffer_load_dwordx4 v7, s[4:7], s35 offen offset:2048 lds
  v_add_f32 v199, 1.0, v199
  v_mfma_f32_16x16x32_bf16 v[132:135], v[164:167], a[20:23], v[132:135]
  ds_read_b64_tr_b16 v[188:189], v14 offset:1024
  v_mul_f32 v96, v96, v196
  v_mfma_f32_16x16x32_bf16 v[132:135], v[168:171], a[36:39], v[132:135]
  v_rcp_f32 v197, v197
  v_mul_f32 v201, v101, v101
  v_mfma_f32_16x16x32_bf16 v[136:139], v[160:163], a[8:11], 0
  ds_read_b64_tr_b16 v[190:191], v14 offset:7168
  v_mul_f32 v202, v102, v102
  v_mfma_f32_16x16x32_bf16 v[136:139], v[164:167], a[24:27], v[136:139]
  v_rcp_f32 v198, v198
  v_mfma_f32_16x16x32_bf16 v[136:139], v[168:171], a[40:43], v[136:139]
  ds_read_b64_tr_b16 v[192:193], v14 offset:2048
  v_mul_f32 v97, v97, v197
  v_mfma_f32_16x16x32_bf16 v[140:143], v[160:163], a[12:15], 0
  s_add_u32 s35, s33, 1769472
  v_rcp_f32 v199, v199
  v_mfma_f32_16x16x32_bf16 v[140:143], v[164:167], a[28:31], v[140:143]
  s_add_u32 m0, s31, 49152
  ds_read_b64_tr_b16 v[194:195], v14 offset:8192
  v_mul_f32 v98, v98, v198
  v_mfma_f32_16x16x32_bf16 v[140:143], v[168:171], a[44:47], v[140:143]
  s_waitcnt lgkmcnt(6)
  buffer_load_dwordx4 v5, s[4:7], s35 offen offset:0 lds
  v_mul_f32 v99, v99, v199
  v_mul_f32 v203, v103, v103
  v_mfma_f32_16x16x32_bf16 v[144:147], v[172:175], a[0:3], 0
  ds_read_b64_tr_b16 v[160:161], v15 offset:0
  v_fma_f32 v200, v200, v29, v25
  v_mfma_f32_16x16x32_bf16 v[144:147], v[176:179], a[16:19], v[144:147]
  v_fma_f32 v201, v201, v29, v25
  v_fma_f32 v202, v202, v29, v25
  v_mfma_f32_16x16x32_bf16 v[144:147], v[180:183], a[32:35], v[144:147]
  ds_read_b64_tr_b16 v[162:163], v15 offset:6144
  v_fma_f32 v203, v203, v29, v25
  v_mfma_f32_16x16x32_bf16 v[148:151], v[172:175], a[4:7], 0
  v_mul_f32 v200, v200, v100
  v_mul_f32 v201, v201, v101
  v_mfma_f32_16x16x32_bf16 v[148:151], v[176:179], a[20:23], v[148:151]
  ds_read_b64_tr_b16 v[164:165], v15 offset:1024
  v_exp_f32 v200, v200
  v_mfma_f32_16x16x32_bf16 v[148:151], v[180:183], a[36:39], v[148:151]
  v_exp_f32 v201, v201
  v_mfma_f32_16x16x32_bf16 v[152:155], v[172:175], a[8:11], 0
  ds_read_b64_tr_b16 v[166:167], v15 offset:7168
  v_mul_f32 v202, v202, v102
  v_mfma_f32_16x16x32_bf16 v[152:155], v[176:179], a[24:27], v[152:155]
  buffer_load_dwordx4 v6, s[4:7], s35 offen offset:1024 lds
  v_mul_f32 v203, v203, v103
  v_mfma_f32_16x16x32_bf16 v[152:155], v[180:183], a[40:43], v[152:155]
  ds_read_b64_tr_b16 v[168:169], v15 offset:2048
  v_add_f32 v200, 1.0, v200
  v_mfma_f32_16x16x32_bf16 v[156:159], v[172:175], a[12:15], 0
  v_exp_f32 v202, v202
  v_mfma_f32_16x16x32_bf16 v[156:159], v[176:179], a[28:31], v[156:159]
  s_waitcnt lgkmcnt(5)
  ds_read_b64_tr_b16 v[170:171], v15 offset:8192
  v_exp_f32 v203, v203
  v_mfma_f32_16x16x32_bf16 v[156:159], v[180:183], a[44:47], v[156:159]
  v_rcp_f32 v200, v200
  v_mfma_f32_16x16x32_bf16 v[128:131], v[184:187], a[48:51], v[128:131]
  ds_read_b64_tr_b16 v[172:173], v14 offset:12288
  v_add_f32 v201, 1.0, v201
  v_mfma_f32_16x16x32_bf16 v[128:131], v[188:191], a[64:67], v[128:131]
  v_rcp_f32 v201, v201
  v_mfma_f32_16x16x32_bf16 v[128:131], v[192:195], a[80:83], v[128:131]
  ds_read_b64_tr_b16 v[174:175], v14 offset:18432
  v_add_f32 v202, 1.0, v202
  v_mfma_f32_16x16x32_bf16 v[132:135], v[184:187], a[52:55], v[132:135]
  buffer_load_dwordx4 v7, s[4:7], s35 offen offset:2048 lds
  v_rcp_f32 v202, v202
  v_mfma_f32_16x16x32_bf16 v[132:135], v[188:191], a[68:71], v[132:135]
  ds_read_b64_tr_b16 v[176:177], v14 offset:13312
  v_add_f32 v203, 1.0, v203
  v_mfma_f32_16x16x32_bf16 v[132:135], v[192:195], a[84:87], v[132:135]
  v_rcp_f32 v203, v203
  v_mfma_f32_16x16x32_bf16 v[136:139], v[184:187], a[56:59], v[136:139]
  ds_read_b64_tr_b16 v[178:179], v14 offset:19456
  v_mul_f32 v100, v100, v200
  v_mfma_f32_16x16x32_bf16 v[136:139], v[188:191], a[72:75], v[136:139]
  v_mul_f32 v101, v101, v201
  v_mul_f32 v102, v102, v202
  v_mfma_f32_16x16x32_bf16 v[136:139], v[192:195], a[88:91], v[136:139]
  ds_read_b64_tr_b16 v[180:181], v14 offset:14336
  v_mul_f32 v103, v103, v203
  v_mfma_f32_16x16x32_bf16 v[140:143], v[184:187], a[60:63], v[140:143]
  v_mul_f32 v196, v104, v104
  v_mul_f32 v197, v105, v105
  v_mul_f32 v198, v106, v106
  v_mfma_f32_16x16x32_bf16 v[140:143], v[188:191], a[76:79], v[140:143]
  ds_read_b64_tr_b16 v[182:183], v14 offset:20480
  v_mul_f32 v199, v107, v107
  v_mfma_f32_16x16x32_bf16 v[140:143], v[192:195], a[92:95], v[140:143]
  s_waitcnt lgkmcnt(6)
  v_fma_f32 v196, v196, v30, v26
  v_fma_f32 v197, v197, v30, v26
  v_mfma_f32_16x16x32_bf16 v[144:147], v[160:163], a[48:51], v[144:147]
  ds_read_b64_tr_b16 v[184:185], v15 offset:12288
  v_fma_f32 v198, v198, v30, v26
  v_mfma_f32_16x16x32_bf16 v[144:147], v[164:167], a[64:67], v[144:147]
  v_fma_f32 v199, v199, v30, v26
  v_mul_f32 v196, v196, v104
  v_mfma_f32_16x16x32_bf16 v[144:147], v[168:171], a[80:83], v[144:147]
  ds_read_b64_tr_b16 v[186:187], v15 offset:18432
  v_mul_f32 v197, v197, v105
  v_mfma_f32_16x16x32_bf16 v[148:151], v[160:163], a[52:55], v[148:151]
  v_exp_f32 v196, v196
  v_mul_f32 v198, v198, v106
  v_mfma_f32_16x16x32_bf16 v[148:151], v[164:167], a[68:71], v[148:151]
  ds_read_b64_tr_b16 v[188:189], v15 offset:13312
  v_mul_f32 v199, v199, v107
  v_mfma_f32_16x16x32_bf16 v[148:151], v[168:171], a[84:87], v[148:151]
  v_exp_f32 v197, v197
  v_mfma_f32_16x16x32_bf16 v[152:155], v[160:163], a[56:59], v[152:155]
  ds_read_b64_tr_b16 v[190:191], v15 offset:19456
  v_add_f32 v196, 1.0, v196
  v_mfma_f32_16x16x32_bf16 v[152:155], v[164:167], a[72:75], v[152:155]
  v_exp_f32 v198, v198
  v_mfma_f32_16x16x32_bf16 v[152:155], v[168:171], a[88:91], v[152:155]
  ds_read_b64_tr_b16 v[192:193], v15 offset:14336
  v_exp_f32 v199, v199
  v_mfma_f32_16x16x32_bf16 v[156:159], v[160:163], a[60:63], v[156:159]
  v_rcp_f32 v196, v196
  v_mfma_f32_16x16x32_bf16 v[156:159], v[164:167], a[76:79], v[156:159]
  s_waitcnt lgkmcnt(5) vmcnt(9)
  ds_read_b64_tr_b16 v[194:195], v15 offset:20480
  v_add_f32 v197, 1.0, v197
  v_mfma_f32_16x16x32_bf16 v[156:159], v[168:171], a[92:95], v[156:159]
  s_barrier
  v_mfma_f32_16x16x32_bf16 v[128:131], v[172:175], a[96:99], v[128:131]
  s_add_u32 s3, s42, 16384
  buffer_store_dwordx4 v[204:207], v21, s[16:19], s3 offen offset:0 sc1
  ds_read_b64_tr_b16 v[160:161], v12 offset:0
  v_mfma_f32_16x16x32_bf16 v[128:131], v[176:179], a[112:115], v[128:131]
  s_add_u32 s35, s33, 3538944
  v_rcp_f32 v197, v197
  v_mfma_f32_16x16x32_bf16 v[128:131], v[180:183], a[128:131], v[128:131]
  s_add_u32 m0, s31, 61440
  ds_read_b64_tr_b16 v[162:163], v12 offset:6144
  v_add_f32 v198, 1.0, v198
  v_add_f32 v199, 1.0, v199
  v_mfma_f32_16x16x32_bf16 v[132:135], v[172:175], a[100:103], v[132:135]
  buffer_load_dwordx4 v5, s[4:7], s35 offen offset:0 lds
  v_mul_f32 v104, v104, v196
  v_mfma_f32_16x16x32_bf16 v[132:135], v[176:179], a[116:119], v[132:135]
  ds_read_b64_tr_b16 v[164:165], v12 offset:1024
  v_mul_f32 v105, v105, v197
  v_mfma_f32_16x16x32_bf16 v[132:135], v[180:183], a[132:135], v[132:135]
  v_rcp_f32 v198, v198
  v_mfma_f32_16x16x32_bf16 v[136:139], v[172:175], a[104:107], v[136:139]
  ds_read_b64_tr_b16 v[166:167], v12 offset:7168
  v_mul_f32 v200, v108, v108
  v_mfma_f32_16x16x32_bf16 v[136:139], v[176:179], a[120:123], v[136:139]
  v_rcp_f32 v199, v199
  v_mfma_f32_16x16x32_bf16 v[136:139], v[180:183], a[136:139], v[136:139]
  ds_read_b64_tr_b16 v[168:169], v12 offset:2048
  v_mul_f32 v106, v106, v198
  v_mul_f32 v201, v109, v109
  v_mfma_f32_16x16x32_bf16 v[140:143], v[172:175], a[108:111], v[140:143]
  s_waitcnt vmcnt(24)
  buffer_atomic_inc v23, v223, s[16:19], s46 offen offset:0
  v_mfma_f32_16x16x32_bf16 v[140:143], v[176:179], a[124:127], v[140:143]
  ds_read_b64_tr_b16 v[170:171], v12 offset:8192
  v_mul_f32 v107, v107, v199
  v_mfma_f32_16x16x32_bf16 v[140:143], v[180:183], a[140:143], v[140:143]
  s_waitcnt lgkmcnt(6)
  buffer_load_dwordx4 v6, s[4:7], s35 offen offset:1024 lds
  v_mul_f32 v202, v110, v110
  v_mfma_f32_16x16x32_bf16 v[144:147], v[184:187], a[96:99], v[144:147]
  ds_read_b64_tr_b16 v[172:173], v13 offset:0
  v_mul_f32 v203, v111, v111
  v_mfma_f32_16x16x32_bf16 v[144:147], v[188:191], a[112:115], v[144:147]
  v_fma_f32 v200, v200, v31, v27
  v_fma_f32 v201, v201, v31, v27
  v_fma_f32 v202, v202, v31, v27
  v_mfma_f32_16x16x32_bf16 v[144:147], v[192:195], a[128:131], v[144:147]
  ds_read_b64_tr_b16 v[174:175], v13 offset:6144
  v_fma_f32 v203, v203, v31, v27
  v_mfma_f32_16x16x32_bf16 v[148:151], v[184:187], a[100:103], v[148:151]
L_st_e000:
  s_cbranch_execz L_st_f000
  v_mul_f32 v200, v200, v108
  v_mul_f32 v201, v201, v109
  v_mfma_f32_16x16x32_bf16 v[148:151], v[188:191], a[116:119], v[148:151]
  ds_read_b64_tr_b16 v[176:177], v13 offset:1024
  v_mul_f32 v202, v202, v110
  v_mfma_f32_16x16x32_bf16 v[148:151], v[192:195], a[132:135], v[148:151]
  buffer_store_dwordx4 v[208:211], v21, s[16:19], s3 offen offset:1024 sc1
  v_mfma_f32_16x16x32_bf16 v[152:155], v[184:187], a[104:107], v[152:155]
  ds_read_b64_tr_b16 v[178:179], v13 offset:7168
  v_mul_f32 v203, v203, v111
  v_mfma_f32_16x16x32_bf16 v[152:155], v[188:191], a[120:123], v[152:155]
  buffer_load_dwordx4 v7, s[4:7], s35 offen offset:2048 lds
  v_exp_f32 v200, v200
  v_mfma_f32_16x16x32_bf16 v[152:155], v[192:195], a[136:139], v[152:155]
  ds_read_b64_tr_b16 v[180:181], v13 offset:2048
  v_mul_f32 v196, v112, v112
  v_mfma_f32_16x16x32_bf16 v[156:159], v[184:187], a[108:111], v[156:159]
  v_exp_f32 v201, v201
  v_mfma_f32_16x16x32_bf16 v[156:159], v[188:191], a[124:127], v[156:159]
  s_waitcnt lgkmcnt(5)
  ds_read_b64_tr_b16 v[182:183], v13 offset:8192
  v_add_f32 v200, 1.0, v200
  v_mfma_f32_16x16x32_bf16 v[156:159], v[192:195], a[140:143], v[156:159]
  v_exp_f32 v202, v202
  v_mfma_f32_16x16x32_bf16 v[128:131], v[160:163], a[144:147], v[128:131]
  ds_read_b64_tr_b16 v[184:185], v12 offset:12288
  v_exp_f32 v203, v203
  v_mfma_f32_16x16x32_bf16 v[128:131], v[164:167], a[160:163], v[128:131]
  v_rcp_f32 v200, v200
  v_mfma_f32_16x16x32_bf16 v[128:131], v[168:171], a[176:179], v[128:131]
  ds_read_b64_tr_b16 v[186:187], v12 offset:18432
  v_add_f32 v201, 1.0, v201
  v_mfma_f32_16x16x32_bf16 v[132:135], v[160:163], a[148:151], v[132:135]
  v_rcp_f32 v201, v201
  v_mfma_f32_16x16x32_bf16 v[132:135], v[164:167], a[164:167], v[132:135]
  ds_read_b64_tr_b16 v[188:189], v12 offset:13312
  v_add_f32 v202, 1.0, v202
  v_mfma_f32_16x16x32_bf16 v[132:135], v[168:171], a[180:183], v[132:135]
  v_rcp_f32 v202, v202
  v_mfma_f32_16x16x32_bf16 v[136:139], v[160:163], a[152:155], v[136:139]
  ds_read_b64_tr_b16 v[190:191], v12 offset:19456
  v_add_f32 v203, 1.0, v203
  v_mul_f32 v108, v108, v200
  v_mfma_f32_16x16x32_bf16 v[136:139], v[164:167], a[168:171], v[136:139]
  v_rcp_f32 v203, v203
  v_mfma_f32_16x16x32_bf16 v[136:139], v[168:171], a[184:187], v[136:139]
  ds_read_b64_tr_b16 v[192:193], v12 offset:14336
  v_mul_f32 v109, v109, v201
  v_mfma_f32_16x16x32_bf16 v[140:143], v[160:163], a[156:159], v[140:143]
  buffer_store_dwordx4 v[212:215], v21, s[16:19], s3 offen offset:2048 sc1
  v_mfma_f32_16x16x32_bf16 v[140:143], v[164:167], a[172:175], v[140:143]
  ds_read_b64_tr_b16 v[194:195], v12 offset:20480
  v_mul_f32 v110, v110, v202
  v_mfma_f32_16x16x32_bf16 v[140:143], v[168:171], a[188:191], v[140:143]
  s_waitcnt lgkmcnt(6)
  v_mul_f32 v111, v111, v203
  v_mul_f32 v197, v113, v113
  v_mul_f32 v198, v114, v114
  v_mfma_f32_16x16x32_bf16 v[144:147], v[172:175], a[144:147], v[144:147]
  ds_read_b64_tr_b16 v[160:161], v13 offset:12288
  v_mul_f32 v199, v115, v115
  v_mfma_f32_16x16x32_bf16 v[144:147], v[176:179], a[160:163], v[144:147]
  v_fma_f32 v196, v196, v28, v24
  v_fma_f32 v197, v197, v28, v24
  v_mfma_f32_16x16x32_bf16 v[144:147], v[180:183], a[176:179], v[144:147]
  ds_read_b64_tr_b16 v[162:163], v13 offset:18432
  v_fma_f32 v198, v198, v28, v24
  v_mfma_f32_16x16x32_bf16 v[148:151], v[172:175], a[148:151], v[148:151]
  v_fma_f32 v199, v199, v28, v24
  v_mul_f32 v196, v196, v112
  v_mfma_f32_16x16x32_bf16 v[148:151], v[176:179], a[164:167], v[148:151]
  ds_read_b64_tr_b16 v[164:165], v13 offset:13312
  v_mul_f32 v197, v197, v113
  v_mfma_f32_16x16x32_bf16 v[148:151], v[180:183], a[180:183], v[148:151]
  v_exp_f32 v196, v196
  v_mul_f32 v198, v198, v114
  v_mfma_f32_16x16x32_bf16 v[152:155], v[172:175], a[152:155], v[152:155]
  ds_read_b64_tr_b16 v[166:167], v13 offset:19456
  v_mul_f32 v199, v199, v115
  v_mfma_f32_16x16x32_bf16 v[152:155], v[176:179], a[168:171], v[152:155]
  v_exp_f32 v197, v197
  v_mfma_f32_16x16x32_bf16 v[152:155], v[180:183], a[184:187], v[152:155]
  ds_read_b64_tr_b16 v[168:169], v13 offset:14336
  v_add_f32 v196, 1.0, v196
  v_mfma_f32_16x16x32_bf16 v[156:159], v[172:175], a[156:159], v[156:159]
  v_exp_f32 v198, v198
  v_mfma_f32_16x16x32_bf16 v[156:159], v[176:179], a[172:175], v[156:159]
  s_waitcnt lgkmcnt(5) vmcnt(10)
  ds_read_b64_tr_b16 v[170:171], v13 offset:20480
  v_exp_f32 v199, v199
  v_mfma_f32_16x16x32_bf16 v[156:159], v[180:183], a[188:191], v[156:159]
  s_barrier
  v_mfma_f32_16x16x32_bf16 v[128:131], v[184:187], a[192:195], v[128:131]
  ds_read_b64_tr_b16 v[172:173], v12 offset:24576
  v_add_f32 v197, 1.0, v197
  v_mfma_f32_16x16x32_bf16 v[128:131], v[188:191], a[208:211], v[128:131]
  s_add_u32 s35, s33, 0
  buffer_store_dwordx4 v[216:219], v21, s[16:19], s3 offen offset:3072 sc1
  v_mfma_f32_16x16x32_bf16 v[128:131], v[192:195], a[224:227], v[128:131]
  s_add_u32 m0, s31, 0
  ds_read_b64_tr_b16 v[174:175], v12 offset:30720
  v_add_f32 v198, 1.0, v198
  v_mfma_f32_16x16x32_bf16 v[132:135], v[184:187], a[196:199], v[132:135]
  buffer_load_dwordx4 v5, s[8:11], s35 offen offset:0 lds
  v_add_f32 v199, 1.0, v199
  v_mfma_f32_16x16x32_bf16 v[132:135], v[188:191], a[212:215], v[132:135]
  ds_read_b64_tr_b16 v[176:177], v12 offset:25600
  v_rcp_f32 v196, v196
  v_mfma_f32_16x16x32_bf16 v[132:135], v[192:195], a[228:231], v[132:135]
  v_rcp_f32 v197, v197
  v_mfma_f32_16x16x32_bf16 v[136:139], v[184:187], a[200:203], v[136:139]
  ds_read_b64_tr_b16 v[178:179], v12 offset:31744
  v_mul_f32 v112, v112, v196
  v_mfma_f32_16x16x32_bf16 v[136:139], v[188:191], a[216:219], v[136:139]
  v_rcp_f32 v198, v198
  v_mfma_f32_16x16x32_bf16 v[136:139], v[192:195], a[232:235], v[136:139]
  ds_read_b64_tr_b16 v[180:181], v12 offset:26624
  v_mul_f32 v113, v113, v197
  v_mfma_f32_16x16x32_bf16 v[140:143], v[184:187], a[204:207], v[140:143]
  v_rcp_f32 v199, v199
  v_mul_f32 v114, v114, v198
  v_mfma_f32_16x16x32_bf16 v[140:143], v[188:191], a[220:223], v[140:143]
  ds_read_b64_tr_b16 v[182:183], v12 offset:32768
  v_mul_f32 v200, v116, v116
  v_mfma_f32_16x16x32_bf16 v[140:143], v[192:195], a[236:239], v[140:143]
  s_waitcnt lgkmcnt(6)
  buffer_load_dwordx4 v6, s[8:11], s35 offen offset:1024 lds
  v_mul_f32 v115, v115, v199
  v_mfma_f32_16x16x32_bf16 v[144:147], v[160:163], a[192:195], v[144:147]
  ds_read_b64_tr_b16 v[184:185], v13 offset:24576
  v_mul_f32 v201, v117, v117
  v_mfma_f32_16x16x32_bf16 v[144:147], v[164:167], a[208:211], v[144:147]
  v_mul_f32 v202, v118, v118
  v_mul_f32 v203, v119, v119
  v_mfma_f32_16x16x32_bf16 v[144:147], v[168:171], a[224:227], v[144:147]
  ds_read_b64_tr_b16 v[186:187], v13 offset:30720
  v_fma_f32 v200, v200, v29, v25
  v_fma_f32 v201, v201, v29, v25
  v_mfma_f32_16x16x32_bf16 v[148:151], v[160:163], a[196:199], v[148:151]
  v_fma_f32 v202, v202, v29, v25
  v_fma_f32 v203, v203, v29, v25
  v_mfma_f32_16x16x32_bf16 v[148:151], v[164:167], a[212:215], v[148:151]
  ds_read_b64_tr_b16 v[188:189], v13 offset:25600
  v_mul_f32 v200, v200, v116
  v_mfma_f32_16x16x32_bf16 v[148:151], v[168:171], a[228:231], v[148:151]
  v_exp_f32 v200, v200
  v_mfma_f32_16x16x32_bf16 v[152:155], v[160:163], a[200:203], v[152:155]
  ds_read_b64_tr_b16 v[190:191], v13 offset:31744
  v_mul_f32 v201, v201, v117
  v_mfma_f32_16x16x32_bf16 v[152:155], v[164:167], a[216:219], v[152:155]
  buffer_load_dwordx4 v7, s[8:11], s35 offen offset:2048 lds
  v_mul_f32 v202, v202, v118
  v_mfma_f32_16x16x32_bf16 v[152:155], v[168:171], a[232:235], v[152:155]
  ds_read_b64_tr_b16 v[192:193], v13 offset:26624
  v_exp_f32 v201, v201
  v_mfma_f32_16x16x32_bf16 v[156:159], v[160:163], a[204:207], v[156:159]
  v_exp_f32 v202, v202
  v_mfma_f32_16x16x32_bf16 v[156:159], v[164:167], a[220:223], v[156:159]
  s_waitcnt lgkmcnt(5)
  ds_read_b64_tr_b16 v[194:195], v13 offset:32768
  v_mul_f32 v203, v203, v119
  v_mfma_f32_16x16x32_bf16 v[156:159], v[168:171], a[236:239], v[156:159]
  v_exp_f32 v203, v203
  v_mfma_f32_16x16x32_bf16 v[128:131], v[172:175], a[240:243], v[128:131]
  ds_read_b64_tr_b16 v[160:161], v16 offset:36864
  v_add_f32 v200, 1.0, v200
  v_mfma_f32_16x16x32_bf16 v[128:131], v[176:179], v[224:227], v[128:131]
  s_add_u32 s35, s33, 1769472
  v_rcp_f32 v200, v200
  v_add_f32 v201, 1.0, v201
  v_mfma_f32_16x16x32_bf16 v[128:131], v[180:183], v[240:243], v[128:131]
  s_add_u32 m0, s31, 73728
  ds_read_b64_tr_b16 v[162:163], v16 offset:43008
  v_add_f32 v202, 1.0, v202
  v_mfma_f32_16x16x32_bf16 v[132:135], v[172:175], a[244:247], v[132:135]
  buffer_load_dwordx4 v5, s[8:11], s35 offen offset:0 lds
  v_add_f32 v203, 1.0, v203
  v_mfma_f32_16x16x32_bf16 v[132:135], v[176:179], v[228:231], v[132:135]
  ds_read_b64_tr_b16 v[164:165], v16 offset:37888
  v_mul_f32 v116, v116, v200
  v_mfma_f32_16x16x32_bf16 v[132:135], v[180:183], v[244:247], v[132:135]
  v_rcp_f32 v201, v201
  v_mfma_f32_16x16x32_bf16 v[136:139], v[172:175], a[248:251], v[136:139]
  ds_read_b64_tr_b16 v[166:167], v16 offset:44032
  v_rcp_f32 v202, v202
  v_mfma_f32_16x16x32_bf16 v[136:139], v[176:179], v[232:235], v[136:139]
  v_rcp_f32 v203, v203
  v_mfma_f32_16x16x32_bf16 v[136:139], v[180:183], v[248:251], v[136:139]
  ds_read_b64_tr_b16 v[168:169], v16 offset:38912
  v_mul_f32 v117, v117, v201
  v_mfma_f32_16x16x32_bf16 v[140:143], v[172:175], a[252:255], v[140:143]
  v_mul_f32 v118, v118, v202
  v_mul_f32 v119, v119, v203
  v_mfma_f32_16x16x32_bf16 v[140:143], v[176:179], v[236:239], v[140:143]
  ds_read_b64_tr_b16 v[170:171], v16 offset:45056
  v_mul_f32 v196, v120, v120
  v_mfma_f32_16x16x32_bf16 v[140:143], v[180:183], v[252:255], v[140:143]
  s_waitcnt lgkmcnt(6)
  buffer_load_dwordx4 v6, s[8:11], s35 offen offset:1024 lds
  v_mul_f32 v197, v121, v121
  v_mfma_f32_16x16x32_bf16 v[144:147], v[184:187], a[240:243], v[144:147]
  ds_read_b64_tr_b16 v[172:173], v17 offset:36864
  v_mul_f32 v198, v122, v122
  v_mul_f32 v199, v123, v123
  v_mfma_f32_16x16x32_bf16 v[144:147], v[188:191], v[224:227], v[144:147]
  v_fma_f32 v196, v196, v30, v26
  v_fma_f32 v197, v197, v30, v26
  v_mfma_f32_16x16x32_bf16 v[144:147], v[192:195], v[240:243], v[144:147]
  ds_read_b64_tr_b16 v[174:175], v17 offset:43008
  v_fma_f32 v198, v198, v30, v26
  v_mfma_f32_16x16x32_bf16 v[148:151], v[184:187], a[244:247], v[148:151]
  v_fma_f32 v199, v199, v30, v26
  v_mul_f32 v196, v196, v120
  v_mfma_f32_16x16x32_bf16 v[148:151], v[188:191], v[228:231], v[148:151]
  ds_read_b64_tr_b16 v[176:177], v17 offset:37888
  v_mul_f32 v197, v197, v121
  v_mfma_f32_16x16x32_bf16 v[148:151], v[192:195], v[244:247], v[148:151]
  v_exp_f32 v196, v196
  v_mul_f32 v198, v198, v122
  v_mfma_f32_16x16x32_bf16 v[152:155], v[184:187], a[248:251], v[152:155]
  ds_read_b64_tr_b16 v[178:179], v17 offset:44032
  v_mul_f32 v199, v199, v123
  v_mfma_f32_16x16x32_bf16 v[152:155], v[188:191], v[232:235], v[152:155]
  buffer_load_dwordx4 v7, s[8:11], s35 offen offset:2048 lds
  v_add_f32 v196, 1.0, v196
  v_mfma_f32_16x16x32_bf16 v[152:155], v[192:195], v[248:251], v[152:155]
  ds_read_b64_tr_b16 v[180:181], v17 offset:38912
  v_mul_f32 v200, v124, v124
  v_mfma_f32_16x16x32_bf16 v[156:159], v[184:187], a[252:255], v[156:159]
  v_exp_f32 v197, v197
  v_mfma_f32_16x16x32_bf16 v[156:159], v[188:191], v[236:239], v[156:159]
  s_waitcnt lgkmcnt(5) vmcnt(8)
  ds_read_b64_tr_b16 v[182:183], v17 offset:45056
  v_mul_f32 v201, v125, v125
  v_mfma_f32_16x16x32_bf16 v[156:159], v[192:195], v[252:255], v[156:159]
  s_barrier
  v_mfma_f32_16x16x32_bf16 v[32:35], v[160:163], a[0:3], 0
  ds_read_b64_tr_b16 v[184:185], v16 offset:49152
  v_exp_f32 v198, v198
  v_mfma_f32_16x16x32_bf16 v[32:35], v[164:167], a[32:35], v[32:35]
  s_add_u32 s35, s33, 3538944
  v_exp_f32 v199, v199
  v_mfma_f32_16x16x32_bf16 v[32:35], v[168:171], a[64:67], v[32:35]
  s_add_u32 m0, s31, 12288
  ds_read_b64_tr_b16 v[186:187], v16 offset:55296
  v_add_f32 v197, 1.0, v197
  v_mfma_f32_16x16x32_bf16 v[36:39], v[160:163], a[4:7], 0
  buffer_load_dwordx4 v5, s[8:11], s35 offen offset:0 lds
  v_add_f32 v198, 1.0, v198
  v_mfma_f32_16x16x32_bf16 v[36:39], v[164:167], a[36:39], v[36:39]
  ds_read_b64_tr_b16 v[188:189], v16 offset:50176
  v_rcp_f32 v196, v196
  v_mfma_f32_16x16x32_bf16 v[36:39], v[168:171], a[68:71], v[36:39]
  v_rcp_f32 v197, v197
  v_mfma_f32_16x16x32_bf16 v[40:43], v[160:163], a[8:11], 0
  ds_read_b64_tr_b16 v[190:191], v16 offset:56320
  v_add_f32 v199, 1.0, v199
  v_mfma_f32_16x16x32_bf16 v[40:43], v[164:167], a[40:43], v[40:43]
  v_rcp_f32 v198, v198
  v_mfma_f32_16x16x32_bf16 v[40:43], v[168:171], a[72:75], v[40:43]
  ds_read_b64_tr_b16 v[192:193], v16 offset:51200
  v_mul_f32 v120, v120, v196
  v_mfma_f32_16x16x32_bf16 v[44:47], v[160:163], a[12:15], 0
  v_rcp_f32 v199, v199
  v_mfma_f32_16x16x32_bf16 v[44:47], v[164:167], a[44:47], v[44:47]
  ds_read_b64_tr_b16 v[194:195], v16 offset:57344
  v_mul_f32 v121, v121, v197
  v_mul_f32 v122, v122, v198
  v_mfma_f32_16x16x32_bf16 v[44:47], v[168:171], a[76:79], v[44:47]
  s_waitcnt lgkmcnt(6)
  buffer_load_dwordx4 v6, s[8:11], s35 offen offset:1024 lds
  v_mul_f32 v123, v123, v199
  v_mfma_f32_16x16x32_bf16 v[32:35], v[172:175], a[16:19], v[32:35]
  ds_read_b64_tr_b16 v[160:161], v17 offset:49152
  v_mul_f32 v202, v126, v126
  v_mfma_f32_16x16x32_bf16 v[32:35], v[176:179], a[48:51], v[32:35]
  v_mul_f32 v203, v127, v127
  v_fma_f32 v200, v200, v31, v27
  v_mfma_f32_16x16x32_bf16 v[32:35], v[180:183], a[80:83], v[32:35]
  ds_read_b64_tr_b16 v[162:163], v17 offset:55296
  v_fma_f32 v201, v201, v31, v27
  v_mfma_f32_16x16x32_bf16 v[36:39], v[172:175], a[20:23], v[36:39]
  v_fma_f32 v202, v202, v31, v27
  v_fma_f32 v203, v203, v31, v27
  v_mfma_f32_16x16x32_bf16 v[36:39], v[176:179], a[52:55], v[36:39]
  ds_read_b64_tr_b16 v[164:165], v17 offset:50176
  v_mul_f32 v200, v200, v124
  v_mul_f32 v201, v201, v125
  v_mfma_f32_16x16x32_bf16 v[36:39], v[180:183], a[84:87], v[36:39]
  v_exp_f32 v200, v200
  v_mfma_f32_16x16x32_bf16 v[40:43], v[172:175], a[24:27], v[40:43]
  ds_read_b64_tr_b16 v[166:167], v17 offset:56320
  v_mul_f32 v202, v202, v126
  v_mfma_f32_16x16x32_bf16 v[40:43], v[176:179], a[56:59], v[40:43]
  buffer_load_dwordx4 v7, s[8:11], s35 offen offset:2048 lds
  v_mul_f32 v203, v203, v127
  v_mfma_f32_16x16x32_bf16 v[40:43], v[180:183], a[88:91], v[40:43]
  ds_read_b64_tr_b16 v[168:169], v17 offset:51200
  v_add_f32 v200, 1.0, v200
  v_mfma_f32_16x16x32_bf16 v[44:47], v[172:175], a[28:31], v[44:47]
  v_exp_f32 v201, v201
  v_mul_f32 v128, v128, v96
  v_mfma_f32_16x16x32_bf16 v[44:47], v[176:179], a[60:63], v[44:47]
  s_waitcnt lgkmcnt(5)
  ds_read_b64_tr_b16 v[170:171], v17 offset:57344
  v_mul_f32 v129, v129, v97
  v_mfma_f32_16x16x32_bf16 v[44:47], v[180:183], a[92:95], v[44:47]
  v_exp_f32 v202, v202
  v_mfma_f32_16x16x32_bf16 v[32:35], v[184:187], a[96:99], v[32:35]
  ds_read_b64_tr_b16 v[172:173], v18 offset:0
  v_lshlrev_b32 v3, 3, v1
  v_mfma_f32_16x16x32_bf16 v[32:35], v[188:191], a[128:131], v[32:35]
  s_add_u32 s35, s34, 0
  v_exp_f32 v203, v203
  v_mfma_f32_16x16x32_bf16 v[32:35], v[192:195], a[160:163], v[32:35]
  s_add_u32 m0, s31, 24576
  ds_read_b64_tr_b16 v[174:175], v18 offset:6144
  v_sub_u32 v3, v23, v3
  v_mfma_f32_16x16x32_bf16 v[36:39], v[184:187], a[100:103], v[36:39]
  buffer_load_dwordx4 v8, s[12:15], s35 offen offset:0 lds
  v_rcp_f32 v200, v200
  v_mfma_f32_16x16x32_bf16 v[36:39], v[188:191], a[132:135], v[36:39]
  ds_read_b64_tr_b16 v[176:177], v18 offset:1024
  v_add_u32 v11, s56, v8
  v_mfma_f32_16x16x32_bf16 v[36:39], v[192:195], a[164:167], v[36:39]
  v_add_f32 v201, 1.0, v201
  v_add_f32 v202, 1.0, v202
  v_mfma_f32_16x16x32_bf16 v[40:43], v[184:187], a[104:107], v[40:43]
  ds_read_b64_tr_b16 v[178:179], v18 offset:7168
  v_add_u32 v221, s57, v8
  v_mfma_f32_16x16x32_bf16 v[40:43], v[188:191], a[136:139], v[40:43]
  v_rcp_f32 v201, v201
  v_mfma_f32_16x16x32_bf16 v[40:43], v[192:195], a[168:171], v[40:43]
  ds_read_b64_tr_b16 v[180:181], v18 offset:2048
  v_add_f32 v203, 1.0, v203
  v_mfma_f32_16x16x32_bf16 v[44:47], v[184:187], a[108:111], v[44:47]
  v_rcp_f32 v202, v202
  v_mul_f32 v124, v124, v200
  v_mfma_f32_16x16x32_bf16 v[44:47], v[188:191], a[140:143], v[44:47]
  ds_read_b64_tr_b16 v[182:183], v18 offset:8192
  v_mul_f32 v125, v125, v201
  v_mfma_f32_16x16x32_bf16 v[44:47], v[192:195], a[172:175], v[44:47]
  s_waitcnt lgkmcnt(6)
  buffer_load_dwordx4 v9, s[12:15], s35 offen offset:1024 lds
  v_mul_f32 v126, v126, v202
  v_mfma_f32_16x16x32_bf16 v[32:35], v[160:163], a[112:115], v[32:35]
  ds_read_b64_tr_b16 v[184:185], v19 offset:0
  v_mul_f32 v130, v130, v98
  v_mfma_f32_16x16x32_bf16 v[32:35], v[164:167], a[144:147], v[32:35]
  v_rcp_f32 v203, v203
  v_mfma_f32_16x16x32_bf16 v[32:35], v[168:171], a[176:179], v[32:35]
  s_buffer_load_dword s39, s[16:19], s45 offset:0 glc
  ds_read_b64_tr_b16 v[186:187], v19 offset:6144
  v_mul_f32 v131, v131, v99
  v_mfma_f32_16x16x32_bf16 v[36:39], v[160:163], a[116:119], v[36:39]
  v_mul_f32 v127, v127, v203
  v_cvt_pk_bf16_f32 v204, v128, v129
  v_cvt_pk_bf16_f32 v205, v130, v131
  v_mfma_f32_16x16x32_bf16 v[36:39], v[164:167], a[148:151], v[36:39]
  ds_read_b64_tr_b16 v[188:189], v19 offset:1024
  v_mul_f32 v144, v144, v112
  v_mfma_f32_16x16x32_bf16 v[36:39], v[168:171], a[180:183], v[36:39]
  s_waitcnt vmcnt(11)
  buffer_atomic_inc v23, v223, s[16:19], s46 offen offset:128
  v_mfma_f32_16x16x32_bf16 v[40:43], v[160:163], a[120:123], v[40:43]
  ds_read_b64_tr_b16 v[190:191], v19 offset:7168
  v_mul_f32 v145, v145, v113
  v_mfma_f32_16x16x32_bf16 v[40:43], v[164:167], a[152:155], v[40:43]
  buffer_load_dwordx4 v10, s[12:15], s35 offen offset:2048 lds
  v_mul_f32 v146, v146, v114
  v_mfma_f32_16x16x32_bf16 v[40:43], v[168:171], a[184:187], v[40:43]
  ds_read_b64_tr_b16 v[192:193], v19 offset:2048
  v_mul_f32 v147, v147, v115
  v_cvt_pk_bf16_f32 v206, v144, v145
  v_mfma_f32_16x16x32_bf16 v[44:47], v[160:163], a[124:127], v[44:47]
  v_cvt_pk_bf16_f32 v207, v146, v147
  v_mul_f32 v132, v132, v100
  v_mfma_f32_16x16x32_bf16 v[44:47], v[164:167], a[156:159], v[44:47]
  s_waitcnt lgkmcnt(5) vmcnt(7)
  ds_read_b64_tr_b16 v[194:195], v19 offset:8192
  v_mul_f32 v133, v133, v101
  v_mfma_f32_16x16x32_bf16 v[44:47], v[168:171], a[188:191], v[44:47]
  s_barrier
  v_mfma_f32_16x16x32_bf16 v[32:35], v[172:175], a[192:195], v[32:35]
  s_add_u32 s3, s42, 24576
  buffer_store_dwordx4 v[204:207], v21, s[16:19], s3 offen offset:0 sc1
  ds_read_b64_tr_b16 v[160:161], v16 offset:0
  v_mfma_f32_16x16x32_bf16 v[32:35], v[176:179], a[224:227], v[32:35]
  s_add_u32 s35, s34, 110592
  ds_write_b128 v21, v[204:207] offset:24576
  v_mfma_f32_16x16x32_bf16 v[32:35], v[180:183], v[224:227], v[32:35]
  s_add_u32 m0, s31, 36864
  ds_read_b64_tr_b16 v[162:163], v16 offset:6144
  v_mul_f32 v134, v134, v102
  v_mul_f32 v135, v135, v103
  v_mfma_f32_16x16x32_bf16 v[36:39], v[172:175], a[196:199], v[36:39]
  buffer_load_dwordx4 v8, s[12:15], s35 offen offset:0 lds
  v_cvt_pk_bf16_f32 v208, v132, v133
  v_mfma_f32_16x16x32_bf16 v[36:39], v[176:179], a[228:231], v[36:39]
  ds_read_b64_tr_b16 v[164:165], v16 offset:1024
  v_cvt_pk_bf16_f32 v209, v134, v135
  v_mfma_f32_16x16x32_bf16 v[36:39], v[180:183], v[228:231], v[36:39]
  v_mul_f32 v148, v148, v116
  v_mul_f32 v149, v149, v117
  v_mfma_f32_16x16x32_bf16 v[40:43], v[172:175], a[200:203], v[40:43]
  ds_read_b64_tr_b16 v[166:167], v16 offset:7168
  v_mul_f32 v150, v150, v118
  v_mfma_f32_16x16x32_bf16 v[40:43], v[176:179], a[232:235], v[40:43]
  v_mul_f32 v151, v151, v119
  v_cvt_pk_bf16_f32 v210, v148, v149
  v_mfma_f32_16x16x32_bf16 v[40:43], v[180:183], v[232:235], v[40:43]
  ds_read_b64_tr_b16 v[168:169], v16 offset:2048
  v_cvt_pk_bf16_f32 v211, v150, v151
  v_mfma_f32_16x16x32_bf16 v[44:47], v[172:175], a[204:207], v[44:47]
  ds_write_b128 v21, v[208:211] offset:25600
  v_mul_f32 v136, v136, v104
  v_mfma_f32_16x16x32_bf16 v[44:47], v[176:179], a[236:239], v[44:47]
  ds_read_b64_tr_b16 v[170:171], v16 offset:8192
  v_mul_f32 v137, v137, v105
  v_mfma_f32_16x16x32_bf16 v[44:47], v[180:183], v[236:239], v[44:47]
  s_waitcnt lgkmcnt(8)
  buffer_load_dwordx4 v9, s[12:15], s35 offen offset:1024 lds
  v_mul_f32 v138, v138, v106
  v_mfma_f32_16x16x32_bf16 v[32:35], v[184:187], a[208:211], v[32:35]
  ds_read_b64_tr_b16 v[172:173], v17 offset:0
  v_mul_f32 v139, v139, v107
  v_mfma_f32_16x16x32_bf16 v[32:35], v[188:191], a[240:243], v[32:35]
  v_cvt_pk_bf16_f32 v212, v136, v137
  v_cvt_pk_bf16_f32 v213, v138, v139
  v_mfma_f32_16x16x32_bf16 v[32:35], v[192:195], v[240:243], v[32:35]
  ds_read_b64_tr_b16 v[174:175], v17 offset:6144
  v_mul_f32 v152, v152, v120
  v_mfma_f32_16x16x32_bf16 v[36:39], v[184:187], a[212:215], v[36:39]
  v_mul_f32 v153, v153, v121
  v_mul_f32 v154, v154, v122
  v_mul_f32 v155, v155, v123
  v_mfma_f32_16x16x32_bf16 v[36:39], v[188:191], a[244:247], v[36:39]
  ds_read_b64_tr_b16 v[176:177], v17 offset:1024
  v_cvt_pk_bf16_f32 v214, v152, v153
  v_mfma_f32_16x16x32_bf16 v[36:39], v[192:195], v[244:247], v[36:39]
  buffer_store_dwordx4 v[208:211], v21, s[16:19], s3 offen offset:1024 sc1
  v_mfma_f32_16x16x32_bf16 v[40:43], v[184:187], a[216:219], v[40:43]
  ds_read_b64_tr_b16 v[178:179], v17 offset:7168
  v_cvt_pk_bf16_f32 v215, v154, v155
  v_mfma_f32_16x16x32_bf16 v[40:43], v[188:191], a[248:251], v[40:43]
  buffer_load_dwordx4 v10, s[12:15], s35 offen offset:2048 lds
  v_mul_f32 v140, v140, v108
  v_mfma_f32_16x16x32_bf16 v[40:43], v[192:195], v[248:251], v[40:43]
  ds_read_b64_tr_b16 v[180:181], v17 offset:2048
  v_mul_f32 v141, v141, v109
  v_mfma_f32_16x16x32_bf16 v[44:47], v[184:187], a[220:223], v[44:47]
  ds_write_b128 v21, v[212:215] offset:26624
  v_mfma_f32_16x16x32_bf16 v[44:47], v[188:191], a[252:255], v[44:47]
  s_waitcnt lgkmcnt(6)
  ds_read_b64_tr_b16 v[182:183], v17 offset:8192
  v_mul_f32 v142, v142, v110
  v_mul_f32 v143, v143, v111
  v_mfma_f32_16x16x32_bf16 v[44:47], v[192:195], v[252:255], v[44:47]
  v_cvt_pk_bf16_f32 v216, v140, v141
  v_cvt_pk_bf16_f32 v217, v142, v143
  v_mfma_f32_16x16x32_bf16 v[48:51], v[160:163], a[0:3], 0
  ds_read_b64_tr_b16 v[184:185], v18 offset:12288
  v_mul_f32 v156, v156, v124
  v_mfma_f32_16x16x32_bf16 v[48:51], v[164:167], a[32:35], v[48:51]
  s_add_u32 s35, s34, 128
  ds_read_b128 a[0:3], v23 offset:0
  v_mul_f32 v157, v157, v125
  v_mfma_f32_16x16x32_bf16 v[48:51], v[168:171], a[64:67], v[48:51]
  s_add_u32 m0, s31, 49152
  ds_read_b64_tr_b16 v[186:187], v18 offset:18432
  v_mul_f32 v158, v158, v126
  v_mfma_f32_16x16x32_bf16 v[52:55], v[160:163], a[4:7], 0
  buffer_load_dwordx4 v8, s[12:15], s35 offen offset:0 lds
  v_mul_f32 v159, v159, v127
  v_mfma_f32_16x16x32_bf16 v[52:55], v[164:167], a[36:39], v[52:55]
  ds_read_b64_tr_b16 v[188:189], v18 offset:13312
  ds_read_b128 a[4:7], v23 offset:1024
  v_mfma_f32_16x16x32_bf16 v[52:55], v[168:171], a[68:71], v[52:55]
  v_cvt_pk_bf16_f32 v218, v156, v157
  v_cvt_pk_bf16_f32 v219, v158, v159
  v_mul_f32 v196, v32, v32
  v_mfma_f32_16x16x32_bf16 v[56:59], v[160:163], a[8:11], 0
  ds_read_b64_tr_b16 v[190:191], v18 offset:19456
  v_mul_f32 v197, v33, v33
  v_mfma_f32_16x16x32_bf16 v[56:59], v[164:167], a[40:43], v[56:59]
  ds_write_b128 v21, v[216:219] offset:27648
  v_mfma_f32_16x16x32_bf16 v[56:59], v[168:171], a[72:75], v[56:59]
  ds_read_b64_tr_b16 v[192:193], v18 offset:14336
  ds_read_b128 a[8:11], v23 offset:2048
  v_mfma_f32_16x16x32_bf16 v[60:63], v[160:163], a[12:15], 0
  s_waitcnt lgkmcnt(0)
  s_cmp_ge_u32 s39, 4
  s_cbranch_scc0 L_slow0
L_ppx0:
  v_mfma_f32_16x16x32_bf16 v[60:63], v[164:167], a[44:47], v[60:63]
  ds_read_b64_tr_b16 v[194:195], v18 offset:20480
  ds_read_b128 a[12:15], v23 offset:3072
  v_mfma_f32_16x16x32_bf16 v[60:63], v[168:171], a[76:79], v[60:63]
  s_waitcnt lgkmcnt(11)
  buffer_load_dwordx4 v9, s[12:15], s35 offen offset:1024 lds
  v_mul_f32 v198, v34, v34
  v_mfma_f32_16x16x32_bf16 v[48:51], v[172:175], a[16:19], v[48:51]
  buffer_store_dwordx4 v[212:215], v21, s[16:19], s3 offen offset:2048 sc1
  ds_read_b64_tr_b16 v[160:161], v19 offset:12288
  v_mul_f32 v199, v35, v35
  v_mfma_f32_16x16x32_bf16 v[48:51], v[176:179], a[48:51], v[48:51]
  ds_read_b128 a[16:19], v23 offset:4096
  v_fma_f32 v196, v196, v28, v24
  v_mfma_f32_16x16x32_bf16 v[48:51], v[180:183], a[80:83], v[48:51]
  ds_read_b64_tr_b16 v[162:163], v19 offset:18432
  v_fma_f32 v197, v197, v28, v24
  v_mfma_f32_16x16x32_bf16 v[52:55], v[172:175], a[20:23], v[52:55]
  v_fma_f32 v198, v198, v28, v24
  v_fma_f32 v199, v199, v28, v24
  v_mfma_f32_16x16x32_bf16 v[52:55], v[176:179], a[52:55], v[52:55]
  ds_read_b64_tr_b16 v[164:165], v19 offset:13312
  ds_read_b128 a[20:23], v23 offset:5120
  v_mfma_f32_16x16x32_bf16 v[52:55], v[180:183], a[84:87], v[52:55]
  v_mul_f32 v196, v196, v32
  v_mul_f32 v197, v197, v33
  v_mfma_f32_16x16x32_bf16 v[56:59], v[172:175], a[24:27], v[56:59]
  ds_read_b64_tr_b16 v[166:167], v19 offset:19456
  v_mul_f32 v198, v198, v34
  v_mfma_f32_16x16x32_bf16 v[56:59], v[176:179], a[56:59], v[56:59]
  buffer_load_dwordx4 v10, s[12:15], s35 offen offset:2048 lds
  v_mul_f32 v199, v199, v35
  v_mfma_f32_16x16x32_bf16 v[56:59], v[180:183], a[88:91], v[56:59]
  ds_read_b64_tr_b16 v[168:169], v19 offset:14336
  ds_read_b128 a[24:27], v23 offset:6144
  v_mul_f32 v200, v36, v36
  v_mfma_f32_16x16x32_bf16 v[60:63], v[172:175], a[28:31], v[60:63]
  v_exp_f32 v196, v196
  v_mfma_f32_16x16x32_bf16 v[60:63], v[176:179], a[60:63], v[60:63]
  s_waitcnt lgkmcnt(9) vmcnt(9)
  ds_read_b64_tr_b16 v[170:171], v19 offset:20480
  ds_read_b128 a[28:31], v23 offset:7168
  v_mfma_f32_16x16x32_bf16 v[60:63], v[180:183], a[92:95], v[60:63]
  s_barrier
  v_mfma_f32_16x16x32_bf16 v[48:51], v[184:187], a[96:99], v[48:51]
  ds_read_b64_tr_b16 v[172:173], v16 offset:12288
  ds_read_b128 a[32:35], v23 offset:8192
  v_mfma_f32_16x16x32_bf16 v[48:51], v[188:191], a[128:131], v[48:51]
  s_add_u32 s35, s34, 110720
  ds_read_b128 a[36:39], v23 offset:9216
  v_add_f32 v196, 1.0, v196
  v_mfma_f32_16x16x32_bf16 v[48:51], v[192:195], a[160:163], v[48:51]
  s_add_u32 m0, s31, 0
  ds_read_b64_tr_b16 v[174:175], v16 offset:18432
  ds_read_b128 a[40:43], v23 offset:10240
  v_mfma_f32_16x16x32_bf16 v[52:55], v[184:187], a[100:103], v[52:55]
  buffer_load_dwordx4 v8, s[12:15], s35 offen offset:0 lds
  v_exp_f32 v197, v197
  v_mfma_f32_16x16x32_bf16 v[52:55], v[188:191], a[132:135], v[52:55]
  ds_read_b64_tr_b16 v[176:177], v16 offset:13312
  ds_read_b128 a[44:47], v23 offset:11264
  v_mfma_f32_16x16x32_bf16 v[52:55], v[192:195], a[164:167], v[52:55]
  ds_read_b128 a[48:51], v23 offset:12288
  v_add_f32 v197, 1.0, v197
  v_mfma_f32_16x16x32_bf16 v[56:59], v[184:187], a[104:107], v[56:59]
  ds_read_b64_tr_b16 v[178:179], v16 offset:19456
  ds_read_b128 a[52:55], v23 offset:13312
  v_mfma_f32_16x16x32_bf16 v[56:59], v[188:191], a[136:139], v[56:59]
  buffer_store_dwordx4 v[216:219], v21, s[16:19], s3 offen offset:3072 sc1
  v_mfma_f32_16x16x32_bf16 v[56:59], v[192:195], a[168:171], v[56:59]
  ds_read_b64_tr_b16 v[180:181], v16 offset:14336
  ds_read_b128 a[56:59], v23 offset:14336
  v_mfma_f32_16x16x32_bf16 v[60:63], v[184:187], a[108:111], v[60:63]
  ds_read_b128 a[60:63], v23 offset:15360
  v_mul_f32 v201, v37, v37
  v_mfma_f32_16x16x32_bf16 v[60:63], v[188:191], a[140:143], v[60:63]
  ds_read_b64_tr_b16 v[182:183], v16 offset:20480
  ds_read_b128 a[64:67], v23 offset:16384
  v_mul_f32 v202, v38, v38
  v_mfma_f32_16x16x32_bf16 v[60:63], v[192:195], a[172:175], v[60:63]
  s_waitcnt lgkmcnt(15)
  buffer_load_dwordx4 v9, s[12:15], s35 offen offset:1024 lds
  v_mul_f32 v203, v39, v39
  v_mfma_f32_16x16x32_bf16 v[48:51], v[160:163], a[112:115], v[48:51]
  ds_read_b64_tr_b16 v[184:185], v17 offset:12288
  ds_read_b128 a[68:71], v23 offset:17408
  v_mfma_f32_16x16x32_bf16 v[48:51], v[164:167], a[144:147], v[48:51]
  ds_read_b128 a[72:75], v23 offset:18432
  v_fma_f32 v200, v200, v29, v25
  v_mfma_f32_16x16x32_bf16 v[48:51], v[168:171], a[176:179], v[48:51]
  ds_read_b64_tr_b16 v[186:187], v17 offset:18432
  ds_read_b128 a[76:79], v23 offset:19456
  v_mfma_f32_16x16x32_bf16 v[52:55], v[160:163], a[116:119], v[52:55]
  v_exp_f32 v198, v198
  v_mfma_f32_16x16x32_bf16 v[52:55], v[164:167], a[148:151], v[52:55]
  ds_read_b64_tr_b16 v[188:189], v17 offset:13312
  ds_read_b128 a[80:83], v23 offset:20480
  v_mfma_f32_16x16x32_bf16 v[52:55], v[168:171], a[180:183], v[52:55]
  ds_read_b128 a[84:87], v23 offset:21504
  v_exp_f32 v199, v199
  v_mfma_f32_16x16x32_bf16 v[56:59], v[160:163], a[120:123], v[56:59]
  ds_read_b64_tr_b16 v[190:191], v17 offset:19456
  ds_read_b128 a[88:91], v23 offset:22528
  v_mfma_f32_16x16x32_bf16 v[56:59], v[164:167], a[152:155], v[56:59]
  buffer_load_dwordx4 v10, s[12:15], s35 offen offset:2048 lds
  v_add_f32 v198, 1.0, v198
  v_mfma_f32_16x16x32_bf16 v[56:59], v[168:171], a[184:187], v[56:59]
  ds_read_b64_tr_b16 v[192:193], v17 offset:14336
  ds_read_b128 a[92:95], v23 offset:23552
  v_mfma_f32_16x16x32_bf16 v[60:63], v[160:163], a[124:127], v[60:63]
  v_rcp_f32 v196, v196
  v_mfma_f32_16x16x32_bf16 v[60:63], v[164:167], a[156:159], v[60:63]
  s_waitcnt lgkmcnt(13)
  ds_read_b64_tr_b16 v[194:195], v17 offset:20480
  v_add_f32 v199, 1.0, v199
  v_mfma_f32_16x16x32_bf16 v[60:63], v[168:171], a[188:191], v[60:63]
  v_rcp_f32 v197, v197
  v_mfma_f32_16x16x32_bf16 v[48:51], v[172:175], a[192:195], v[48:51]
  ds_read_b64_tr_b16 v[160:161], v12 offset:24576
  v_rcp_f32 v198, v198
  v_mfma_f32_16x16x32_bf16 v[48:51], v[176:179], a[224:227], v[48:51]
L_st_f000:
  s_cbranch_execz L_wuret_s2
  s_add_u32 s35, s34, 256
  v_rcp_f32 v199, v199
  v_mfma_f32_16x16x32_bf16 v[48:51], v[180:183], v[224:227], v[48:51]
  s_add_u32 m0, s31, 61440
  ds_read_b64_tr_b16 v[162:163], v12 offset:30720
  v_mul_f32 v32, v32, v196
  v_mfma_f32_16x16x32_bf16 v[52:55], v[172:175], a[196:199], v[52:55]
  buffer_load_dwordx4 v8, s[12:15], s35 offen offset:0 lds
  v_mul_f32 v33, v33, v197
  v_mfma_f32_16x16x32_bf16 v[52:55], v[176:179], a[228:231], v[52:55]
  ds_read_b64_tr_b16 v[164:165], v12 offset:25600
  v_mul_f32 v34, v34, v198
  v_mfma_f32_16x16x32_bf16 v[52:55], v[180:183], v[228:231], v[52:55]
  v_mul_f32 v35, v35, v199
  v_fma_f32 v201, v201, v29, v25
  v_mfma_f32_16x16x32_bf16 v[56:59], v[172:175], a[200:203], v[56:59]
  ds_read_b64_tr_b16 v[166:167], v12 offset:31744
  v_fma_f32 v202, v202, v29, v25
  v_mfma_f32_16x16x32_bf16 v[56:59], v[176:179], a[232:235], v[56:59]
  v_fma_f32 v203, v203, v29, v25
  v_mul_f32 v200, v200, v36
  v_mul_f32 v201, v201, v37
  v_mfma_f32_16x16x32_bf16 v[56:59], v[180:183], v[232:235], v[56:59]
  ds_read_b64_tr_b16 v[168:169], v12 offset:26624
  v_mul_f32 v202, v202, v38
  v_mfma_f32_16x16x32_bf16 v[60:63], v[172:175], a[204:207], v[60:63]
  v_exp_f32 v200, v200
  v_mfma_f32_16x16x32_bf16 v[60:63], v[176:179], a[236:239], v[60:63]
  ds_read_b64_tr_b16 v[170:171], v12 offset:32768
  v_mul_f32 v203, v203, v39
  v_mfma_f32_16x16x32_bf16 v[60:63], v[180:183], v[236:239], v[60:63]
  s_waitcnt lgkmcnt(6)
  buffer_load_dwordx4 v9, s[12:15], s35 offen offset:1024 lds
  v_add_f32 v200, 1.0, v200
  v_mfma_f32_16x16x32_bf16 v[48:51], v[184:187], a[208:211], v[48:51]
  ds_read_b64_tr_b16 v[172:173], v13 offset:24576
  v_mul_f32 v196, v40, v40
  v_mfma_f32_16x16x32_bf16 v[48:51], v[188:191], a[240:243], v[48:51]
  v_exp_f32 v201, v201
  v_mfma_f32_16x16x32_bf16 v[48:51], v[192:195], v[240:243], v[48:51]
  ds_read_b64_tr_b16 v[174:175], v13 offset:30720
  v_exp_f32 v202, v202
  v_mfma_f32_16x16x32_bf16 v[52:55], v[184:187], a[212:215], v[52:55]
  v_exp_f32 v203, v203
  v_mfma_f32_16x16x32_bf16 v[52:55], v[188:191], a[244:247], v[52:55]
  ds_read_b64_tr_b16 v[176:177], v13 offset:25600
  v_add_f32 v201, 1.0, v201
  v_mfma_f32_16x16x32_bf16 v[52:55], v[192:195], v[244:247], v[52:55]
  v_rcp_f32 v200, v200
  v_mfma_f32_16x16x32_bf16 v[56:59], v[184:187], a[216:219], v[56:59]
  ds_read_b64_tr_b16 v[178:179], v13 offset:31744
  v_add_f32 v202, 1.0, v202
  v_mfma_f32_16x16x32_bf16 v[56:59], v[188:191], a[248:251], v[56:59]
  buffer_load_dwordx4 v10, s[12:15], s35 offen offset:2048 lds
  v_add_f32 v203, 1.0, v203
  v_mfma_f32_16x16x32_bf16 v[56:59], v[192:195], v[248:251], v[56:59]
  ds_read_b64_tr_b16 v[180:181], v13 offset:26624
  v_mul_f32 v36, v36, v200
  v_mfma_f32_16x16x32_bf16 v[60:63], v[184:187], a[220:223], v[60:63]
  v_rcp_f32 v201, v201
  v_mfma_f32_16x16x32_bf16 v[60:63], v[188:191], a[252:255], v[60:63]
  s_waitcnt lgkmcnt(5) vmcnt(11)
  ds_read_b64_tr_b16 v[182:183], v13 offset:32768
  v_rcp_f32 v202, v202
  v_mfma_f32_16x16x32_bf16 v[60:63], v[192:195], v[252:255], v[60:63]
  s_barrier
  v_mfma_f32_16x16x32_bf16 v[64:67], v[160:163], a[0:3], 0
  ds_read_b64_tr_b16 v[184:185], v12 offset:36864
  v_mul_f32 v37, v37, v201
  v_mfma_f32_16x16x32_bf16 v[64:67], v[164:167], a[16:19], v[64:67]
  s_add_u32 s36, s43, 0
  v_rcp_f32 v203, v203
  v_mfma_f32_16x16x32_bf16 v[64:67], v[168:171], a[32:35], v[64:67]
  s_add_u32 m0, s44, 0
  ds_read_b64_tr_b16 v[186:187], v12 offset:43008
  v_mul_f32 v38, v38, v202
  v_mfma_f32_16x16x32_bf16 v[68:71], v[160:163], a[4:7], 0
  buffer_load_dwordx4 v222, s[16:19], s36 offen offset:0 sc1 lds
  v_mul_f32 v39, v39, v203
  v_mfma_f32_16x16x32_bf16 v[68:71], v[164:167], a[20:23], v[68:71]
  ds_read_b64_tr_b16 v[188:189], v12 offset:37888
  v_mul_f32 v197, v41, v41
  v_mfma_f32_16x16x32_bf16 v[68:71], v[168:171], a[36:39], v[68:71]
  s_add_u32 s35, s34, 110848
  v_mul_f32 v198, v42, v42
  v_mul_f32 v199, v43, v43
  v_fma_f32 v196, v196, v30, v26
  v_mfma_f32_16x16x32_bf16 v[72:75], v[160:163], a[8:11], 0
  s_add_u32 m0, s31, 12288
  ds_read_b64_tr_b16 v[190:191], v12 offset:44032
  v_fma_f32 v197, v197, v30, v26
  v_mfma_f32_16x16x32_bf16 v[72:75], v[164:167], a[24:27], v[72:75]
  buffer_load_dwordx4 v8, s[12:15], s35 offen offset:0 lds
  v_fma_f32 v198, v198, v30, v26
  v_mfma_f32_16x16x32_bf16 v[72:75], v[168:171], a[40:43], v[72:75]
  ds_read_b64_tr_b16 v[192:193], v12 offset:38912
  v_fma_f32 v199, v199, v30, v26
  v_mfma_f32_16x16x32_bf16 v[76:79], v[160:163], a[12:15], 0
  v_mul_f32 v196, v196, v40
  v_mul_f32 v197, v197, v41
  v_mfma_f32_16x16x32_bf16 v[76:79], v[164:167], a[28:31], v[76:79]
  ds_read_b64_tr_b16 v[194:195], v12 offset:45056
  v_mul_f32 v198, v198, v42
  v_mfma_f32_16x16x32_bf16 v[76:79], v[168:171], a[44:47], v[76:79]
  s_waitcnt lgkmcnt(6)
  buffer_load_dwordx4 v9, s[12:15], s35 offen offset:1024 lds
  v_mul_f32 v199, v199, v43
  v_mfma_f32_16x16x32_bf16 v[80:83], v[172:175], a[0:3], 0
  ds_read_b64_tr_b16 v[160:161], v13 offset:36864
  v_mul_f32 v200, v44, v44
  v_mfma_f32_16x16x32_bf16 v[80:83], v[176:179], a[16:19], v[80:83]
  v_exp_f32 v196, v196
  v_mul_f32 v201, v45, v45
  v_mfma_f32_16x16x32_bf16 v[80:83], v[180:183], a[32:35], v[80:83]
  s_add_u32 m0, s44, 0
  ds_read_b64_tr_b16 v[162:163], v13 offset:43008
  v_mul_f32 v202, v46, v46
  v_mfma_f32_16x16x32_bf16 v[84:87], v[172:175], a[4:7], 0
  buffer_load_dwordx4 v222, s[16:19], s36 offen offset:1024 sc1 lds
  v_add_f32 v196, 1.0, v196
  v_mfma_f32_16x16x32_bf16 v[84:87], v[176:179], a[20:23], v[84:87]
  ds_read_b64_tr_b16 v[164:165], v13 offset:37888
  v_mul_f32 v203, v47, v47
  v_mfma_f32_16x16x32_bf16 v[84:87], v[180:183], a[36:39], v[84:87]
  v_exp_f32 v197, v197
  v_mfma_f32_16x16x32_bf16 v[88:91], v[172:175], a[8:11], 0
  s_add_u32 m0, s31, 12288
  ds_read_b64_tr_b16 v[166:167], v13 offset:44032
  v_fma_f32 v200, v200, v31, v27
  v_mfma_f32_16x16x32_bf16 v[88:91], v[176:179], a[24:27], v[88:91]
  buffer_load_dwordx4 v10, s[12:15], s35 offen offset:2048 lds
  v_add_f32 v197, 1.0, v197
  v_mfma_f32_16x16x32_bf16 v[88:91], v[180:183], a[40:43], v[88:91]
  ds_read_b64_tr_b16 v[168:169], v13 offset:38912
  v_fma_f32 v201, v201, v31, v27
  v_mfma_f32_16x16x32_bf16 v[92:95], v[172:175], a[12:15], 0
  v_exp_f32 v198, v198
  v_mfma_f32_16x16x32_bf16 v[92:95], v[176:179], a[28:31], v[92:95]
  s_waitcnt lgkmcnt(5) vmcnt(12)
  ds_read_b64_tr_b16 v[170:171], v13 offset:45056
  v_exp_f32 v199, v199
  v_mfma_f32_16x16x32_bf16 v[92:95], v[180:183], a[44:47], v[92:95]
  s_barrier
  v_mfma_f32_16x16x32_bf16 v[64:67], v[184:187], a[48:51], v[64:67]
  ds_read_b64_tr_b16 v[172:173], v12 offset:49152
  v_add_f32 v198, 1.0, v198
  v_mfma_f32_16x16x32_bf16 v[64:67], v[188:191], a[64:67], v[64:67]
  v_rcp_f32 v196, v196
  v_mfma_f32_16x16x32_bf16 v[64:67], v[192:195], a[80:83], v[64:67]
  s_add_u32 m0, s44, 0
  ds_read_b64_tr_b16 v[174:175], v12 offset:55296
  v_add_f32 v199, 1.0, v199
  v_mfma_f32_16x16x32_bf16 v[68:71], v[184:187], a[52:55], v[68:71]
  buffer_load_dwordx4 v222, s[16:19], s36 offen offset:2048 sc1 lds
  v_mul_f32 v40, v40, v196
  v_mfma_f32_16x16x32_bf16 v[68:71], v[188:191], a[68:71], v[68:71]
  ds_read_b64_tr_b16 v[176:177], v12 offset:50176
  v_fma_f32 v202, v202, v31, v27
  v_mfma_f32_16x16x32_bf16 v[68:71], v[192:195], a[84:87], v[68:71]
  s_add_u32 s35, s34, 221184
  v_rcp_f32 v197, v197
  v_mfma_f32_16x16x32_bf16 v[72:75], v[184:187], a[56:59], v[72:75]
  s_add_u32 m0, s31, 73728
  ds_read_b64_tr_b16 v[178:179], v12 offset:56320
  v_rcp_f32 v198, v198
  v_mfma_f32_16x16x32_bf16 v[72:75], v[188:191], a[72:75], v[72:75]
  s_buffer_load_dword s39, s[16:19], s45 offset:128 glc
  buffer_load_dwordx4 v8, s[12:15], s35 offen offset:0 lds
  v_mul_f32 v41, v41, v197
  v_mfma_f32_16x16x32_bf16 v[72:75], v[192:195], a[88:91], v[72:75]
  ds_read_b64_tr_b16 v[180:181], v12 offset:51200
  v_mul_f32 v42, v42, v198
  v_mfma_f32_16x16x32_bf16 v[76:79], v[184:187], a[60:63], v[76:79]
  s_add_u32 s36, s43, 3072
  v_rcp_f32 v199, v199
  v_mfma_f32_16x16x32_bf16 v[76:79], v[188:191], a[76:79], v[76:79]
  s_add_u32 m0, s44, 3072
  ds_read_b64_tr_b16 v[182:183], v12 offset:57344
  v_fma_f32 v203, v203, v31, v27
  v_mfma_f32_16x16x32_bf16 v[76:79], v[192:195], a[92:95], v[76:79]
  s_waitcnt lgkmcnt(6)
  buffer_load_dwordx4 v222, s[16:19], s36 offen offset:0 sc1 lds
  v_mul_f32 v43, v43, v199
  v_mfma_f32_16x16x32_bf16 v[80:83], v[160:163], a[48:51], v[80:83]
  ds_read_b64_tr_b16 v[184:185], v13 offset:49152
  v_mul_f32 v200, v200, v44
  v_mfma_f32_16x16x32_bf16 v[80:83], v[164:167], a[64:67], v[80:83]
  v_exp_f32 v200, v200
  v_mfma_f32_16x16x32_bf16 v[80:83], v[168:171], a[80:83], v[80:83]
  s_add_u32 m0, s31, 73728
  ds_read_b64_tr_b16 v[186:187], v13 offset:55296
  v_mul_f32 v201, v201, v45
  v_mfma_f32_16x16x32_bf16 v[84:87], v[160:163], a[52:55], v[84:87]
  buffer_load_dwordx4 v9, s[12:15], s35 offen offset:1024 lds
  v_exp_f32 v201, v201
  v_mfma_f32_16x16x32_bf16 v[84:87], v[164:167], a[68:71], v[84:87]
  ds_read_b64_tr_b16 v[188:189], v13 offset:50176
  v_mul_f32 v202, v202, v46
  v_mfma_f32_16x16x32_bf16 v[84:87], v[168:171], a[84:87], v[84:87]
  v_exp_f32 v202, v202
  v_mfma_f32_16x16x32_bf16 v[88:91], v[160:163], a[56:59], v[88:91]
  s_add_u32 m0, s44, 3072
  ds_read_b64_tr_b16 v[190:191], v13 offset:56320
  v_mul_f32 v203, v203, v47
  v_mfma_f32_16x16x32_bf16 v[88:91], v[164:167], a[72:75], v[88:91]
  buffer_load_dwordx4 v222, s[16:19], s36 offen offset:1024 sc1 lds
  v_add_f32 v200, 1.0, v200
  v_mfma_f32_16x16x32_bf16 v[88:91], v[168:171], a[88:91], v[88:91]
  ds_read_b64_tr_b16 v[192:193], v13 offset:51200
  v_add_f32 v201, 1.0, v201
  v_mfma_f32_16x16x32_bf16 v[92:95], v[160:163], a[60:63], v[92:95]
  v_exp_f32 v203, v203
  v_mfma_f32_16x16x32_bf16 v[92:95], v[164:167], a[76:79], v[92:95]
  s_waitcnt lgkmcnt(5) vmcnt(13)
  ds_read_b64_tr_b16 v[194:195], v13 offset:57344
  v_add_f32 v202, 1.0, v202
  v_mfma_f32_16x16x32_bf16 v[92:95], v[168:171], a[92:95], v[92:95]
  s_barrier
  v_mfma_f32_16x16x32_bf16 v[96:99], v[172:175], a[0:3], 0
  ds_read_b64_tr_b16 v[160:161], v12 offset:0
  v_add_f32 v203, 1.0, v203
  v_mfma_f32_16x16x32_bf16 v[96:99], v[176:179], a[16:19], v[96:99]
  v_rcp_f32 v200, v200
  v_mul_f32 v48, v48, v32
  v_mfma_f32_16x16x32_bf16 v[96:99], v[180:183], a[32:35], v[96:99]
  s_add_u32 m0, s31, 73728
  ds_read_b64_tr_b16 v[162:163], v12 offset:6144
  v_mul_f32 v49, v49, v33
  v_mfma_f32_16x16x32_bf16 v[100:103], v[172:175], a[4:7], 0
  buffer_load_dwordx4 v11, s[12:15], s35 offen offset:2048 lds
  v_mul_f32 v44, v44, v200
  v_mfma_f32_16x16x32_bf16 v[100:103], v[176:179], a[20:23], v[100:103]
  ds_read_b64_tr_b16 v[164:165], v12 offset:1024
  v_mul_f32 v50, v50, v34
  v_mfma_f32_16x16x32_bf16 v[100:103], v[180:183], a[36:39], v[100:103]
  v_rcp_f32 v201, v201
  v_mfma_f32_16x16x32_bf16 v[104:107], v[172:175], a[8:11], 0
  s_add_u32 m0, s44, 3072
  ds_read_b64_tr_b16 v[166:167], v12 offset:7168
  v_mul_f32 v51, v51, v35
  v_mfma_f32_16x16x32_bf16 v[104:107], v[176:179], a[24:27], v[104:107]
  buffer_load_dwordx4 v222, s[16:19], s36 offen offset:2048 sc1 lds
  v_mul_f32 v45, v45, v201
  v_mfma_f32_16x16x32_bf16 v[104:107], v[180:183], a[40:43], v[104:107]
  ds_read_b64_tr_b16 v[168:169], v12 offset:2048
  v_cvt_pk_bf16_f32 v204, v48, v49
  v_mfma_f32_16x16x32_bf16 v[108:111], v[172:175], a[12:15], 0
  s_add_u32 s35, s34, 221312
  v_rcp_f32 v202, v202
  v_mfma_f32_16x16x32_bf16 v[108:111], v[176:179], a[28:31], v[108:111]
  s_add_u32 m0, s31, 24576
  ds_read_b64_tr_b16 v[170:171], v12 offset:8192
  v_cvt_pk_bf16_f32 v205, v50, v51
  v_mfma_f32_16x16x32_bf16 v[108:111], v[180:183], a[44:47], v[108:111]
  s_waitcnt lgkmcnt(6)
  buffer_load_dwordx4 v8, s[12:15], s35 offen offset:0 lds
  v_mul_f32 v46, v46, v202
  v_mfma_f32_16x16x32_bf16 v[112:115], v[184:187], a[0:3], 0
  s_add_u32 s3, s42, 32768
  buffer_store_dwordx2 v[204:205], v22, s[16:19], s3 offen offset:0 sc1
  ds_read_b64_tr_b16 v[172:173], v13 offset:0
  v_mfma_f32_16x16x32_bf16 v[112:115], v[188:191], a[16:19], v[112:115]
  s_waitcnt lgkmcnt(0)
  s_cmp_ge_u32 s39, 4
  s_cbranch_scc0 L_slow1
L_ppx1:
  v_mfma_f32_16x16x32_bf16 v[112:115], v[192:195], a[32:35], v[112:115]
  ds_read_b64_tr_b16 v[174:175], v13 offset:6144
  v_rcp_f32 v203, v203
  v_mfma_f32_16x16x32_bf16 v[116:119], v[184:187], a[4:7], 0
  buffer_load_dwordx4 v9, s[12:15], s35 offen offset:1024 lds
  ds_write_b64 v22, v[204:205] offset:32768
  v_mfma_f32_16x16x32_bf16 v[116:119], v[188:191], a[20:23], v[116:119]
  ds_read_b64_tr_b16 v[176:177], v13 offset:1024
  v_mul_f32 v47, v47, v203
  v_mfma_f32_16x16x32_bf16 v[116:119], v[192:195], a[36:39], v[116:119]
  s_add_u32 s36, s43, 12288
  v_mul_f32 v52, v52, v36
  v_mul_f32 v53, v53, v37
  v_mfma_f32_16x16x32_bf16 v[120:123], v[184:187], a[8:11], 0
  s_add_u32 m0, s44, 12288
  ds_read_b64_tr_b16 v[178:179], v13 offset:7168
  v_mul_f32 v54, v54, v38
  v_mfma_f32_16x16x32_bf16 v[120:123], v[188:191], a[24:27], v[120:123]
  buffer_load_dwordx4 v222, s[16:19], s36 offen offset:0 sc1 lds
  v_mul_f32 v55, v55, v39
  v_mfma_f32_16x16x32_bf16 v[120:123], v[192:195], a[40:43], v[120:123]
  ds_read_b64_tr_b16 v[180:181], v13 offset:2048
  v_cvt_pk_bf16_f32 v208, v52, v53
  v_mfma_f32_16x16x32_bf16 v[124:127], v[184:187], a[12:15], 0
  v_cvt_pk_bf16_f32 v209, v54, v55
  ds_write_b64 v22, v[208:209] offset:33792
  v_mfma_f32_16x16x32_bf16 v[124:127], v[188:191], a[28:31], v[124:127]
  s_waitcnt lgkmcnt(7) vmcnt(16)
  ds_read_b64_tr_b16 v[182:183], v13 offset:8192
  v_mul_f32 v56, v56, v40
  v_mfma_f32_16x16x32_bf16 v[124:127], v[192:195], a[44:47], v[124:127]
  s_barrier
  v_mfma_f32_16x16x32_bf16 v[96:99], v[160:163], a[48:51], v[96:99]
  buffer_store_dwordx2 v[208:209], v22, s[16:19], s3 offen offset:1024 sc1
  ds_read_b64_tr_b16 v[184:185], v14 offset:0
  v_mfma_f32_16x16x32_bf16 v[96:99], v[164:167], a[64:67], v[96:99]
  ds_read_b128 a[96:99], v23 offset:24576
  v_mul_f32 v57, v57, v41
  v_mfma_f32_16x16x32_bf16 v[96:99], v[168:171], a[80:83], v[96:99]
  ds_read_b64_tr_b16 v[186:187], v14 offset:6144
  v_mul_f32 v58, v58, v42
  v_mfma_f32_16x16x32_bf16 v[100:103], v[160:163], a[52:55], v[100:103]
  buffer_load_dwordx4 v222, s[16:19], s36 offen offset:1024 sc1 lds
  v_mul_f32 v59, v59, v43
  v_mfma_f32_16x16x32_bf16 v[100:103], v[164:167], a[68:71], v[100:103]
  ds_read_b64_tr_b16 v[188:189], v14 offset:1024
  v_cvt_pk_bf16_f32 v212, v56, v57
  v_mfma_f32_16x16x32_bf16 v[100:103], v[168:171], a[84:87], v[100:103]
  ds_read_b128 a[100:103], v23 offset:25600
  v_cvt_pk_bf16_f32 v213, v58, v59
  v_mfma_f32_16x16x32_bf16 v[104:107], v[160:163], a[56:59], v[104:107]
  s_add_u32 m0, s31, 24576
  ds_read_b64_tr_b16 v[190:191], v14 offset:7168
  v_mul_f32 v60, v60, v44
  v_mfma_f32_16x16x32_bf16 v[104:107], v[164:167], a[72:75], v[104:107]
  buffer_load_dwordx4 v11, s[12:15], s35 offen offset:2048 lds
  ds_write_b64 v22, v[212:213] offset:34816
  v_mfma_f32_16x16x32_bf16 v[104:107], v[168:171], a[88:91], v[104:107]
  buffer_store_dwordx2 v[212:213], v22, s[16:19], s3 offen offset:2048 sc1
  ds_read_b64_tr_b16 v[192:193], v14 offset:2048
  v_mfma_f32_16x16x32_bf16 v[108:111], v[160:163], a[60:63], v[108:111]
  s_add_u32 s35, s34, 221440
  ds_read_b128 a[104:107], v23 offset:26624
  v_mul_f32 v61, v61, v45
  v_mfma_f32_16x16x32_bf16 v[108:111], v[164:167], a[76:79], v[108:111]
  s_add_u32 m0, s31, 36864
  ds_read_b64_tr_b16 v[194:195], v14 offset:8192
  v_mul_f32 v62, v62, v46
  v_mfma_f32_16x16x32_bf16 v[108:111], v[168:171], a[92:95], v[108:111]
  s_waitcnt lgkmcnt(10)
  buffer_load_dwordx4 v8, s[12:15], s35 offen offset:0 lds
  v_mul_f32 v63, v63, v47
  v_mfma_f32_16x16x32_bf16 v[112:115], v[172:175], a[48:51], v[112:115]
  ds_read_b64_tr_b16 v[160:161], v15 offset:0
  v_cvt_pk_bf16_f32 v216, v60, v61
  v_mfma_f32_16x16x32_bf16 v[112:115], v[176:179], a[64:67], v[112:115]
  ds_read_b128 a[108:111], v23 offset:27648
  v_cvt_pk_bf16_f32 v217, v62, v63
  v_mfma_f32_16x16x32_bf16 v[112:115], v[180:183], a[80:83], v[112:115]
  s_add_u32 m0, s44, 12288
  ds_read_b64_tr_b16 v[162:163], v15 offset:6144
  v_lshrrev_b32 v196, 4, v1
  v_mfma_f32_16x16x32_bf16 v[116:119], v[172:175], a[52:55], v[116:119]
  buffer_load_dwordx4 v222, s[16:19], s36 offen offset:2048 sc1 lds
  ds_write_b64 v22, v[216:217] offset:35840
  s_lshr_b32 s32, s29, 2
  s_xor_b32 s32, s32, s25
  s_lshl_b32 s32, s32, 2
  s_and_b32 s33, s29, 3
  s_add_u32 s32, s32, s33
  s_bfm_b32 s32, 1, s32
  s_lshl_b32 s33, s26, 10
  s_add_u32 s33, s33, 147456
  v_mfma_f32_16x16x32_bf16 v[116:119], v[176:179], a[68:71], v[116:119]
  buffer_store_dwordx2 v[216:217], v22, s[16:19], s3 offen offset:3072 sc1
  ds_read_b64_tr_b16 v[164:165], v15 offset:1024
  v_mfma_f32_16x16x32_bf16 v[116:119], v[180:183], a[84:87], v[116:119]
  ds_read_b128 a[112:115], v23 offset:28672
  v_lshlrev_b32 v196, 1, v196
  v_mfma_f32_16x16x32_bf16 v[120:123], v[172:175], a[56:59], v[120:123]
  s_add_u32 m0, s31, 36864
  ds_read_b64_tr_b16 v[166:167], v15 offset:7168
  v_xor_b32 v196, v196, v1
  v_mfma_f32_16x16x32_bf16 v[120:123], v[176:179], a[72:75], v[120:123]
  buffer_load_dwordx4 v9, s[12:15], s35 offen offset:1024 lds
  v_bfe_u32 v196, v196, 2, 1
  v_mfma_f32_16x16x32_bf16 v[120:123], v[180:183], a[88:91], v[120:123]
  ds_read_b64_tr_b16 v[168:169], v15 offset:2048
  v_lshlrev_b32 v197, 6, v196
  v_mfma_f32_16x16x32_bf16 v[124:127], v[172:175], a[60:63], v[124:127]
  ds_read_b128 a[116:119], v23 offset:29696
  v_sub_u32 v197, v8, v197
  v_mfma_f32_16x16x32_bf16 v[124:127], v[176:179], a[76:79], v[124:127]
  s_waitcnt lgkmcnt(5) vmcnt(19)
  ds_read_b64_tr_b16 v[170:171], v15 offset:8192
  v_xor_b32 v196, s30, v196
  v_mfma_f32_16x16x32_bf16 v[124:127], v[180:183], a[92:95], v[124:127]
  s_barrier
  v_mfma_f32_16x16x32_bf16 v[128:131], v[184:187], a[0:3], 0
  ds_read_b64_tr_b16 v[172:173], v12 offset:12288
  v_mul_u32_u24 v198, 294912, v196
  v_mfma_f32_16x16x32_bf16 v[128:131], v[188:191], a[16:19], v[128:131]
  s_add_u32 s36, s43, 15360
  ds_read_b128 a[120:123], v23 offset:30720
  v_add_u32 v5, v197, v198
  v_mfma_f32_16x16x32_bf16 v[128:131], v[192:195], a[32:35], v[128:131]
  s_add_u32 m0, s44, 15360
  ds_read_b64_tr_b16 v[174:175], v12 offset:18432
  v_add_u32 v6, 35840, v5
  v_mfma_f32_16x16x32_bf16 v[132:135], v[184:187], a[4:7], 0
  buffer_load_dwordx4 v222, s[16:19], s36 offen offset:0 sc1 lds
  v_add_u32 v7, 71680, v5
  v_mfma_f32_16x16x32_bf16 v[132:135], v[188:191], a[20:23], v[132:135]
  ds_read_b64_tr_b16 v[176:177], v12 offset:13312
  v_mul_u32_u24 v198, 36864, v196
  v_mfma_f32_16x16x32_bf16 v[132:135], v[192:195], a[36:39], v[132:135]
  ds_read_b128 a[124:127], v23 offset:31744
  v_add_u32 v197, v197, v198
  v_mfma_f32_16x16x32_bf16 v[136:139], v[184:187], a[8:11], 0
  s_add_u32 m0, s31, 36864
  ds_read_b64_tr_b16 v[178:179], v12 offset:19456
  ds_read2st64_b64 a[128:131], v3 offset0:64 offset1:65
  v_mfma_f32_16x16x32_bf16 v[136:139], v[188:191], a[24:27], v[136:139]
  buffer_load_dwordx4 v11, s[12:15], s35 offen offset:2048 lds
  v_add_u32 v2, 366592, v197
  v_mfma_f32_16x16x32_bf16 v[136:139], v[192:195], a[40:43], v[136:139]
  ds_read_b64_tr_b16 v[180:181], v12 offset:14336
  ds_read2st64_b64 a[132:135], v3 offset0:66 offset1:67
  v_mfma_f32_16x16x32_bf16 v[140:143], v[184:187], a[12:15], 0
  ds_read2st64_b64 a[136:139], v3 offset0:68 offset1:69
  v_add_u32 v24, 122880, v12
  v_mfma_f32_16x16x32_bf16 v[140:143], v[188:191], a[28:31], v[140:143]
  s_add_u32 m0, s44, 15360
  ds_read_b64_tr_b16 v[182:183], v12 offset:20480
  ds_read2st64_b64 a[140:143], v3 offset0:70 offset1:71
  v_mfma_f32_16x16x32_bf16 v[140:143], v[192:195], a[44:47], v[140:143]
  s_waitcnt lgkmcnt(12)
  buffer_load_dwordx4 v222, s[16:19], s36 offen offset:1024 sc1 lds
  v_add_u32 v26, 122880, v16
  v_mfma_f32_16x16x32_bf16 v[144:147], v[160:163], a[0:3], 0
  ds_read_b64_tr_b16 v[184:185], v13 offset:12288
  v_add_u32 v25, 122880, v13
  v_mfma_f32_16x16x32_bf16 v[144:147], v[164:167], a[16:19], v[144:147]
  s_add_u32 s35, s40, 0
  v_add_u32 v27, 122880, v17
  v_add_u32 v29, s33, v222
  s_lshl_b32 s33, s26, 9
  s_add_u32 s33, s33, 155648
  s_lshl_b32 s48, s27, 1
  s_lshr_b32 s49, s29, 2
  s_add_u32 s48, s48, s49
  s_mul_i32 s48, s48, 73728
  s_and_b32 s49, s29, 3
  s_lshl_b32 s49, s49, 10
  s_add_u32 s48, s48, s49
  s_lshl_b32 s49, s30, 15
  s_add_u32 s49, s49, s48
  s_lshl_b32 s50, s25, 12
  s_add_u32 s49, s49, s50
  s_lshl_b32 s50, s26, 8
  s_add_u32 s49, s49, s50
  s_add_u32 s51, s49, s50
  s_xor_b32 s52, s25, s30
  v_mfma_f32_16x16x32_bf16 v[144:147], v[168:171], a[32:35], v[144:147]
  s_add_u32 m0, s31, 49152
  ds_read_b64_tr_b16 v[186:187], v13 offset:18432
  v_lshl_add_u32 v30, v1, 3, s33
  v_mfma_f32_16x16x32_bf16 v[148:151], v[160:163], a[4:7], 0
  buffer_load_dwordx4 v8, s[12:15], s35 offen offset:0 lds
  v_mov_b32 v31, 0x7f000000
  v_mfma_f32_16x16x32_bf16 v[148:151], v[164:167], a[20:23], v[148:151]
  ds_read_b64_tr_b16 v[188:189], v13 offset:13312
  v_mfma_f32_16x16x32_bf16 v[148:151], v[168:171], a[36:39], v[148:151]
  v_mfma_f32_16x16x32_bf16 v[152:155], v[160:163], a[8:11], 0
  s_add_u32 m0, s44, 15360
  ds_read_b64_tr_b16 v[190:191], v13 offset:19456
  v_mfma_f32_16x16x32_bf16 v[152:155], v[164:167], a[24:27], v[152:155]
  buffer_load_dwordx4 v222, s[16:19], s36 offen offset:2048 sc1 lds
  v_mfma_f32_16x16x32_bf16 v[152:155], v[168:171], a[40:43], v[152:155]
  ds_read_b64_tr_b16 v[192:193], v13 offset:14336
  v_mfma_f32_16x16x32_bf16 v[156:159], v[160:163], a[12:15], 0
  v_mfma_f32_16x16x32_bf16 v[156:159], v[164:167], a[28:31], v[156:159]
  s_waitcnt lgkmcnt(5) vmcnt(18)
  ds_read_b64_tr_b16 v[194:195], v13 offset:20480
  v_mfma_f32_16x16x32_bf16 v[156:159], v[168:171], a[44:47], v[156:159]
  s_barrier
  v_mfma_f32_16x16x32_bf16 v[128:131], v[172:175], a[48:51], v[128:131]
  ds_read_b64_tr_b16 v[160:161], v14 offset:12288
  v_mfma_f32_16x16x32_bf16 v[128:131], v[176:179], a[64:67], v[128:131]
  v_mfma_f32_16x16x32_bf16 v[128:131], v[180:183], a[80:83], v[128:131]
  s_add_u32 m0, s31, 49152
  ds_read_b64_tr_b16 v[162:163], v14 offset:18432
  v_mfma_f32_16x16x32_bf16 v[132:135], v[172:175], a[52:55], v[132:135]
  buffer_load_dwordx4 v9, s[12:15], s35 offen offset:1024 lds
  v_mfma_f32_16x16x32_bf16 v[132:135], v[176:179], a[68:71], v[132:135]
  ds_read_b64_tr_b16 v[164:165], v14 offset:13312
  v_mfma_f32_16x16x32_bf16 v[132:135], v[180:183], a[84:87], v[132:135]
  s_waitcnt vmcnt(7)
  buffer_atomic_inc v23, v223, s[16:19], s46 offen offset:256
  v_mfma_f32_16x16x32_bf16 v[136:139], v[172:175], a[56:59], v[136:139]
  ds_read_b64_tr_b16 v[166:167], v14 offset:19456
  v_mfma_f32_16x16x32_bf16 v[136:139], v[176:179], a[72:75], v[136:139]
  buffer_load_dwordx4 v10, s[12:15], s35 offen offset:2048 lds
  v_mfma_f32_16x16x32_bf16 v[136:139], v[180:183], a[88:91], v[136:139]
  ds_read_b64_tr_b16 v[168:169], v14 offset:14336
  v_mfma_f32_16x16x32_bf16 v[140:143], v[172:175], a[60:63], v[140:143]
  s_add_u32 s35, s40, 128
  v_mfma_f32_16x16x32_bf16 v[140:143], v[176:179], a[76:79], v[140:143]
  s_add_u32 m0, s31, 0
  ds_read_b64_tr_b16 v[170:171], v14 offset:20480
  v_mfma_f32_16x16x32_bf16 v[140:143], v[180:183], a[92:95], v[140:143]
  s_waitcnt lgkmcnt(6)
  buffer_load_dwordx4 v8, s[12:15], s35 offen offset:0 lds
  v_mfma_f32_16x16x32_bf16 v[144:147], v[184:187], a[48:51], v[144:147]
  ds_read_b64_tr_b16 v[172:173], v15 offset:12288
  v_mfma_f32_16x16x32_bf16 v[144:147], v[188:191], a[64:67], v[144:147]
  v_mfma_f32_16x16x32_bf16 v[144:147], v[192:195], a[80:83], v[144:147]
  ds_read_b64_tr_b16 v[174:175], v15 offset:18432
  v_mfma_f32_16x16x32_bf16 v[148:151], v[184:187], a[52:55], v[148:151]
  buffer_load_dwordx4 v9, s[12:15], s35 offen offset:1024 lds
  v_mfma_f32_16x16x32_bf16 v[148:151], v[188:191], a[68:71], v[148:151]
  ds_read_b64_tr_b16 v[176:177], v15 offset:13312
  v_mfma_f32_16x16x32_bf16 v[148:151], v[192:195], a[84:87], v[148:151]
  v_mfma_f32_16x16x32_bf16 v[152:155], v[184:187], a[56:59], v[152:155]
  ds_read_b64_tr_b16 v[178:179], v15 offset:19456
  v_mfma_f32_16x16x32_bf16 v[152:155], v[188:191], a[72:75], v[152:155]
  buffer_load_dwordx4 v10, s[12:15], s35 offen offset:2048 lds
  v_mfma_f32_16x16x32_bf16 v[152:155], v[192:195], a[88:91], v[152:155]
  ds_read_b64_tr_b16 v[180:181], v15 offset:14336
  v_mfma_f32_16x16x32_bf16 v[156:159], v[184:187], a[60:63], v[156:159]
  v_mfma_f32_16x16x32_bf16 v[156:159], v[188:191], a[76:79], v[156:159]
  s_waitcnt lgkmcnt(5) vmcnt(16)
  ds_read_b64_tr_b16 v[182:183], v15 offset:20480
  v_mfma_f32_16x16x32_bf16 v[156:159], v[192:195], a[92:95], v[156:159]
  s_barrier
  v_mfma_f32_16x16x32_bf16 v[64:67], v[160:163], a[96:99], v[64:67]
  ds_read_b64_tr_b16 v[184:185], v12 offset:24576
  v_mfma_f32_16x16x32_bf16 v[64:67], v[164:167], a[112:115], v[64:67]
  s_add_u32 s35, s40, 110592
  v_mfma_f32_16x16x32_bf16 v[64:67], v[168:171], a[128:131], v[64:67]
  s_add_u32 m0, s31, 61440
  ds_read_b64_tr_b16 v[186:187], v12 offset:30720
  v_mfma_f32_16x16x32_bf16 v[68:71], v[160:163], a[100:103], v[68:71]
  buffer_load_dwordx4 v8, s[12:15], s35 offen offset:0 lds
  v_mfma_f32_16x16x32_bf16 v[68:71], v[164:167], a[116:119], v[68:71]
  ds_read_b64_tr_b16 v[188:189], v12 offset:25600
  v_mfma_f32_16x16x32_bf16 v[68:71], v[168:171], a[132:135], v[68:71]
  v_mfma_f32_16x16x32_bf16 v[72:75], v[160:163], a[104:107], v[72:75]
  ds_read_b64_tr_b16 v[190:191], v12 offset:31744
  v_mfma_f32_16x16x32_bf16 v[72:75], v[164:167], a[120:123], v[72:75]
  buffer_load_dwordx4 v9, s[12:15], s35 offen offset:1024 lds
  v_mfma_f32_16x16x32_bf16 v[72:75], v[168:171], a[136:139], v[72:75]
  ds_read_b64_tr_b16 v[192:193], v12 offset:26624
  v_mfma_f32_16x16x32_bf16 v[76:79], v[160:163], a[108:111], v[76:79]
  v_mfma_f32_16x16x32_bf16 v[76:79], v[164:167], a[124:127], v[76:79]
  ds_read_b64_tr_b16 v[194:195], v12 offset:32768
  v_mfma_f32_16x16x32_bf16 v[76:79], v[168:171], a[140:143], v[76:79]
  s_waitcnt lgkmcnt(6)
  buffer_load_dwordx4 v10, s[12:15], s35 offen offset:2048 lds
  v_mfma_f32_16x16x32_bf16 v[80:83], v[172:175], a[96:99], v[80:83]
  ds_read_b64_tr_b16 v[160:161], v13 offset:24576
  v_mfma_f32_16x16x32_bf16 v[80:83], v[176:179], a[112:115], v[80:83]
  s_add_u32 s35, s40, 110720
  v_mfma_f32_16x16x32_bf16 v[80:83], v[180:183], a[128:131], v[80:83]
  s_add_u32 m0, s31, 12288
  ds_read_b64_tr_b16 v[162:163], v13 offset:30720
  v_mfma_f32_16x16x32_bf16 v[84:87], v[172:175], a[100:103], v[84:87]
  buffer_load_dwordx4 v8, s[12:15], s35 offen offset:0 lds
  v_mfma_f32_16x16x32_bf16 v[84:87], v[176:179], a[116:119], v[84:87]
  ds_read_b64_tr_b16 v[164:165], v13 offset:25600
  v_mfma_f32_16x16x32_bf16 v[84:87], v[180:183], a[132:135], v[84:87]
  v_mfma_f32_16x16x32_bf16 v[88:91], v[172:175], a[104:107], v[88:91]
  ds_read_b64_tr_b16 v[166:167], v13 offset:31744
  v_mfma_f32_16x16x32_bf16 v[88:91], v[176:179], a[120:123], v[88:91]
  buffer_load_dwordx4 v9, s[12:15], s35 offen offset:1024 lds
  v_mfma_f32_16x16x32_bf16 v[88:91], v[180:183], a[136:139], v[88:91]
  ds_read_b64_tr_b16 v[168:169], v13 offset:26624
  v_mfma_f32_16x16x32_bf16 v[92:95], v[172:175], a[108:111], v[92:95]
  s_buffer_load_dword s39, s[16:19], s45 offset:256 glc
  v_mfma_f32_16x16x32_bf16 v[92:95], v[176:179], a[124:127], v[92:95]
  s_waitcnt lgkmcnt(5) vmcnt(14)
  ds_read_b64_tr_b16 v[170:171], v13 offset:32768
  v_mfma_f32_16x16x32_bf16 v[92:95], v[180:183], a[140:143], v[92:95]
  s_barrier
  v_mfma_f32_16x16x32_bf16 v[96:99], v[184:187], a[96:99], v[96:99]
  ds_read_b64_tr_b16 v[172:173], v12 offset:36864
  ds_read_b128 a[144:147], v23 offset:0
  v_mfma_f32_16x16x32_bf16 v[96:99], v[188:191], a[112:115], v[96:99]
  ds_read_b128 a[148:151], v23 offset:1024
  v_mfma_f32_16x16x32_bf16 v[96:99], v[192:195], a[128:131], v[96:99]
  ds_read_b64_tr_b16 v[174:175], v12 offset:43008
  ds_read_b128 a[152:155], v23 offset:2048
  v_mfma_f32_16x16x32_bf16 v[100:103], v[184:187], a[100:103], v[100:103]
  buffer_load_dwordx4 v10, s[12:15], s35 offen offset:2048 lds
  v_mfma_f32_16x16x32_bf16 v[100:103], v[188:191], a[116:119], v[100:103]
  ds_read_b64_tr_b16 v[176:177], v12 offset:37888
  ds_read_b128 a[156:159], v23 offset:3072
  v_mfma_f32_16x16x32_bf16 v[100:103], v[192:195], a[132:135], v[100:103]
  s_add_u32 s35, s40, 221184
  ds_read_b128 a[160:163], v23 offset:4096
  v_mfma_f32_16x16x32_bf16 v[104:107], v[184:187], a[104:107], v[104:107]
  s_add_u32 m0, s31, 73728
  ds_read_b64_tr_b16 v[178:179], v12 offset:44032
  ds_read_b128 a[164:167], v23 offset:5120
  v_mfma_f32_16x16x32_bf16 v[104:107], v[188:191], a[120:123], v[104:107]
L_wu_s2_2:
L_st_10000:
  s_cbranch_execz L_st_11000
  buffer_load_dwordx4 v8, s[12:15], s35 offen offset:0 lds
  v_mfma_f32_16x16x32_bf16 v[104:107], v[192:195], a[136:139], v[104:107]
  ds_read_b64_tr_b16 v[180:181], v12 offset:38912
  ds_read_b128 a[168:171], v23 offset:6144
  v_mfma_f32_16x16x32_bf16 v[108:111], v[184:187], a[108:111], v[108:111]
  ds_read_b128 a[172:175], v23 offset:7168
  v_mfma_f32_16x16x32_bf16 v[108:111], v[188:191], a[124:127], v[108:111]
  ds_read_b64_tr_b16 v[182:183], v12 offset:45056
  ds_read_b128 a[176:179], v23 offset:8192
  v_mfma_f32_16x16x32_bf16 v[108:111], v[192:195], a[140:143], v[108:111]
  s_waitcnt lgkmcnt(15)
  buffer_load_dwordx4 v9, s[12:15], s35 offen offset:1024 lds
  v_mfma_f32_16x16x32_bf16 v[112:115], v[160:163], a[96:99], v[112:115]
  ds_read_b64_tr_b16 v[184:185], v13 offset:36864
  ds_read_b128 a[180:183], v23 offset:9216
  v_mfma_f32_16x16x32_bf16 v[112:115], v[164:167], a[112:115], v[112:115]
  ds_read_b128 a[184:187], v23 offset:10240
  v_mfma_f32_16x16x32_bf16 v[112:115], v[168:171], a[128:131], v[112:115]
  ds_read_b64_tr_b16 v[186:187], v13 offset:43008
  ds_read_b128 a[188:191], v23 offset:11264
  v_mfma_f32_16x16x32_bf16 v[116:119], v[160:163], a[100:103], v[116:119]
  buffer_load_dwordx4 v221, s[12:15], s35 offen offset:2048 lds
  v_mfma_f32_16x16x32_bf16 v[116:119], v[164:167], a[116:119], v[116:119]
  ds_read_b64_tr_b16 v[188:189], v13 offset:37888
  v_mfma_f32_16x16x32_bf16 v[116:119], v[168:171], a[132:135], v[116:119]
  v_mfma_f32_16x16x32_bf16 v[120:123], v[160:163], a[104:107], v[120:123]
  ds_read_b64_tr_b16 v[190:191], v13 offset:44032
  v_mfma_f32_16x16x32_bf16 v[120:123], v[164:167], a[120:123], v[120:123]
  v_mfma_f32_16x16x32_bf16 v[120:123], v[168:171], a[136:139], v[120:123]
  ds_read_b64_tr_b16 v[192:193], v13 offset:38912
  v_mfma_f32_16x16x32_bf16 v[124:127], v[160:163], a[108:111], v[124:127]
  s_waitcnt lgkmcnt(0)
  s_cmp_ge_u32 s39, 4
  s_cbranch_scc0 L_slow2
L_ppx2:
  v_mfma_f32_16x16x32_bf16 v[124:127], v[164:167], a[124:127], v[124:127]
  s_waitcnt lgkmcnt(3) vmcnt(12)
  ds_read_b64_tr_b16 v[194:195], v13 offset:45056
  v_mfma_f32_16x16x32_bf16 v[124:127], v[168:171], a[140:143], v[124:127]
  s_barrier
  v_mfma_f32_16x16x32_bf16 v[128:131], v[172:175], a[96:99], v[128:131]
  ds_read_b64_tr_b16 v[160:161], v12 offset:49152
  v_mfma_f32_16x16x32_bf16 v[128:131], v[176:179], a[112:115], v[128:131]
  s_add_u32 s36, s43, 24576
  v_mfma_f32_16x16x32_bf16 v[128:131], v[180:183], a[128:131], v[128:131]
  s_add_u32 m0, s44, 24576
  ds_read_b64_tr_b16 v[162:163], v12 offset:55296
  v_mfma_f32_16x16x32_bf16 v[132:135], v[172:175], a[100:103], v[132:135]
  buffer_load_dwordx4 v222, s[16:19], s36 offen offset:0 sc1 lds
  v_mfma_f32_16x16x32_bf16 v[132:135], v[176:179], a[116:119], v[132:135]
  ds_read_b64_tr_b16 v[164:165], v12 offset:50176
  v_mfma_f32_16x16x32_bf16 v[132:135], v[180:183], a[132:135], v[132:135]
  v_mfma_f32_16x16x32_bf16 v[136:139], v[172:175], a[104:107], v[136:139]
  ds_read_b64_tr_b16 v[166:167], v12 offset:56320
  v_mfma_f32_16x16x32_bf16 v[136:139], v[176:179], a[120:123], v[136:139]
  buffer_load_dwordx4 v222, s[16:19], s36 offen offset:1024 sc1 lds
  v_mfma_f32_16x16x32_bf16 v[136:139], v[180:183], a[136:139], v[136:139]
  ds_read_b64_tr_b16 v[168:169], v12 offset:51200
  v_mfma_f32_16x16x32_bf16 v[140:143], v[172:175], a[108:111], v[140:143]
  v_mfma_f32_16x16x32_bf16 v[140:143], v[176:179], a[124:127], v[140:143]
  ds_read_b64_tr_b16 v[170:171], v12 offset:57344
  v_mfma_f32_16x16x32_bf16 v[140:143], v[180:183], a[140:143], v[140:143]
  s_waitcnt lgkmcnt(6)
  buffer_load_dwordx4 v222, s[16:19], s36 offen offset:2048 sc1 lds
  v_mfma_f32_16x16x32_bf16 v[144:147], v[184:187], a[96:99], v[144:147]
  ds_read_b64_tr_b16 v[172:173], v13 offset:49152
  v_mfma_f32_16x16x32_bf16 v[144:147], v[188:191], a[112:115], v[144:147]
  s_add_u32 s36, s43, 27648
  v_mfma_f32_16x16x32_bf16 v[144:147], v[192:195], a[128:131], v[144:147]
  s_add_u32 m0, s44, 27648
  ds_read_b64_tr_b16 v[174:175], v13 offset:55296
  v_mfma_f32_16x16x32_bf16 v[148:151], v[184:187], a[100:103], v[148:151]
  buffer_load_dwordx4 v222, s[16:19], s36 offen offset:0 sc1 lds
  v_mfma_f32_16x16x32_bf16 v[148:151], v[188:191], a[116:119], v[148:151]
  ds_read_b64_tr_b16 v[176:177], v13 offset:50176
  v_mfma_f32_16x16x32_bf16 v[148:151], v[192:195], a[132:135], v[148:151]
  v_mfma_f32_16x16x32_bf16 v[152:155], v[184:187], a[104:107], v[152:155]
  ds_read_b64_tr_b16 v[178:179], v13 offset:56320
  v_mfma_f32_16x16x32_bf16 v[152:155], v[188:191], a[120:123], v[152:155]
  buffer_load_dwordx4 v222, s[16:19], s36 offen offset:1024 sc1 lds
  v_mfma_f32_16x16x32_bf16 v[152:155], v[192:195], a[136:139], v[152:155]
  ds_read_b64_tr_b16 v[180:181], v13 offset:51200
  v_mfma_f32_16x16x32_bf16 v[156:159], v[184:187], a[108:111], v[156:159]
  v_mfma_f32_16x16x32_bf16 v[156:159], v[188:191], a[124:127], v[156:159]
  s_waitcnt lgkmcnt(5) vmcnt(14)
  ds_read_b64_tr_b16 v[182:183], v13 offset:57344
  v_mfma_f32_16x16x32_bf16 v[156:159], v[192:195], a[140:143], v[156:159]
  s_barrier
  v_mfma_f32_16x16x32_bf16 v[64:67], v[160:163], a[144:147], v[64:67]
  ds_read_b64_tr_b16 v[184:185], v12 offset:0
  v_mfma_f32_16x16x32_bf16 v[64:67], v[164:167], a[160:163], v[64:67]
  v_mfma_f32_16x16x32_bf16 v[64:67], v[168:171], a[176:179], v[64:67]
  ds_read_b64_tr_b16 v[186:187], v12 offset:6144
  v_mfma_f32_16x16x32_bf16 v[68:71], v[160:163], a[148:151], v[68:71]
  buffer_load_dwordx4 v222, s[16:19], s36 offen offset:2048 sc1 lds
  v_mfma_f32_16x16x32_bf16 v[68:71], v[164:167], a[164:167], v[68:71]
  ds_read_b64_tr_b16 v[188:189], v12 offset:1024
  v_mfma_f32_16x16x32_bf16 v[68:71], v[168:171], a[180:183], v[68:71]
  s_add_u32 s35, s40, 221312
  v_mfma_f32_16x16x32_bf16 v[72:75], v[160:163], a[152:155], v[72:75]
  s_add_u32 m0, s31, 24576
  ds_read_b64_tr_b16 v[190:191], v12 offset:7168
  v_mfma_f32_16x16x32_bf16 v[72:75], v[164:167], a[168:171], v[72:75]
  buffer_load_dwordx4 v8, s[12:15], s35 offen offset:0 lds
  v_mfma_f32_16x16x32_bf16 v[72:75], v[168:171], a[184:187], v[72:75]
  ds_read_b64_tr_b16 v[192:193], v12 offset:2048
  v_mfma_f32_16x16x32_bf16 v[76:79], v[160:163], a[156:159], v[76:79]
  v_mfma_f32_16x16x32_bf16 v[76:79], v[164:167], a[172:175], v[76:79]
  ds_read_b64_tr_b16 v[194:195], v12 offset:8192
  v_mfma_f32_16x16x32_bf16 v[76:79], v[168:171], a[188:191], v[76:79]
  s_waitcnt lgkmcnt(6)
  buffer_load_dwordx4 v9, s[12:15], s35 offen offset:1024 lds
  v_mfma_f32_16x16x32_bf16 v[80:83], v[172:175], a[144:147], v[80:83]
  ds_read_b64_tr_b16 v[160:161], v13 offset:0
  v_mfma_f32_16x16x32_bf16 v[80:83], v[176:179], a[160:163], v[80:83]
  v_mfma_f32_16x16x32_bf16 v[80:83], v[180:183], a[176:179], v[80:83]
  ds_read_b64_tr_b16 v[162:163], v13 offset:6144
  v_mfma_f32_16x16x32_bf16 v[84:87], v[172:175], a[148:151], v[84:87]
  buffer_load_dwordx4 v221, s[12:15], s35 offen offset:2048 lds
  v_mfma_f32_16x16x32_bf16 v[84:87], v[176:179], a[164:167], v[84:87]
  ds_read_b64_tr_b16 v[164:165], v13 offset:1024
  v_mfma_f32_16x16x32_bf16 v[84:87], v[180:183], a[180:183], v[84:87]
  s_add_u32 s35, s40, 256
  v_mfma_f32_16x16x32_bf16 v[88:91], v[172:175], a[152:155], v[88:91]
  s_add_u32 m0, s31, 86016
  ds_read_b64_tr_b16 v[166:167], v13 offset:7168
  v_mfma_f32_16x16x32_bf16 v[88:91], v[176:179], a[168:171], v[88:91]
  buffer_load_dwordx4 v8, s[12:15], s35 offen offset:0 lds
  v_mfma_f32_16x16x32_bf16 v[88:91], v[180:183], a[184:187], v[88:91]
  ds_read_b64_tr_b16 v[168:169], v13 offset:2048
  v_mfma_f32_16x16x32_bf16 v[92:95], v[172:175], a[156:159], v[92:95]
  v_mfma_f32_16x16x32_bf16 v[92:95], v[176:179], a[172:175], v[92:95]
  s_waitcnt lgkmcnt(5) vmcnt(16)
  ds_read_b64_tr_b16 v[170:171], v13 offset:8192
  v_mfma_f32_16x16x32_bf16 v[92:95], v[180:183], a[188:191], v[92:95]
  s_barrier
  v_mfma_f32_16x16x32_bf16 v[96:99], v[184:187], a[144:147], v[96:99]
  ds_read_b64_tr_b16 v[172:173], v14 offset:0
  ds_read_b128 a[192:195], v23 offset:12288
  v_mfma_f32_16x16x32_bf16 v[96:99], v[188:191], a[160:163], v[96:99]
  ds_read_b128 a[196:199], v23 offset:13312
  v_mfma_f32_16x16x32_bf16 v[96:99], v[192:195], a[176:179], v[96:99]
  ds_read_b64_tr_b16 v[174:175], v14 offset:6144
  ds_read_b128 a[200:203], v23 offset:14336
  v_mfma_f32_16x16x32_bf16 v[100:103], v[184:187], a[148:151], v[100:103]
  buffer_load_dwordx4 v9, s[12:15], s35 offen offset:1024 lds
  v_mfma_f32_16x16x32_bf16 v[100:103], v[188:191], a[164:167], v[100:103]
  ds_read_b64_tr_b16 v[176:177], v14 offset:1024
  ds_read_b128 a[204:207], v23 offset:15360
  v_mfma_f32_16x16x32_bf16 v[100:103], v[192:195], a[180:183], v[100:103]
  ds_read_b128 a[208:211], v23 offset:16384
  v_mfma_f32_16x16x32_bf16 v[104:107], v[184:187], a[152:155], v[104:107]
  ds_read_b64_tr_b16 v[178:179], v14 offset:7168
  ds_read_b128 a[212:215], v23 offset:17408
  v_mfma_f32_16x16x32_bf16 v[104:107], v[188:191], a[168:171], v[104:107]
  buffer_load_dwordx4 v10, s[12:15], s35 offen offset:2048 lds
  v_mfma_f32_16x16x32_bf16 v[104:107], v[192:195], a[184:187], v[104:107]
  ds_read_b64_tr_b16 v[180:181], v14 offset:2048
  ds_read_b128 a[216:219], v23 offset:18432
  v_mfma_f32_16x16x32_bf16 v[108:111], v[184:187], a[156:159], v[108:111]
  s_add_u32 s35, s40, 110848
  ds_read_b128 a[220:223], v23 offset:19456
  v_mfma_f32_16x16x32_bf16 v[108:111], v[188:191], a[172:175], v[108:111]
  s_add_u32 m0, s31, 122880
  ds_read_b64_tr_b16 v[182:183], v14 offset:8192
  ds_read_b128 a[224:227], v23 offset:20480
  v_mfma_f32_16x16x32_bf16 v[108:111], v[192:195], a[188:191], v[108:111]
  s_waitcnt lgkmcnt(15)
  buffer_load_dwordx4 v8, s[12:15], s35 offen offset:0 lds
  v_mfma_f32_16x16x32_bf16 v[112:115], v[160:163], a[144:147], v[112:115]
  ds_read_b64_tr_b16 v[184:185], v15 offset:0
  ds_read_b128 a[228:231], v23 offset:21504
  v_mfma_f32_16x16x32_bf16 v[112:115], v[164:167], a[160:163], v[112:115]
  ds_read_b128 a[232:235], v23 offset:22528
  v_mfma_f32_16x16x32_bf16 v[112:115], v[168:171], a[176:179], v[112:115]
  ds_read_b64_tr_b16 v[186:187], v15 offset:6144
  ds_read_b128 a[236:239], v23 offset:23552
  v_mfma_f32_16x16x32_bf16 v[116:119], v[160:163], a[148:151], v[116:119]
  buffer_load_dwordx4 v9, s[12:15], s35 offen offset:1024 lds
  v_mfma_f32_16x16x32_bf16 v[116:119], v[164:167], a[164:167], v[116:119]
  ds_read_b64_tr_b16 v[188:189], v15 offset:1024
  v_mfma_f32_16x16x32_bf16 v[116:119], v[168:171], a[180:183], v[116:119]
  v_mfma_f32_16x16x32_bf16 v[120:123], v[160:163], a[152:155], v[120:123]
  ds_read_b64_tr_b16 v[190:191], v15 offset:7168
  v_mfma_f32_16x16x32_bf16 v[120:123], v[164:167], a[168:171], v[120:123]
  buffer_load_dwordx4 v10, s[12:15], s35 offen offset:2048 lds
  v_mfma_f32_16x16x32_bf16 v[120:123], v[168:171], a[184:187], v[120:123]
  ds_read_b64_tr_b16 v[192:193], v15 offset:2048
  v_mfma_f32_16x16x32_bf16 v[124:127], v[160:163], a[156:159], v[124:127]
  v_mfma_f32_16x16x32_bf16 v[124:127], v[164:167], a[172:175], v[124:127]
  s_waitcnt lgkmcnt(3) vmcnt(18)
  ds_read_b64_tr_b16 v[194:195], v15 offset:8192
  v_mfma_f32_16x16x32_bf16 v[124:127], v[168:171], a[188:191], v[124:127]
  s_barrier
  v_mfma_f32_16x16x32_bf16 v[64:67], v[172:175], a[192:195], v[64:67]
  ds_read_b64_tr_b16 v[160:161], v12 offset:12288
  v_mfma_f32_16x16x32_bf16 v[64:67], v[176:179], a[208:211], v[64:67]
  s_add_u32 s35, s40, 221440
  v_mfma_f32_16x16x32_bf16 v[64:67], v[180:183], a[224:227], v[64:67]
  s_add_u32 m0, s31, 36864
  ds_read_b64_tr_b16 v[162:163], v12 offset:18432
  v_mfma_f32_16x16x32_bf16 v[68:71], v[172:175], a[196:199], v[68:71]
  buffer_load_dwordx4 v8, s[12:15], s35 offen offset:0 lds
  v_mfma_f32_16x16x32_bf16 v[68:71], v[176:179], a[212:215], v[68:71]
  ds_read_b64_tr_b16 v[164:165], v12 offset:13312
  v_mfma_f32_16x16x32_bf16 v[68:71], v[180:183], a[228:231], v[68:71]
  v_mfma_f32_16x16x32_bf16 v[72:75], v[172:175], a[200:203], v[72:75]
  ds_read_b64_tr_b16 v[166:167], v12 offset:19456
  v_mfma_f32_16x16x32_bf16 v[72:75], v[176:179], a[216:219], v[72:75]
  buffer_load_dwordx4 v9, s[12:15], s35 offen offset:1024 lds
  v_mfma_f32_16x16x32_bf16 v[72:75], v[180:183], a[232:235], v[72:75]
  ds_read_b64_tr_b16 v[168:169], v12 offset:14336
  v_mfma_f32_16x16x32_bf16 v[76:79], v[172:175], a[204:207], v[76:79]
  v_mfma_f32_16x16x32_bf16 v[76:79], v[176:179], a[220:223], v[76:79]
  ds_read_b64_tr_b16 v[170:171], v12 offset:20480
  v_mfma_f32_16x16x32_bf16 v[76:79], v[180:183], a[236:239], v[76:79]
  s_waitcnt lgkmcnt(6)
  buffer_load_dwordx4 v221, s[12:15], s35 offen offset:2048 lds
  v_mfma_f32_16x16x32_bf16 v[80:83], v[184:187], a[192:195], v[80:83]
  ds_read_b64_tr_b16 v[172:173], v13 offset:12288
  v_mfma_f32_16x16x32_bf16 v[80:83], v[188:191], a[208:211], v[80:83]
  s_add_u32 s35, s34, 384
  v_mfma_f32_16x16x32_bf16 v[80:83], v[192:195], a[224:227], v[80:83]
  s_add_u32 m0, s31, 49152
  ds_read_b64_tr_b16 v[174:175], v13 offset:18432
  v_mfma_f32_16x16x32_bf16 v[84:87], v[184:187], a[196:199], v[84:87]
  buffer_load_dwordx4 v8, s[12:15], s35 offen offset:0 lds
  v_mfma_f32_16x16x32_bf16 v[84:87], v[188:191], a[212:215], v[84:87]
  ds_read_b64_tr_b16 v[176:177], v13 offset:13312
  v_mfma_f32_16x16x32_bf16 v[84:87], v[192:195], a[228:231], v[84:87]
  v_mfma_f32_16x16x32_bf16 v[88:91], v[184:187], a[200:203], v[88:91]
  ds_read_b64_tr_b16 v[178:179], v13 offset:19456
  v_mfma_f32_16x16x32_bf16 v[88:91], v[188:191], a[216:219], v[88:91]
  buffer_load_dwordx4 v9, s[12:15], s35 offen offset:1024 lds
  v_mfma_f32_16x16x32_bf16 v[88:91], v[192:195], a[232:235], v[88:91]
  ds_read_b64_tr_b16 v[180:181], v13 offset:14336
  v_mfma_f32_16x16x32_bf16 v[92:95], v[184:187], a[204:207], v[92:95]
  v_mfma_f32_16x16x32_bf16 v[92:95], v[188:191], a[220:223], v[92:95]
  s_waitcnt lgkmcnt(5) vmcnt(14)
  ds_read_b64_tr_b16 v[182:183], v13 offset:20480
  v_mfma_f32_16x16x32_bf16 v[92:95], v[192:195], a[236:239], v[92:95]
  s_barrier
  v_mfma_f32_16x16x32_bf16 v[96:99], v[160:163], a[192:195], v[96:99]
  ds_read_b64_tr_b16 v[184:185], v14 offset:12288
  ds_read_b128 a[240:243], v23 offset:24576
  v_mfma_f32_16x16x32_bf16 v[96:99], v[164:167], a[208:211], v[96:99]
  ds_read_b128 a[244:247], v23 offset:25600
  v_mfma_f32_16x16x32_bf16 v[96:99], v[168:171], a[224:227], v[96:99]
  ds_read_b64_tr_b16 v[186:187], v14 offset:18432
  ds_read_b128 a[248:251], v23 offset:26624
  v_mfma_f32_16x16x32_bf16 v[100:103], v[160:163], a[196:199], v[100:103]
  buffer_load_dwordx4 v10, s[12:15], s35 offen offset:2048 lds
  v_mfma_f32_16x16x32_bf16 v[100:103], v[164:167], a[212:215], v[100:103]
  ds_read_b64_tr_b16 v[188:189], v14 offset:13312
  ds_read_b128 a[252:255], v23 offset:27648
  v_mfma_f32_16x16x32_bf16 v[100:103], v[168:171], a[228:231], v[100:103]
  s_add_u32 s35, s34, 110976
  ds_read_b128 v[224:227], v23 offset:28672
  v_mfma_f32_16x16x32_bf16 v[104:107], v[160:163], a[200:203], v[104:107]
  s_add_u32 m0, s31, 0
  ds_read_b64_tr_b16 v[190:191], v14 offset:19456
  ds_read_b128 v[228:231], v23 offset:29696
  v_mfma_f32_16x16x32_bf16 v[104:107], v[164:167], a[216:219], v[104:107]
  buffer_load_dwordx4 v8, s[12:15], s35 offen offset:0 lds
  v_mfma_f32_16x16x32_bf16 v[104:107], v[168:171], a[232:235], v[104:107]
  ds_read_b64_tr_b16 v[192:193], v14 offset:14336
  ds_read_b128 v[232:235], v23 offset:30720
  v_mfma_f32_16x16x32_bf16 v[108:111], v[160:163], a[204:207], v[108:111]
  ds_read_b128 v[236:239], v23 offset:31744
  v_mfma_f32_16x16x32_bf16 v[108:111], v[164:167], a[220:223], v[108:111]
  ds_read_b64_tr_b16 v[194:195], v14 offset:20480
  ds_read2st64_b64 v[240:243], v3 offset0:64 offset1:65
  v_mfma_f32_16x16x32_bf16 v[108:111], v[168:171], a[236:239], v[108:111]
  s_waitcnt lgkmcnt(15)
  buffer_load_dwordx4 v9, s[12:15], s35 offen offset:1024 lds
  v_mfma_f32_16x16x32_bf16 v[112:115], v[172:175], a[192:195], v[112:115]
  ds_read_b64_tr_b16 v[160:161], v15 offset:12288
  ds_read2st64_b64 v[244:247], v3 offset0:66 offset1:67
  v_mfma_f32_16x16x32_bf16 v[112:115], v[176:179], a[208:211], v[112:115]
  ds_read2st64_b64 v[248:251], v3 offset0:68 offset1:69
  v_mfma_f32_16x16x32_bf16 v[112:115], v[180:183], a[224:227], v[112:115]
  ds_read_b64_tr_b16 v[162:163], v15 offset:18432
  ds_read2st64_b64 v[252:255], v3 offset0:70 offset1:71
  v_mfma_f32_16x16x32_bf16 v[116:119], v[172:175], a[196:199], v[116:119]
  buffer_load_dwordx4 v10, s[12:15], s35 offen offset:2048 lds
  v_mfma_f32_16x16x32_bf16 v[116:119], v[176:179], a[212:215], v[116:119]
  ds_read_b64_tr_b16 v[164:165], v15 offset:13312
  v_mfma_f32_16x16x32_bf16 v[116:119], v[180:183], a[228:231], v[116:119]
  s_add_u32 s35, s34, 221568
  v_mfma_f32_16x16x32_bf16 v[120:123], v[172:175], a[200:203], v[120:123]
  s_add_u32 m0, s31, 98304
  ds_read_b64_tr_b16 v[166:167], v15 offset:19456
  v_mfma_f32_16x16x32_bf16 v[120:123], v[176:179], a[216:219], v[120:123]
  buffer_load_dwordx4 v8, s[12:15], s35 offen offset:0 lds
  v_mfma_f32_16x16x32_bf16 v[120:123], v[180:183], a[232:235], v[120:123]
  ds_read_b64_tr_b16 v[168:169], v15 offset:14336
  v_mfma_f32_16x16x32_bf16 v[124:127], v[172:175], a[204:207], v[124:127]
  v_mfma_f32_16x16x32_bf16 v[124:127], v[176:179], a[220:223], v[124:127]
  s_waitcnt lgkmcnt(3) vmcnt(16)
  ds_read_b64_tr_b16 v[170:171], v15 offset:20480
  v_mfma_f32_16x16x32_bf16 v[124:127], v[180:183], a[236:239], v[124:127]
  s_barrier
  v_mfma_f32_16x16x32_bf16 v[64:67], v[184:187], a[240:243], v[64:67]
  ds_read_b64_tr_b16 v[172:173], v12 offset:24576
  v_mfma_f32_16x16x32_bf16 v[64:67], v[188:191], v[224:227], v[64:67]
  v_mfma_f32_16x16x32_bf16 v[64:67], v[192:195], v[240:243], v[64:67]
  ds_read_b64_tr_b16 v[174:175], v12 offset:30720
  v_mfma_f32_16x16x32_bf16 v[68:71], v[184:187], a[244:247], v[68:71]
  buffer_load_dwordx4 v9, s[12:15], s35 offen offset:1024 lds
  v_mfma_f32_16x16x32_bf16 v[68:71], v[188:191], v[228:231], v[68:71]
  ds_read_b64_tr_b16 v[176:177], v12 offset:25600
  v_mfma_f32_16x16x32_bf16 v[68:71], v[192:195], v[244:247], v[68:71]
  v_mfma_f32_16x16x32_bf16 v[72:75], v[184:187], a[248:251], v[72:75]
  ds_read_b64_tr_b16 v[178:179], v12 offset:31744
  v_mfma_f32_16x16x32_bf16 v[72:75], v[188:191], v[232:235], v[72:75]
  buffer_load_dwordx4 v11, s[12:15], s35 offen offset:2048 lds
  v_mfma_f32_16x16x32_bf16 v[72:75], v[192:195], v[248:251], v[72:75]
  ds_read_b64_tr_b16 v[180:181], v12 offset:26624
  v_mfma_f32_16x16x32_bf16 v[76:79], v[184:187], a[252:255], v[76:79]
  s_add_u32 s35, s40, 384
  v_mfma_f32_16x16x32_bf16 v[76:79], v[188:191], v[236:239], v[76:79]
  s_add_u32 m0, s31, 135168
  ds_read_b64_tr_b16 v[182:183], v12 offset:32768
  v_cvt_pk_bf16_f32 v204, v64, v65
  v_mfma_f32_16x16x32_bf16 v[76:79], v[192:195], v[252:255], v[76:79]
  s_waitcnt lgkmcnt(6)
  buffer_load_dwordx4 v8, s[12:15], s35 offen offset:0 lds
  v_cvt_pk_bf16_f32 v205, v66, v67
  v_mfma_f32_16x16x32_bf16 v[80:83], v[160:163], a[240:243], v[80:83]
  ds_read_b64_tr_b16 v[184:185], v13 offset:24576
  v_mfma_f32_16x16x32_bf16 v[80:83], v[164:167], v[224:227], v[80:83]
  v_cvt_pk_bf16_f32 v208, v68, v69
  v_cvt_pk_bf16_f32 v209, v70, v71
  v_mfma_f32_16x16x32_bf16 v[80:83], v[168:171], v[240:243], v[80:83]
  ds_read_b64_tr_b16 v[186:187], v13 offset:30720
  v_mfma_f32_16x16x32_bf16 v[84:87], v[160:163], a[244:247], v[84:87]
  buffer_load_dwordx4 v9, s[12:15], s35 offen offset:1024 lds
  v_mfma_f32_16x16x32_bf16 v[84:87], v[164:167], v[228:231], v[84:87]
  ds_read_b64_tr_b16 v[188:189], v13 offset:25600
  v_cvt_pk_bf16_f32 v212, v72, v73
  v_mfma_f32_16x16x32_bf16 v[84:87], v[168:171], v[244:247], v[84:87]
  v_cvt_pk_bf16_f32 v213, v74, v75
  v_mfma_f32_16x16x32_bf16 v[88:91], v[160:163], a[248:251], v[88:91]
  ds_read_b64_tr_b16 v[190:191], v13 offset:31744
  v_mfma_f32_16x16x32_bf16 v[88:91], v[164:167], v[232:235], v[88:91]
  buffer_load_dwordx4 v10, s[12:15], s35 offen offset:2048 lds
  v_cvt_pk_bf16_f32 v216, v76, v77
  v_mfma_f32_16x16x32_bf16 v[88:91], v[168:171], v[248:251], v[88:91]
  ds_read_b64_tr_b16 v[192:193], v13 offset:26624
  v_cvt_pk_bf16_f32 v217, v78, v79
  v_mfma_f32_16x16x32_bf16 v[92:95], v[160:163], a[252:255], v[92:95]
  v_mfma_f32_16x16x32_bf16 v[92:95], v[164:167], v[236:239], v[92:95]
  s_waitcnt lgkmcnt(5) vmcnt(15)
  ds_read_b64_tr_b16 v[194:195], v13 offset:32768
  v_cvt_pk_bf16_f32 v206, v80, v81
  v_mfma_f32_16x16x32_bf16 v[92:95], v[168:171], v[252:255], v[92:95]
  s_barrier
  v_mfma_f32_16x16x32_bf16 v[96:99], v[172:175], a[240:243], v[96:99]
  ds_read_b64_tr_b16 v[160:161], v14 offset:24576
  v_cvt_pk_bf16_f32 v207, v82, v83
  v_mfma_f32_16x16x32_bf16 v[96:99], v[176:179], v[224:227], v[96:99]
  s_add_u32 s35, s40, 110976
  s_add_u32 s3, s37, 0
  s_bitcmp1_b32 s32, 0
  s_cbranch_scc1 L_own0_0
  buffer_store_dwordx4 v[204:207], v20, s[16:19], s3 offen offset:0 sc1
L_ownb0_0:
  v_mfma_f32_16x16x32_bf16 v[96:99], v[180:183], v[240:243], v[96:99]
  s_add_u32 m0, s31, 61440
  ds_read_b64_tr_b16 v[162:163], v14 offset:30720
  v_cvt_pk_bf16_f32 v210, v84, v85
  v_mfma_f32_16x16x32_bf16 v[100:103], v[172:175], a[244:247], v[100:103]
  buffer_load_dwordx4 v8, s[12:15], s35 offen offset:0 lds
  v_cvt_pk_bf16_f32 v211, v86, v87
  v_mfma_f32_16x16x32_bf16 v[100:103], v[176:179], v[228:231], v[100:103]
  ds_read_b64_tr_b16 v[164:165], v14 offset:25600
  v_cvt_pk_bf16_f32 v214, v88, v89
  v_mfma_f32_16x16x32_bf16 v[100:103], v[180:183], v[244:247], v[100:103]
  v_cvt_pk_bf16_f32 v215, v90, v91
  v_mfma_f32_16x16x32_bf16 v[104:107], v[172:175], a[248:251], v[104:107]
  ds_read_b64_tr_b16 v[166:167], v14 offset:31744
  v_mfma_f32_16x16x32_bf16 v[104:107], v[176:179], v[232:235], v[104:107]
  buffer_load_dwordx4 v9, s[12:15], s35 offen offset:1024 lds
  v_cvt_pk_bf16_f32 v218, v92, v93
  v_mfma_f32_16x16x32_bf16 v[104:107], v[180:183], v[248:251], v[104:107]
  ds_read_b64_tr_b16 v[168:169], v14 offset:26624
  v_cvt_pk_bf16_f32 v219, v94, v95
  v_mfma_f32_16x16x32_bf16 v[108:111], v[172:175], a[252:255], v[108:111]
  v_mfma_f32_16x16x32_bf16 v[108:111], v[176:179], v[236:239], v[108:111]
  ds_read_b64_tr_b16 v[170:171], v14 offset:32768
  v_cvt_pk_bf16_f32 v204, v96, v97
  v_mfma_f32_16x16x32_bf16 v[108:111], v[180:183], v[252:255], v[108:111]
  s_waitcnt lgkmcnt(6)
  buffer_load_dwordx4 v10, s[12:15], s35 offen offset:2048 lds
  v_cvt_pk_bf16_f32 v205, v98, v99
  v_mfma_f32_16x16x32_bf16 v[112:115], v[184:187], a[240:243], v[112:115]
  ds_read_b64_tr_b16 v[172:173], v15 offset:24576
  v_mfma_f32_16x16x32_bf16 v[112:115], v[188:191], v[224:227], v[112:115]
  s_add_u32 s35, s40, 221568
  v_mfma_f32_16x16x32_bf16 v[112:115], v[192:195], v[240:243], v[112:115]
  s_add_u32 m0, s31, 12288
  ds_read_b64_tr_b16 v[174:175], v15 offset:30720
  v_mfma_f32_16x16x32_bf16 v[116:119], v[184:187], a[244:247], v[116:119]
  buffer_load_dwordx4 v8, s[12:15], s35 offen offset:0 lds
  v_mfma_f32_16x16x32_bf16 v[116:119], v[188:191], v[228:231], v[116:119]
  ds_read_b64_tr_b16 v[176:177], v15 offset:25600
  v_mfma_f32_16x16x32_bf16 v[116:119], v[192:195], v[244:247], v[116:119]
  s_bitcmp1_b32 s32, 1
  s_cbranch_scc1 L_own0_1
  buffer_store_dwordx4 v[208:211], v20, s[16:19], s3 offen offset:1024 sc1
L_ownb0_1:
  v_mfma_f32_16x16x32_bf16 v[120:123], v[184:187], a[248:251], v[120:123]
  ds_read_b64_tr_b16 v[178:179], v15 offset:31744
  v_mfma_f32_16x16x32_bf16 v[120:123], v[188:191], v[232:235], v[120:123]
  buffer_load_dwordx4 v9, s[12:15], s35 offen offset:1024 lds
  v_cvt_pk_bf16_f32 v208, v100, v101
  v_mfma_f32_16x16x32_bf16 v[120:123], v[192:195], v[248:251], v[120:123]
  ds_read_b64_tr_b16 v[180:181], v15 offset:26624
  v_cvt_pk_bf16_f32 v209, v102, v103
  v_mfma_f32_16x16x32_bf16 v[124:127], v[184:187], a[252:255], v[124:127]
  v_mfma_f32_16x16x32_bf16 v[124:127], v[188:191], v[236:239], v[124:127]
  s_waitcnt lgkmcnt(5)
  ds_read_b64_tr_b16 v[182:183], v15 offset:32768
  v_cvt_pk_bf16_f32 v206, v112, v113
  v_mfma_f32_16x16x32_bf16 v[124:127], v[192:195], v[252:255], v[124:127]
  v_cvt_pk_bf16_f32 v207, v114, v115
  v_mfma_f32_16x16x32_bf16 v[128:131], v[160:163], a[144:147], v[128:131]
  ds_read_b64_tr_b16 v[184:185], v24 offset:0
  v_mfma_f32_16x16x32_bf16 v[128:131], v[164:167], a[160:163], v[128:131]
  v_cvt_pk_bf16_f32 v210, v116, v117
  v_cvt_pk_bf16_f32 v211, v118, v119
  v_mfma_f32_16x16x32_bf16 v[128:131], v[168:171], a[176:179], v[128:131]
  ds_read_b64_tr_b16 v[186:187], v24 offset:6144
  v_mfma_f32_16x16x32_bf16 v[132:135], v[160:163], a[148:151], v[132:135]
  buffer_load_dwordx4 v221, s[12:15], s35 offen offset:2048 lds
  v_mfma_f32_16x16x32_bf16 v[132:135], v[164:167], a[164:167], v[132:135]
  ds_read_b64_tr_b16 v[188:189], v24 offset:1024
  v_mfma_f32_16x16x32_bf16 v[132:135], v[168:171], a[180:183], v[132:135]
  s_add_u32 s35, s41, 0
  v_mfma_f32_16x16x32_bf16 v[136:139], v[160:163], a[152:155], v[136:139]
  s_add_u32 m0, s31, 110592
  ds_read_b64_tr_b16 v[190:191], v24 offset:7168
  v_mfma_f32_16x16x32_bf16 v[136:139], v[164:167], a[168:171], v[136:139]
  buffer_load_dwordx4 v5, s[12:15], s35 offen offset:0 lds
  v_mfma_f32_16x16x32_bf16 v[136:139], v[168:171], a[184:187], v[136:139]
  ds_read_b64_tr_b16 v[192:193], v24 offset:2048
  v_mfma_f32_16x16x32_bf16 v[140:143], v[160:163], a[156:159], v[140:143]
  s_bitcmp1_b32 s32, 2
  s_cbranch_scc1 L_own0_2
  buffer_store_dwordx4 v[212:215], v20, s[16:19], s3 offen offset:2048 sc1
L_ownb0_2:
  v_mfma_f32_16x16x32_bf16 v[140:143], v[164:167], a[172:175], v[140:143]
  ds_read_b64_tr_b16 v[194:195], v24 offset:8192
  v_mfma_f32_16x16x32_bf16 v[140:143], v[168:171], a[188:191], v[140:143]
  s_waitcnt lgkmcnt(6)
  buffer_load_dwordx4 v6, s[12:15], s35 offen offset:1024 lds
  v_cvt_pk_bf16_f32 v212, v104, v105
  v_mfma_f32_16x16x32_bf16 v[144:147], v[172:175], a[144:147], v[144:147]
  ds_read_b64_tr_b16 v[160:161], v25 offset:0
  v_cvt_pk_bf16_f32 v213, v106, v107
  v_mfma_f32_16x16x32_bf16 v[144:147], v[176:179], a[160:163], v[144:147]
  v_cvt_pk_bf16_f32 v214, v120, v121
  v_cvt_pk_bf16_f32 v215, v122, v123
  v_mfma_f32_16x16x32_bf16 v[144:147], v[180:183], a[176:179], v[144:147]
  ds_read_b64_tr_b16 v[162:163], v25 offset:6144
  v_mfma_f32_16x16x32_bf16 v[148:151], v[172:175], a[148:151], v[148:151]
  buffer_load_dwordx4 v7, s[12:15], s35 offen offset:2048 lds
  v_mfma_f32_16x16x32_bf16 v[148:151], v[176:179], a[164:167], v[148:151]
  ds_read_b64_tr_b16 v[164:165], v25 offset:1024
  v_mfma_f32_16x16x32_bf16 v[148:151], v[180:183], a[180:183], v[148:151]
  s_add_u32 s35, s41, 110592
  v_mfma_f32_16x16x32_bf16 v[152:155], v[172:175], a[152:155], v[152:155]
  s_add_u32 m0, s31, 73728
  ds_read_b64_tr_b16 v[166:167], v25 offset:7168
  v_mfma_f32_16x16x32_bf16 v[152:155], v[176:179], a[168:171], v[152:155]
  buffer_load_dwordx4 v5, s[12:15], s35 offen offset:0 lds
  v_mfma_f32_16x16x32_bf16 v[152:155], v[180:183], a[184:187], v[152:155]
  ds_read_b64_tr_b16 v[168:169], v25 offset:2048
  v_mfma_f32_16x16x32_bf16 v[156:159], v[172:175], a[156:159], v[156:159]
  v_mfma_f32_16x16x32_bf16 v[156:159], v[176:179], a[172:175], v[156:159]
  s_waitcnt lgkmcnt(5) vmcnt(22)
  ds_read_b64_tr_b16 v[170:171], v25 offset:8192
  v_mfma_f32_16x16x32_bf16 v[156:159], v[180:183], a[188:191], v[156:159]
  s_barrier
  v_mfma_f32_16x16x32_bf16 v[128:131], v[184:187], a[192:195], v[128:131]
  ds_read_b64_tr_b16 v[172:173], v12 offset:36864
  v_mfma_f32_16x16x32_bf16 v[128:131], v[188:191], a[208:211], v[128:131]
  s_bitcmp1_b32 s32, 3
  s_cbranch_scc1 L_own0_3
  buffer_store_dwordx4 v[216:219], v20, s[16:19], s3 offen offset:3072 sc1
L_ownb0_3:
  v_mfma_f32_16x16x32_bf16 v[128:131], v[192:195], a[224:227], v[128:131]
  ds_read_b64_tr_b16 v[174:175], v12 offset:43008
  v_mfma_f32_16x16x32_bf16 v[132:135], v[184:187], a[196:199], v[132:135]
  buffer_load_dwordx4 v6, s[12:15], s35 offen offset:1024 lds
  v_cvt_pk_bf16_f32 v216, v108, v109
  v_mfma_f32_16x16x32_bf16 v[132:135], v[188:191], a[212:215], v[132:135]
  ds_read_b64_tr_b16 v[176:177], v12 offset:37888
  v_cvt_pk_bf16_f32 v217, v110, v111
  v_mfma_f32_16x16x32_bf16 v[132:135], v[192:195], a[228:231], v[132:135]
  s_mov_b32 s28, 1
  v_cvt_pk_bf16_f32 v218, v124, v125
  v_cvt_pk_bf16_f32 v219, v126, v127
  v_mfma_f32_16x16x32_bf16 v[136:139], v[184:187], a[200:203], v[136:139]
  ds_read_b64_tr_b16 v[178:179], v12 offset:44032
  v_mfma_f32_16x16x32_bf16 v[136:139], v[188:191], a[216:219], v[136:139]
  buffer_load_dwordx4 v7, s[12:15], s35 offen offset:2048 lds
  v_mfma_f32_16x16x32_bf16 v[136:139], v[192:195], a[232:235], v[136:139]
  ds_read_b64_tr_b16 v[180:181], v12 offset:38912
  v_mfma_f32_16x16x32_bf16 v[140:143], v[184:187], a[204:207], v[140:143]
  s_add_u32 s35, s41, 221184
  v_mfma_f32_16x16x32_bf16 v[140:143], v[188:191], a[220:223], v[140:143]
  s_add_u32 m0, s31, 24576
  ds_read_b64_tr_b16 v[182:183], v12 offset:45056
  v_mfma_f32_16x16x32_bf16 v[140:143], v[192:195], a[236:239], v[140:143]
  s_waitcnt lgkmcnt(6)
  buffer_load_dwordx4 v5, s[12:15], s35 offen offset:0 lds
  v_mfma_f32_16x16x32_bf16 v[144:147], v[160:163], a[192:195], v[144:147]
  ds_read_b64_tr_b16 v[184:185], v13 offset:36864
  v_mfma_f32_16x16x32_bf16 v[144:147], v[164:167], a[208:211], v[144:147]
  v_mfma_f32_16x16x32_bf16 v[144:147], v[168:171], a[224:227], v[144:147]
  ds_read_b64_tr_b16 v[186:187], v13 offset:43008
  v_mfma_f32_16x16x32_bf16 v[148:151], v[160:163], a[196:199], v[148:151]
  buffer_load_dwordx4 v6, s[12:15], s35 offen offset:1024 lds
  v_mfma_f32_16x16x32_bf16 v[148:151], v[164:167], a[212:215], v[148:151]
  ds_read_b64_tr_b16 v[188:189], v13 offset:37888
  v_mfma_f32_16x16x32_bf16 v[148:151], v[168:171], a[228:231], v[148:151]
  s_add_u32 s3, s37, 8192
  s_bitcmp1_b32 s32, 0
  s_cbranch_scc1 L_own1_0
  buffer_store_dwordx4 v[204:207], v20, s[16:19], s3 offen offset:0 sc1
L_ownb1_0:
  v_mfma_f32_16x16x32_bf16 v[152:155], v[160:163], a[200:203], v[152:155]
  ds_read_b64_tr_b16 v[190:191], v13 offset:44032
  v_mfma_f32_16x16x32_bf16 v[152:155], v[164:167], a[216:219], v[152:155]
  buffer_load_dwordx4 v2, s[12:15], s35 offen offset:2048 lds
  v_mfma_f32_16x16x32_bf16 v[152:155], v[168:171], a[232:235], v[152:155]
L_st_11000:
  s_cbranch_execz L_st_12000
  ds_read_b64_tr_b16 v[192:193], v13 offset:38912
  v_mfma_f32_16x16x32_bf16 v[156:159], v[160:163], a[204:207], v[156:159]
  v_mfma_f32_16x16x32_bf16 v[156:159], v[164:167], a[220:223], v[156:159]
  s_waitcnt lgkmcnt(5)
  ds_read_b64_tr_b16 v[194:195], v13 offset:45056
  v_mfma_f32_16x16x32_bf16 v[156:159], v[168:171], a[236:239], v[156:159]
  v_mfma_f32_16x16x32_bf16 v[128:131], v[172:175], a[240:243], v[128:131]
  ds_read_b64_tr_b16 v[160:161], v12 offset:49152
  v_mfma_f32_16x16x32_bf16 v[128:131], v[176:179], v[224:227], v[128:131]
  v_mfma_f32_16x16x32_bf16 v[128:131], v[180:183], v[240:243], v[128:131]
  ds_read_b64_tr_b16 v[162:163], v12 offset:55296
  v_mfma_f32_16x16x32_bf16 v[132:135], v[172:175], a[244:247], v[132:135]
  v_mfma_f32_16x16x32_bf16 v[132:135], v[176:179], v[228:231], v[132:135]
  ds_read_b64_tr_b16 v[164:165], v12 offset:50176
  v_mfma_f32_16x16x32_bf16 v[132:135], v[180:183], v[244:247], v[132:135]
  v_mfma_f32_16x16x32_bf16 v[136:139], v[172:175], a[248:251], v[136:139]
  ds_read_b64_tr_b16 v[166:167], v12 offset:56320
  v_mfma_f32_16x16x32_bf16 v[136:139], v[176:179], v[232:235], v[136:139]
  v_mfma_f32_16x16x32_bf16 v[136:139], v[180:183], v[248:251], v[136:139]
  ds_read_b64_tr_b16 v[168:169], v12 offset:51200
  v_mfma_f32_16x16x32_bf16 v[140:143], v[172:175], a[252:255], v[140:143]
  s_bitcmp1_b32 s32, 1
  s_cbranch_scc1 L_own1_1
  buffer_store_dwordx4 v[208:211], v20, s[16:19], s3 offen offset:1024 sc1
L_ownb1_1:
  v_mfma_f32_16x16x32_bf16 v[140:143], v[176:179], v[236:239], v[140:143]
  ds_read_b64_tr_b16 v[170:171], v12 offset:57344
  v_cvt_pk_bf16_f32 v204, v128, v129
  v_mfma_f32_16x16x32_bf16 v[140:143], v[180:183], v[252:255], v[140:143]
  s_waitcnt lgkmcnt(6)
  v_cvt_pk_bf16_f32 v205, v130, v131
  v_mfma_f32_16x16x32_bf16 v[144:147], v[184:187], a[240:243], v[144:147]
  ds_read_b64_tr_b16 v[172:173], v13 offset:49152
  v_mfma_f32_16x16x32_bf16 v[144:147], v[188:191], v[224:227], v[144:147]
  v_cvt_pk_bf16_f32 v208, v132, v133
  v_cvt_pk_bf16_f32 v209, v134, v135
  v_mfma_f32_16x16x32_bf16 v[144:147], v[192:195], v[240:243], v[144:147]
  ds_read_b64_tr_b16 v[174:175], v13 offset:55296
  v_mfma_f32_16x16x32_bf16 v[148:151], v[184:187], a[244:247], v[148:151]
  v_mfma_f32_16x16x32_bf16 v[148:151], v[188:191], v[228:231], v[148:151]
  ds_read_b64_tr_b16 v[176:177], v13 offset:50176
  v_mfma_f32_16x16x32_bf16 v[148:151], v[192:195], v[244:247], v[148:151]
  v_mfma_f32_16x16x32_bf16 v[152:155], v[184:187], a[248:251], v[152:155]
  ds_read_b64_tr_b16 v[178:179], v13 offset:56320
  v_mfma_f32_16x16x32_bf16 v[152:155], v[188:191], v[232:235], v[152:155]
  v_mfma_f32_16x16x32_bf16 v[152:155], v[192:195], v[248:251], v[152:155]
  ds_read_b64_tr_b16 v[180:181], v13 offset:51200
  v_mfma_f32_16x16x32_bf16 v[156:159], v[184:187], a[252:255], v[156:159]
  v_mfma_f32_16x16x32_bf16 v[156:159], v[188:191], v[236:239], v[156:159]
  s_waitcnt lgkmcnt(5) vmcnt(24)
  ds_read_b64_tr_b16 v[182:183], v13 offset:57344
  v_cvt_pk_bf16_f32 v206, v144, v145
  v_mfma_f32_16x16x32_bf16 v[156:159], v[192:195], v[252:255], v[156:159]
  s_barrier
  v_mfma_f32_16x16x32_bf16 v[32:35], v[160:163], a[0:3], 0
  ds_read_b64_tr_b16 v[184:185], v12 offset:0
  v_cvt_pk_bf16_f32 v207, v146, v147
  v_mfma_f32_16x16x32_bf16 v[32:35], v[164:167], a[16:19], v[32:35]
  s_bitcmp1_b32 s32, 2
  s_cbranch_scc1 L_own1_2
  buffer_store_dwordx4 v[212:215], v20, s[16:19], s3 offen offset:2048 sc1
L_ownb1_2:
  v_mfma_f32_16x16x32_bf16 v[32:35], v[168:171], a[32:35], v[32:35]
  ds_read_b64_tr_b16 v[186:187], v12 offset:6144
  v_cvt_pk_bf16_f32 v210, v148, v149
  v_mfma_f32_16x16x32_bf16 v[36:39], v[160:163], a[4:7], 0
  v_cvt_pk_bf16_f32 v211, v150, v151
  v_cvt_pk_bf16_f32 v212, v136, v137
  v_mfma_f32_16x16x32_bf16 v[36:39], v[164:167], a[20:23], v[36:39]
  ds_read_b64_tr_b16 v[188:189], v12 offset:1024
  v_cvt_pk_bf16_f32 v213, v138, v139
  v_mfma_f32_16x16x32_bf16 v[36:39], v[168:171], a[36:39], v[36:39]
  v_cvt_pk_bf16_f32 v214, v152, v153
  v_cvt_pk_bf16_f32 v215, v154, v155
  v_mfma_f32_16x16x32_bf16 v[40:43], v[160:163], a[8:11], 0
  ds_read_b64_tr_b16 v[190:191], v12 offset:7168
  v_and_b32 v144, 1, v1
  v_mfma_f32_16x16x32_bf16 v[40:43], v[164:167], a[24:27], v[40:43]
  v_lshrrev_b32 v145, 1, v1
  v_lshl_add_u32 v146, v145, 3, s49
  s_lshl_b32 s49, s30, 12
  s_add_u32 s49, s49, s48
  s_add_u32 s49, s49, 65536
  s_lshl_b32 s50, s24, 8
  s_add_u32 s50, s50, s49
  v_mfma_f32_16x16x32_bf16 v[40:43], v[168:171], a[40:43], v[40:43]
  ds_read_b64_tr_b16 v[192:193], v12 offset:2048
  v_lshl_add_u32 v146, v144, 9, v146
  v_mfma_f32_16x16x32_bf16 v[44:47], v[160:163], a[12:15], 0
  v_mfma_f32_16x16x32_bf16 v[44:47], v[164:167], a[28:31], v[44:47]
  ds_read_b64_tr_b16 v[194:195], v12 offset:8192
  v_mfma_f32_16x16x32_bf16 v[44:47], v[168:171], a[44:47], v[44:47]
  s_waitcnt lgkmcnt(6)
  v_mfma_f32_16x16x32_bf16 v[48:51], v[172:175], a[0:3], 0
  ds_read_b64_tr_b16 v[160:161], v13 offset:0
  v_mfma_f32_16x16x32_bf16 v[48:51], v[176:179], a[16:19], v[48:51]
  v_mfma_f32_16x16x32_bf16 v[48:51], v[180:183], a[32:35], v[48:51]
  ds_read_b64_tr_b16 v[162:163], v13 offset:6144
  v_mfma_f32_16x16x32_bf16 v[52:55], v[172:175], a[4:7], 0
  v_mfma_f32_16x16x32_bf16 v[52:55], v[176:179], a[20:23], v[52:55]
  ds_read_b64_tr_b16 v[164:165], v13 offset:1024
  v_mfma_f32_16x16x32_bf16 v[52:55], v[180:183], a[36:39], v[52:55]
  s_bitcmp1_b32 s32, 3
  s_cbranch_scc1 L_own1_3
  buffer_store_dwordx4 v[216:219], v20, s[16:19], s3 offen offset:3072 sc1
L_ownb1_3:
  v_mfma_f32_16x16x32_bf16 v[56:59], v[172:175], a[8:11], 0
  ds_read_b64_tr_b16 v[166:167], v13 offset:7168
  v_mfma_f32_16x16x32_bf16 v[56:59], v[176:179], a[24:27], v[56:59]
  v_cvt_pk_bf16_f32 v216, v140, v141
  v_cvt_pk_bf16_f32 v217, v142, v143
  v_mfma_f32_16x16x32_bf16 v[56:59], v[180:183], a[40:43], v[56:59]
  ds_read_b64_tr_b16 v[168:169], v13 offset:2048
  v_cvt_pk_bf16_f32 v218, v156, v157
  v_mfma_f32_16x16x32_bf16 v[60:63], v[172:175], a[12:15], 0
  v_cvt_pk_bf16_f32 v219, v158, v159
  v_lshl_add_u32 v140, v1, 3, s51
  v_mfma_f32_16x16x32_bf16 v[60:63], v[176:179], a[28:31], v[60:63]
  s_waitcnt lgkmcnt(5)
  ds_read_b64_tr_b16 v[170:171], v13 offset:8192
  v_sub_u32 v147, v140, v146
  v_mfma_f32_16x16x32_bf16 v[60:63], v[180:183], a[44:47], v[60:63]
  v_mad_i32_i24 v146, v147, s52, v146
  v_lshl_add_u32 v141, v1, 2, s50
  s_lshl_b32 s50, s26, 9
  s_add_u32 s49, s49, s50
  s_lshl_b32 s50, s25, 3
  s_add_u32 s49, s49, s50
  s_lshl_b32 s48, s27, 7
  v_mfma_f32_16x16x32_bf16 v[32:35], v[184:187], a[48:51], v[32:35]
  ds_read_b64_tr_b16 v[172:173], v14 offset:36864
  v_lshl_add_u32 v147, v145, 4, s49
  s_lshl_b32 s49, s29, 4
  s_add_u32 s48, s48, s49
  v_mfma_f32_16x16x32_bf16 v[32:35], v[188:191], a[64:67], v[32:35]
  v_lshl_add_u32 v147, v144, 2, v147
  v_and_b32 v142, 15, v145
  v_mfma_f32_16x16x32_bf16 v[32:35], v[192:195], a[80:83], v[32:35]
  ds_read_b64_tr_b16 v[174:175], v14 offset:43008
  v_add_u32 v142, s48, v142
  v_mfma_f32_16x16x32_bf16 v[36:39], v[184:187], a[52:55], v[36:39]
  v_and_b32 v143, 127, v142
  v_lshlrev_b32 v143, 2, v143
  v_mfma_f32_16x16x32_bf16 v[36:39], v[188:191], a[68:71], v[36:39]
  ds_read_b64_tr_b16 v[176:177], v14 offset:37888
  v_add_u32 v143, 159744, v143
  v_mfma_f32_16x16x32_bf16 v[36:39], v[192:195], a[84:87], v[36:39]
  ds_read_b32 v138, v143
  s_mov_b32 s49, 5242880
  v_mul_u32_u24 v142, 1152, v142
  v_mfma_f32_16x16x32_bf16 v[40:43], v[184:187], a[56:59], v[40:43]
  ds_read_b64_tr_b16 v[178:179], v14 offset:44032
  v_lshrrev_b32 v145, 5, v1
  v_mfma_f32_16x16x32_bf16 v[40:43], v[188:191], a[72:75], v[40:43]
  buffer_load_dwordx2 v[128:129], v140, s[16:19], s49 offen sc1
  s_mov_b32 s49, 5251072
  v_mfma_f32_16x16x32_bf16 v[40:43], v[192:195], a[88:91], v[40:43]
  ds_read_b64_tr_b16 v[180:181], v14 offset:38912
  v_lshl_add_u32 v142, v145, 3, v142
  v_mfma_f32_16x16x32_bf16 v[44:47], v[184:187], a[60:63], v[44:47]
  s_add_u32 s3, s37, 16384
  s_bitcmp1_b32 s32, 0
  s_cbranch_scc1 L_own2_0
  buffer_store_dwordx4 v[204:207], v20, s[16:19], s3 offen offset:0 sc1
L_ownb2_0:
  v_mfma_f32_16x16x32_bf16 v[44:47], v[188:191], a[76:79], v[44:47]
  ds_read_b64_tr_b16 v[182:183], v14 offset:45056
  v_lshlrev_b32 v196, 3, v1
  v_mfma_f32_16x16x32_bf16 v[44:47], v[192:195], a[92:95], v[44:47]
  s_waitcnt lgkmcnt(7)
  buffer_load_dwordx2 v[130:131], v140, s[16:19], s49 offen sc1
  s_mov_b32 s49, 5259264
  v_mfma_f32_16x16x32_bf16 v[48:51], v[160:163], a[48:51], v[48:51]
  ds_read_b64_tr_b16 v[184:185], v15 offset:36864
  v_sub_u32 v196, v20, v196
  v_mfma_f32_16x16x32_bf16 v[48:51], v[164:167], a[64:67], v[48:51]
  buffer_load_dwordx2 v[132:133], v146, s[16:19], s49 offen sc1
  s_mov_b32 s49, 5267456
  v_mfma_f32_16x16x32_bf16 v[48:51], v[168:171], a[80:83], v[48:51]
  ds_read_b64_tr_b16 v[186:187], v15 offset:43008
  v_mfma_f32_16x16x32_bf16 v[52:55], v[160:163], a[52:55], v[52:55]
  buffer_load_dwordx2 v[134:135], v140, s[16:19], s49 offen sc1
  s_mov_b32 s49, 5242880
  v_mfma_f32_16x16x32_bf16 v[52:55], v[164:167], a[68:71], v[52:55]
  ds_read_b64_tr_b16 v[188:189], v15 offset:37888
  v_mfma_f32_16x16x32_bf16 v[52:55], v[168:171], a[84:87], v[52:55]
  buffer_load_dword v136, v147, s[16:19], s49 offen sc1
  s_lshl_b32 s49, s26, 4
  s_lshl_b32 s48, s30, 6
  v_mfma_f32_16x16x32_bf16 v[56:59], v[160:163], a[56:59], v[56:59]
  ds_read_b64_tr_b16 v[190:191], v15 offset:44032
  v_add_u32 v142, s49, v142
  s_lshl_b32 s49, s25, 5
  s_add_u32 s48, s48, s49
  s_add_u32 s48, s48, 1024
  v_mfma_f32_16x16x32_bf16 v[56:59], v[164:167], a[72:75], v[56:59]
  v_lshl_add_u32 v143, v144, 2, v142
  v_add_u32 v143, s48, v143
  s_lshl_b32 s48, s30, 9
  s_lshl_b32 s49, s25, 6
  s_add_u32 s48, s48, s49
  s_mul_i32 s53, s30, 28672
  s_mul_i32 s38, s26, 3584
  s_add_u32 s53, s53, s38
  s_sub_u32 s53, s37, s53
  v_mfma_f32_16x16x32_bf16 v[56:59], v[168:171], a[88:91], v[56:59]
  ds_read_b64_tr_b16 v[192:193], v15 offset:38912
  v_lshl_add_u32 v142, v144, 5, v142
  v_mfma_f32_16x16x32_bf16 v[60:63], v[160:163], a[60:63], v[60:63]
  v_add_u32 v142, s48, v142
  v_mfma_f32_16x16x32_bf16 v[60:63], v[164:167], a[76:79], v[60:63]
  s_waitcnt lgkmcnt(5) vmcnt(9)
  ds_read_b64_tr_b16 v[194:195], v15 offset:45056
  v_mfma_f32_16x16x32_bf16 v[60:63], v[168:171], a[92:95], v[60:63]
  s_barrier
  v_mfma_f32_16x16x32_bf16 v[32:35], v[172:175], a[96:99], v[32:35]
  ds_read_b64_tr_b16 v[160:161], v24 offset:12288
  v_mfma_f32_16x16x32_bf16 v[32:35], v[176:179], a[112:115], v[32:35]
  s_bitcmp1_b32 s32, 1
  s_cbranch_scc1 L_own2_1
  buffer_store_dwordx4 v[208:211], v20, s[16:19], s3 offen offset:1024 sc1
L_ownb2_1:
  v_mfma_f32_16x16x32_bf16 v[32:35], v[180:183], a[128:131], v[32:35]
  ds_read_b64_tr_b16 v[162:163], v24 offset:18432
  v_mfma_f32_16x16x32_bf16 v[36:39], v[172:175], a[100:103], v[36:39]
  v_mfma_f32_16x16x32_bf16 v[36:39], v[176:179], a[116:119], v[36:39]
  ds_read_b64_tr_b16 v[164:165], v24 offset:13312
  v_mfma_f32_16x16x32_bf16 v[36:39], v[180:183], a[132:135], v[36:39]
  v_mfma_f32_16x16x32_bf16 v[40:43], v[172:175], a[104:107], v[40:43]
  ds_read_b64_tr_b16 v[166:167], v24 offset:19456
  v_mfma_f32_16x16x32_bf16 v[40:43], v[176:179], a[120:123], v[40:43]
  v_mfma_f32_16x16x32_bf16 v[40:43], v[180:183], a[136:139], v[40:43]
  ds_read_b64_tr_b16 v[168:169], v24 offset:14336
  v_mfma_f32_16x16x32_bf16 v[44:47], v[172:175], a[108:111], v[44:47]
  v_mfma_f32_16x16x32_bf16 v[44:47], v[176:179], a[124:127], v[44:47]
  ds_read_b64_tr_b16 v[170:171], v24 offset:20480
  v_mfma_f32_16x16x32_bf16 v[44:47], v[180:183], a[140:143], v[44:47]
  s_waitcnt lgkmcnt(6)
  v_mfma_f32_16x16x32_bf16 v[48:51], v[184:187], a[96:99], v[48:51]
  ds_read_b64_tr_b16 v[172:173], v25 offset:12288
  v_mfma_f32_16x16x32_bf16 v[48:51], v[188:191], a[112:115], v[48:51]
  v_mfma_f32_16x16x32_bf16 v[48:51], v[192:195], a[128:131], v[48:51]
  ds_read_b64_tr_b16 v[174:175], v25 offset:18432
  v_mfma_f32_16x16x32_bf16 v[52:55], v[184:187], a[100:103], v[52:55]
  v_mfma_f32_16x16x32_bf16 v[52:55], v[188:191], a[116:119], v[52:55]
  ds_read_b64_tr_b16 v[176:177], v25 offset:13312
  v_mfma_f32_16x16x32_bf16 v[52:55], v[192:195], a[132:135], v[52:55]
  s_bitcmp1_b32 s32, 2
  s_cbranch_scc1 L_own2_2
  buffer_store_dwordx4 v[212:215], v20, s[16:19], s3 offen offset:2048 sc1
L_ownb2_2:
  v_mfma_f32_16x16x32_bf16 v[56:59], v[184:187], a[104:107], v[56:59]
  ds_read_b64_tr_b16 v[178:179], v25 offset:19456
  v_mfma_f32_16x16x32_bf16 v[56:59], v[188:191], a[120:123], v[56:59]
  v_mfma_f32_16x16x32_bf16 v[56:59], v[192:195], a[136:139], v[56:59]
  ds_read_b64_tr_b16 v[180:181], v25 offset:14336
  v_mfma_f32_16x16x32_bf16 v[60:63], v[184:187], a[108:111], v[60:63]
  s_waitcnt vmcnt(8)
  buffer_atomic_inc v23, v223, s[16:19], s47 offen offset:0
  v_mfma_f32_16x16x32_bf16 v[60:63], v[188:191], a[124:127], v[60:63]
  s_waitcnt lgkmcnt(5)
  ds_read_b64_tr_b16 v[182:183], v25 offset:20480
  v_mfma_f32_16x16x32_bf16 v[60:63], v[192:195], a[140:143], v[60:63]
  v_mfma_f32_16x16x32_bf16 v[32:35], v[160:163], a[144:147], v[32:35]
  ds_read_b64_tr_b16 v[184:185], v14 offset:0
  v_mfma_f32_16x16x32_bf16 v[32:35], v[164:167], a[160:163], v[32:35]
  v_mfma_f32_16x16x32_bf16 v[32:35], v[168:171], a[176:179], v[32:35]
  ds_read_b64_tr_b16 v[186:187], v14 offset:6144
  v_mfma_f32_16x16x32_bf16 v[36:39], v[160:163], a[148:151], v[36:39]
  v_mfma_f32_16x16x32_bf16 v[36:39], v[164:167], a[164:167], v[36:39]
  ds_read_b64_tr_b16 v[188:189], v14 offset:1024
  v_mfma_f32_16x16x32_bf16 v[36:39], v[168:171], a[180:183], v[36:39]
  v_mfma_f32_16x16x32_bf16 v[40:43], v[160:163], a[152:155], v[40:43]
  ds_read_b64_tr_b16 v[190:191], v14 offset:7168
  v_mfma_f32_16x16x32_bf16 v[40:43], v[164:167], a[168:171], v[40:43]
  v_mfma_f32_16x16x32_bf16 v[40:43], v[168:171], a[184:187], v[40:43]
  ds_read_b64_tr_b16 v[192:193], v14 offset:2048
  v_mfma_f32_16x16x32_bf16 v[44:47], v[160:163], a[156:159], v[44:47]
  s_bitcmp1_b32 s32, 3
  s_cbranch_scc1 L_own2_3
  buffer_store_dwordx4 v[216:219], v20, s[16:19], s3 offen offset:3072 sc1
L_ownb2_3:
  v_mfma_f32_16x16x32_bf16 v[44:47], v[164:167], a[172:175], v[44:47]
  ds_read_b64_tr_b16 v[194:195], v14 offset:8192
  v_mfma_f32_16x16x32_bf16 v[44:47], v[168:171], a[188:191], v[44:47]
  s_waitcnt lgkmcnt(6)
  v_mfma_f32_16x16x32_bf16 v[48:51], v[172:175], a[144:147], v[48:51]
  ds_read_b64_tr_b16 v[160:161], v15 offset:0
  v_mfma_f32_16x16x32_bf16 v[48:51], v[176:179], a[160:163], v[48:51]
  v_mfma_f32_16x16x32_bf16 v[48:51], v[180:183], a[176:179], v[48:51]
  ds_read_b64_tr_b16 v[162:163], v15 offset:6144
  v_mfma_f32_16x16x32_bf16 v[52:55], v[172:175], a[148:151], v[52:55]
  v_mfma_f32_16x16x32_bf16 v[52:55], v[176:179], a[164:167], v[52:55]
  ds_read_b64_tr_b16 v[164:165], v15 offset:1024
  v_mfma_f32_16x16x32_bf16 v[52:55], v[180:183], a[180:183], v[52:55]
  v_mfma_f32_16x16x32_bf16 v[56:59], v[172:175], a[152:155], v[56:59]
  ds_read_b64_tr_b16 v[166:167], v15 offset:7168
  v_mfma_f32_16x16x32_bf16 v[56:59], v[176:179], a[168:171], v[56:59]
  v_mfma_f32_16x16x32_bf16 v[56:59], v[180:183], a[184:187], v[56:59]
  ds_read_b64_tr_b16 v[168:169], v15 offset:2048
  v_mfma_f32_16x16x32_bf16 v[60:63], v[172:175], a[156:159], v[60:63]
  v_mfma_f32_16x16x32_bf16 v[60:63], v[176:179], a[172:175], v[60:63]
  s_waitcnt lgkmcnt(5)
  ds_read_b64_tr_b16 v[170:171], v15 offset:8192
  v_mfma_f32_16x16x32_bf16 v[60:63], v[180:183], a[188:191], v[60:63]
  v_mfma_f32_16x16x32_bf16 v[32:35], v[184:187], a[192:195], v[32:35]
  ds_read_b64_tr_b16 v[172:173], v12 offset:12288
  v_mfma_f32_16x16x32_bf16 v[32:35], v[188:191], a[208:211], v[32:35]
  v_mfma_f32_16x16x32_bf16 v[32:35], v[192:195], a[224:227], v[32:35]
  ds_read_b64_tr_b16 v[174:175], v12 offset:18432
  v_mfma_f32_16x16x32_bf16 v[36:39], v[184:187], a[196:199], v[36:39]
  v_mfma_f32_16x16x32_bf16 v[36:39], v[188:191], a[212:215], v[36:39]
  ds_read_b64_tr_b16 v[176:177], v12 offset:13312
  v_mfma_f32_16x16x32_bf16 v[36:39], v[192:195], a[228:231], v[36:39]
  v_mfma_f32_16x16x32_bf16 v[40:43], v[184:187], a[200:203], v[40:43]
  ds_read_b64_tr_b16 v[178:179], v12 offset:19456
  v_mfma_f32_16x16x32_bf16 v[40:43], v[188:191], a[216:219], v[40:43]
  v_mfma_f32_16x16x32_bf16 v[40:43], v[192:195], a[232:235], v[40:43]
  ds_read_b64_tr_b16 v[180:181], v12 offset:14336
  v_mfma_f32_16x16x32_bf16 v[44:47], v[184:187], a[204:207], v[44:47]
  v_mfma_f32_16x16x32_bf16 v[44:47], v[188:191], a[220:223], v[44:47]
  ds_read_b64_tr_b16 v[182:183], v12 offset:20480
  v_mfma_f32_16x16x32_bf16 v[44:47], v[192:195], a[236:239], v[44:47]
  s_waitcnt lgkmcnt(6)
  v_mfma_f32_16x16x32_bf16 v[48:51], v[160:163], a[192:195], v[48:51]
  ds_read_b64_tr_b16 v[184:185], v13 offset:12288
  v_mfma_f32_16x16x32_bf16 v[48:51], v[164:167], a[208:211], v[48:51]
  v_mfma_f32_16x16x32_bf16 v[48:51], v[168:171], a[224:227], v[48:51]
  ds_read_b64_tr_b16 v[186:187], v13 offset:18432
  v_mfma_f32_16x16x32_bf16 v[52:55], v[160:163], a[196:199], v[52:55]
  v_mfma_f32_16x16x32_bf16 v[52:55], v[164:167], a[212:215], v[52:55]
  ds_read_b64_tr_b16 v[188:189], v13 offset:13312
  v_mfma_f32_16x16x32_bf16 v[52:55], v[168:171], a[228:231], v[52:55]
  v_mfma_f32_16x16x32_bf16 v[56:59], v[160:163], a[200:203], v[56:59]
  ds_read_b64_tr_b16 v[190:191], v13 offset:19456
  v_mfma_f32_16x16x32_bf16 v[56:59], v[164:167], a[216:219], v[56:59]
  v_mfma_f32_16x16x32_bf16 v[56:59], v[168:171], a[232:235], v[56:59]
  ds_read_b64_tr_b16 v[192:193], v13 offset:14336
  v_mfma_f32_16x16x32_bf16 v[60:63], v[160:163], a[204:207], v[60:63]
  v_mfma_f32_16x16x32_bf16 v[60:63], v[164:167], a[220:223], v[60:63]
  s_waitcnt lgkmcnt(5)
  ds_read_b64_tr_b16 v[194:195], v13 offset:20480
  v_mfma_f32_16x16x32_bf16 v[60:63], v[168:171], a[236:239], v[60:63]
  v_mfma_f32_16x16x32_bf16 v[32:35], v[172:175], a[240:243], v[32:35]
  ds_read_b64_tr_b16 v[160:161], v18 offset:49152
  v_mfma_f32_16x16x32_bf16 v[32:35], v[176:179], v[224:227], v[32:35]
  v_mfma_f32_16x16x32_bf16 v[32:35], v[180:183], v[240:243], v[32:35]
  ds_read_b64_tr_b16 v[162:163], v18 offset:55296
  v_mfma_f32_16x16x32_bf16 v[36:39], v[172:175], a[244:247], v[36:39]
  v_mfma_f32_16x16x32_bf16 v[36:39], v[176:179], v[228:231], v[36:39]
  ds_read_b64_tr_b16 v[164:165], v18 offset:50176
  v_mfma_f32_16x16x32_bf16 v[36:39], v[180:183], v[244:247], v[36:39]
  v_mfma_f32_16x16x32_bf16 v[40:43], v[172:175], a[248:251], v[40:43]
  ds_read_b64_tr_b16 v[166:167], v18 offset:56320
  v_mfma_f32_16x16x32_bf16 v[40:43], v[176:179], v[232:235], v[40:43]
  v_mfma_f32_16x16x32_bf16 v[40:43], v[180:183], v[248:251], v[40:43]
  ds_read_b64_tr_b16 v[168:169], v18 offset:51200
  v_mfma_f32_16x16x32_bf16 v[44:47], v[172:175], a[252:255], v[44:47]
  v_mfma_f32_16x16x32_bf16 v[44:47], v[176:179], v[236:239], v[44:47]
  ds_read_b64_tr_b16 v[170:171], v18 offset:57344
  v_cvt_pk_bf16_f32 v204, v32, v33
  v_mfma_f32_16x16x32_bf16 v[44:47], v[180:183], v[252:255], v[44:47]
  s_waitcnt lgkmcnt(6)
  v_cvt_pk_bf16_f32 v205, v34, v35
  v_mfma_f32_16x16x32_bf16 v[48:51], v[184:187], a[240:243], v[48:51]
  ds_read_b64_tr_b16 v[172:173], v19 offset:49152
  v_mfma_f32_16x16x32_bf16 v[48:51], v[188:191], v[224:227], v[48:51]
  s_waitcnt vmcnt(0)
  buffer_atomic_inc v23, v223, s[16:19], s47 offen offset:512
  v_mfma_f32_16x16x32_bf16 v[48:51], v[192:195], v[240:243], v[48:51]
  ds_read_b64_tr_b16 v[174:175], v19 offset:55296
  v_cvt_pk_bf16_f32 v208, v36, v37
  v_mfma_f32_16x16x32_bf16 v[52:55], v[184:187], a[244:247], v[52:55]
  v_cvt_pk_bf16_f32 v209, v38, v39
  v_mfma_f32_16x16x32_bf16 v[52:55], v[188:191], v[228:231], v[52:55]
  ds_read_b64_tr_b16 v[176:177], v19 offset:50176
  v_cvt_pk_bf16_f32 v212, v40, v41
  v_mfma_f32_16x16x32_bf16 v[52:55], v[192:195], v[244:247], v[52:55]
  v_cvt_pk_bf16_f32 v213, v42, v43
  v_mfma_f32_16x16x32_bf16 v[56:59], v[184:187], a[248:251], v[56:59]
  ds_read_b64_tr_b16 v[178:179], v19 offset:56320
  v_mfma_f32_16x16x32_bf16 v[56:59], v[188:191], v[232:235], v[56:59]
  v_cvt_pk_bf16_f32 v216, v44, v45
  v_cvt_pk_bf16_f32 v217, v46, v47
  v_mfma_f32_16x16x32_bf16 v[56:59], v[192:195], v[248:251], v[56:59]
  ds_read_b64_tr_b16 v[180:181], v19 offset:51200
  v_mfma_f32_16x16x32_bf16 v[60:63], v[184:187], a[252:255], v[60:63]
  v_mfma_f32_16x16x32_bf16 v[60:63], v[188:191], v[236:239], v[60:63]
  s_waitcnt lgkmcnt(5)
  ds_read_b64_tr_b16 v[182:183], v19 offset:57344
  v_cvt_pk_bf16_f32 v206, v48, v49
  v_mfma_f32_16x16x32_bf16 v[60:63], v[192:195], v[252:255], v[60:63]
  v_cvt_pk_bf16_f32 v207, v50, v51
  v_mfma_f32_16x16x32_bf16 v[64:67], v[160:163], a[0:3], 0
  ds_read_b64_tr_b16 v[184:185], v18 offset:12288
  v_mfma_f32_16x16x32_bf16 v[64:67], v[164:167], a[16:19], v[64:67]
  s_add_u32 s3, s37, 24576
  s_bitcmp1_b32 s32, 0
  s_cbranch_scc1 L_own3_0
  buffer_store_dwordx4 v[204:207], v20, s[16:19], s3 offen offset:0 sc1
L_ownb3_0:
  v_mfma_f32_16x16x32_bf16 v[64:67], v[168:171], a[32:35], v[64:67]
  ds_read_b64_tr_b16 v[186:187], v18 offset:18432
  v_cvt_pk_bf16_f32 v210, v52, v53
  v_mfma_f32_16x16x32_bf16 v[68:71], v[160:163], a[4:7], 0
  v_cvt_pk_bf16_f32 v211, v54, v55
  v_mfma_f32_16x16x32_bf16 v[68:71], v[164:167], a[20:23], v[68:71]
  ds_read_b64_tr_b16 v[188:189], v18 offset:13312
  v_cvt_pk_bf16_f32 v214, v56, v57
  v_mfma_f32_16x16x32_bf16 v[68:71], v[168:171], a[36:39], v[68:71]
  v_cvt_pk_bf16_f32 v215, v58, v59
  v_mfma_f32_16x16x32_bf16 v[72:75], v[160:163], a[8:11], 0
  ds_read_b64_tr_b16 v[190:191], v18 offset:19456
  v_mfma_f32_16x16x32_bf16 v[72:75], v[164:167], a[24:27], v[72:75]
  v_cvt_pk_bf16_f32 v218, v60, v61
  v_cvt_pk_bf16_f32 v219, v62, v63
  v_mfma_f32_16x16x32_bf16 v[72:75], v[168:171], a[40:43], v[72:75]
  ds_read_b64_tr_b16 v[192:193], v18 offset:14336
  v_mfma_f32_16x16x32_bf16 v[76:79], v[160:163], a[12:15], 0
  v_mfma_f32_16x16x32_bf16 v[76:79], v[164:167], a[28:31], v[76:79]
  ds_read_b64_tr_b16 v[194:195], v18 offset:20480
  v_mfma_f32_16x16x32_bf16 v[76:79], v[168:171], a[44:47], v[76:79]
  s_waitcnt lgkmcnt(6)
  v_mfma_f32_16x16x32_bf16 v[64:67], v[172:175], a[144:147], v[64:67]
  ds_read_b64_tr_b16 v[160:161], v19 offset:12288
  v_mfma_f32_16x16x32_bf16 v[64:67], v[176:179], a[160:163], v[64:67]
  v_mfma_f32_16x16x32_bf16 v[64:67], v[180:183], a[176:179], v[64:67]
  ds_read_b64_tr_b16 v[162:163], v19 offset:18432
  v_mfma_f32_16x16x32_bf16 v[68:71], v[172:175], a[148:151], v[68:71]
  v_mfma_f32_16x16x32_bf16 v[68:71], v[176:179], a[164:167], v[68:71]
  ds_read_b64_tr_b16 v[164:165], v19 offset:13312
  v_mfma_f32_16x16x32_bf16 v[68:71], v[180:183], a[180:183], v[68:71]
  s_bitcmp1_b32 s32, 1
  s_cbranch_scc1 L_own3_1
  buffer_store_dwordx4 v[208:211], v20, s[16:19], s3 offen offset:1024 sc1
L_ownb3_1:
  v_mfma_f32_16x16x32_bf16 v[72:75], v[172:175], a[152:155], v[72:75]
  ds_read_b64_tr_b16 v[166:167], v19 offset:19456
  v_mfma_f32_16x16x32_bf16 v[72:75], v[176:179], a[168:171], v[72:75]
  v_mfma_f32_16x16x32_bf16 v[72:75], v[180:183], a[184:187], v[72:75]
  ds_read_b64_tr_b16 v[168:169], v19 offset:14336
  v_mfma_f32_16x16x32_bf16 v[76:79], v[172:175], a[156:159], v[76:79]
  v_mfma_f32_16x16x32_bf16 v[76:79], v[176:179], a[172:175], v[76:79]
  s_waitcnt lgkmcnt(5)
  ds_read_b64_tr_b16 v[170:171], v19 offset:20480
  v_mfma_f32_16x16x32_bf16 v[76:79], v[180:183], a[188:191], v[76:79]
  v_mfma_f32_16x16x32_bf16 v[64:67], v[184:187], a[48:51], v[64:67]
  ds_read_b64_tr_b16 v[172:173], v16 offset:24576
  v_mfma_f32_16x16x32_bf16 v[64:67], v[188:191], a[64:67], v[64:67]
  v_mfma_f32_16x16x32_bf16 v[64:67], v[192:195], a[80:83], v[64:67]
  ds_read_b64_tr_b16 v[174:175], v16 offset:30720
  v_mfma_f32_16x16x32_bf16 v[68:71], v[184:187], a[52:55], v[68:71]
  v_mfma_f32_16x16x32_bf16 v[68:71], v[188:191], a[68:71], v[68:71]
  ds_read_b64_tr_b16 v[176:177], v16 offset:25600
  v_mfma_f32_16x16x32_bf16 v[68:71], v[192:195], a[84:87], v[68:71]
  v_mfma_f32_16x16x32_bf16 v[72:75], v[184:187], a[56:59], v[72:75]
  ds_read_b64_tr_b16 v[178:179], v16 offset:31744
  v_mfma_f32_16x16x32_bf16 v[72:75], v[188:191], a[72:75], v[72:75]
  v_mfma_f32_16x16x32_bf16 v[72:75], v[192:195], a[88:91], v[72:75]
  ds_read_b64_tr_b16 v[180:181], v16 offset:26624
  v_mfma_f32_16x16x32_bf16 v[76:79], v[184:187], a[60:63], v[76:79]
  s_bitcmp1_b32 s32, 2
  s_cbranch_scc1 L_own3_2
  buffer_store_dwordx4 v[212:215], v20, s[16:19], s3 offen offset:2048 sc1
L_ownb3_2:
  v_mfma_f32_16x16x32_bf16 v[76:79], v[188:191], a[76:79], v[76:79]
  ds_read_b64_tr_b16 v[182:183], v16 offset:32768
  v_mfma_f32_16x16x32_bf16 v[76:79], v[192:195], a[92:95], v[76:79]
  s_waitcnt lgkmcnt(6)
  v_mfma_f32_16x16x32_bf16 v[64:67], v[160:163], a[192:195], v[64:67]
  ds_read_b64_tr_b16 v[184:185], v17 offset:24576
  v_mfma_f32_16x16x32_bf16 v[64:67], v[164:167], a[208:211], v[64:67]
  v_mfma_f32_16x16x32_bf16 v[64:67], v[168:171], a[224:227], v[64:67]
  ds_read_b64_tr_b16 v[186:187], v17 offset:30720
  v_mfma_f32_16x16x32_bf16 v[68:71], v[160:163], a[196:199], v[68:71]
  v_mfma_f32_16x16x32_bf16 v[68:71], v[164:167], a[212:215], v[68:71]
  ds_read_b64_tr_b16 v[188:189], v17 offset:25600
  v_mfma_f32_16x16x32_bf16 v[68:71], v[168:171], a[228:231], v[68:71]
  v_mfma_f32_16x16x32_bf16 v[72:75], v[160:163], a[200:203], v[72:75]
  ds_read_b64_tr_b16 v[190:191], v17 offset:31744
  v_mfma_f32_16x16x32_bf16 v[72:75], v[164:167], a[216:219], v[72:75]
  v_mfma_f32_16x16x32_bf16 v[72:75], v[168:171], a[232:235], v[72:75]
  ds_read_b64_tr_b16 v[192:193], v17 offset:26624
  v_mfma_f32_16x16x32_bf16 v[76:79], v[160:163], a[204:207], v[76:79]
  v_mfma_f32_16x16x32_bf16 v[76:79], v[164:167], a[220:223], v[76:79]
  s_waitcnt lgkmcnt(5)
  ds_read_b64_tr_b16 v[194:195], v17 offset:32768
  v_mfma_f32_16x16x32_bf16 v[76:79], v[168:171], a[236:239], v[76:79]
  v_mfma_f32_16x16x32_bf16 v[64:67], v[172:175], a[96:99], v[64:67]
  v_mfma_f32_16x16x32_bf16 v[64:67], v[176:179], a[112:115], v[64:67]
  s_bitcmp1_b32 s32, 3
  s_cbranch_scc1 L_own3_3
  buffer_store_dwordx4 v[216:219], v20, s[16:19], s3 offen offset:3072 sc1
L_ownb3_3:
  v_mfma_f32_16x16x32_bf16 v[64:67], v[180:183], a[128:131], v[64:67]
  v_mfma_f32_16x16x32_bf16 v[68:71], v[172:175], a[100:103], v[68:71]
  v_mfma_f32_16x16x32_bf16 v[68:71], v[176:179], a[116:119], v[68:71]
  v_mfma_f32_16x16x32_bf16 v[68:71], v[180:183], a[132:135], v[68:71]
  v_mfma_f32_16x16x32_bf16 v[72:75], v[172:175], a[104:107], v[72:75]
  v_mfma_f32_16x16x32_bf16 v[72:75], v[176:179], a[120:123], v[72:75]
  v_mfma_f32_16x16x32_bf16 v[72:75], v[180:183], a[136:139], v[72:75]
  v_mfma_f32_16x16x32_bf16 v[76:79], v[172:175], a[108:111], v[76:79]
  v_mfma_f32_16x16x32_bf16 v[76:79], v[176:179], a[124:127], v[76:79]
  v_mfma_f32_16x16x32_bf16 v[76:79], v[180:183], a[140:143], v[76:79]
  s_waitcnt lgkmcnt(0)
  v_mfma_f32_16x16x32_bf16 v[64:67], v[184:187], a[240:243], v[64:67]
  v_mfma_f32_16x16x32_bf16 v[64:67], v[188:191], v[224:227], v[64:67]
  v_mfma_f32_16x16x32_bf16 v[64:67], v[192:195], v[240:243], v[64:67]
  v_mfma_f32_16x16x32_bf16 v[68:71], v[184:187], a[244:247], v[68:71]
  v_mfma_f32_16x16x32_bf16 v[68:71], v[188:191], v[228:231], v[68:71]
  v_mfma_f32_16x16x32_bf16 v[68:71], v[192:195], v[244:247], v[68:71]
  v_mfma_f32_16x16x32_bf16 v[72:75], v[184:187], a[248:251], v[72:75]
  v_mfma_f32_16x16x32_bf16 v[72:75], v[188:191], v[232:235], v[72:75]
  v_mfma_f32_16x16x32_bf16 v[72:75], v[192:195], v[248:251], v[72:75]
  v_mfma_f32_16x16x32_bf16 v[76:79], v[184:187], a[252:255], v[76:79]
  v_mfma_f32_16x16x32_bf16 v[76:79], v[188:191], v[236:239], v[76:79]
  v_cvt_pk_bf16_f32 v204, v64, v65
  v_cvt_pk_bf16_f32 v205, v66, v67
  v_mfma_f32_16x16x32_bf16 v[76:79], v[192:195], v[252:255], v[76:79]
  s_add_u32 s3, s53, 65536
  s_bitcmp1_b32 s32, 0
  s_cbranch_scc1 L_own4_0
  buffer_store_dwordx2 v[204:205], v196, s[16:19], s3 offen offset:0 sc1
L_ownb4_0:
  s_nop 7
  s_nop 1
  v_cvt_pk_bf16_f32 v208, v68, v69
  v_cvt_pk_bf16_f32 v209, v70, v71
  s_bitcmp1_b32 s32, 1
  s_cbranch_scc1 L_own4_1
  buffer_store_dwordx2 v[208:209], v196, s[16:19], s3 offen offset:1024 sc1
L_ownb4_1:
  v_cvt_pk_bf16_f32 v212, v72, v73
  v_cvt_pk_bf16_f32 v213, v74, v75
  s_bitcmp1_b32 s32, 2
  s_cbranch_scc1 L_own4_2
  buffer_store_dwordx2 v[212:213], v196, s[16:19], s3 offen offset:2048 sc1
L_ownb4_2:
  v_cvt_pk_bf16_f32 v216, v76, v77
  v_cvt_pk_bf16_f32 v217, v78, v79
  s_bitcmp1_b32 s32, 3
  s_cbranch_scc1 L_own4_3
  buffer_store_dwordx2 v[216:217], v196, s[16:19], s3 offen offset:3072 sc1
L_ownb4_3:
  s_waitcnt lgkmcnt(0)
  v_mul_f32 v144, v138, v138
  s_mov_b32 s35, 0xffff0000
  s_buffer_load_dword s38, s[16:19], s54 glc
  s_buffer_load_dword s39, s[16:19], s54 offset:512 glc
  s_add_u32 s40, s29, 1
  s_and_b32 s40, s40, 7
  s_mul_i32 s40, s40, 2359296
  s_add_u32 s40, s40, 8388608
  s_add_u32 s41, s29, 2
  s_and_b32 s41, s41, 7
  s_mul_i32 s41, s41, 2359296
  s_add_u32 s41, s41, 8388608
  s_add_u32 s42, s29, 3
  s_and_b32 s42, s42, 7
  s_mul_i32 s42, s42, 2359296
  s_add_u32 s42, s42, 8388608
  s_add_u32 s43, s29, 4
  s_and_b32 s43, s43, 7
  s_mul_i32 s43, s43, 2359296
  s_add_u32 s43, s43, 8388608
  s_add_u32 s44, s29, 5
  s_and_b32 s44, s44, 7
  s_mul_i32 s44, s44, 2359296
  s_add_u32 s44, s44, 8388608
  s_add_u32 s56, s29, 6
  s_and_b32 s56, s56, 7
  s_mul_i32 s56, s56, 2359296
  s_add_u32 s56, s56, 8388608
  s_add_u32 s57, s29, 7
  s_and_b32 s57, s57, 7
  s_mul_i32 s57, s57, 2359296
  s_add_u32 s57, s57, 8388608
  s_lshl_b32 s33, s24, 9
  s_add_u32 s33, s33, 147456
  v_lshl_add_u32 v200, v1, 3, s33
  s_lshl_b32 s33, s24, 8
  s_add_u32 s33, s33, 155648
  v_lshl_add_u32 v201, v1, 2, s33
  s_barrier
  ds_read_b64 v[96:97], v200 offset:0
L_st_12000:
  s_cbranch_execz L_wuret_s2
  ds_read_b64 v[112:113], v200 offset:2048
  ds_read_b64 v[80:81], v200 offset:4096
  ds_read_b64 v[32:33], v200 offset:6144
  ds_read_b32 v48, v201
  s_waitcnt vmcnt(0)
  buffer_atomic_inc v23, v223, s[16:19], s47 offen offset:1024
  s_waitcnt lgkmcnt(0)
  s_cmp_ge_u32 s38, 8
  s_cbranch_scc1 L_r1_go
  s_mov_b32 s36, 40
L_r1_s:
  s_buffer_load_dword s38, s[16:19], s54 offset:0 glc
  s_waitcnt lgkmcnt(0)
  s_cmp_ge_u32 s38, 8
  s_cbranch_scc1 L_r1_go
  s_sub_u32 s36, s36, 1
  s_cbranch_scc0 L_r1_s
L_r1:
  buffer_load_dword v28, v223, s[16:19], s54 offen offset:0 sc1
  s_waitcnt vmcnt(0)
L_r1_chk:
  v_readfirstlane_b32 s38, v28
  s_cmp_ge_u32 s38, 8
  s_cbranch_scc1 L_r1_go
  s_sub_u32 s100, s100, 1
  s_cmp_lt_i32 s100, 0
  s_cbranch_scc0 L_r1
L_r1_go:
  s_add_u32 s36, s40, 0
  buffer_load_dwordx2 v[98:99], v140, s[16:19], s36 offen sc1
  s_add_u32 s36, s41, 0
  buffer_load_dwordx2 v[100:101], v140, s[16:19], s36 offen sc1
  s_add_u32 s36, s42, 0
  buffer_load_dwordx2 v[102:103], v140, s[16:19], s36 offen sc1
  s_add_u32 s36, s43, 0
  buffer_load_dwordx2 v[104:105], v140, s[16:19], s36 offen sc1
  s_add_u32 s36, s44, 0
  buffer_load_dwordx2 v[106:107], v140, s[16:19], s36 offen sc1
  s_add_u32 s36, s56, 0
  buffer_load_dwordx2 v[108:109], v140, s[16:19], s36 offen sc1
  s_add_u32 s36, s57, 0
  buffer_load_dwordx2 v[110:111], v140, s[16:19], s36 offen sc1
  s_add_u32 s36, s40, 8192
  buffer_load_dwordx2 v[114:115], v140, s[16:19], s36 offen sc1
  s_add_u32 s36, s41, 8192
  buffer_load_dwordx2 v[116:117], v140, s[16:19], s36 offen sc1
  s_add_u32 s36, s42, 8192
  buffer_load_dwordx2 v[118:119], v140, s[16:19], s36 offen sc1
  s_add_u32 s36, s43, 8192
  buffer_load_dwordx2 v[120:121], v140, s[16:19], s36 offen sc1
  s_add_u32 s36, s44, 8192
  buffer_load_dwordx2 v[122:123], v140, s[16:19], s36 offen sc1
  s_add_u32 s36, s56, 8192
  buffer_load_dwordx2 v[124:125], v140, s[16:19], s36 offen sc1
  s_add_u32 s36, s57, 8192
  buffer_load_dwordx2 v[126:127], v140, s[16:19], s36 offen sc1
L_r1_done:
  s_cmp_ge_u32 s39, 8
  s_cbranch_scc1 L_r3_go
  s_mov_b32 s36, 40
L_r3_s:
  s_buffer_load_dword s38, s[16:19], s54 offset:512 glc
  s_waitcnt lgkmcnt(0)
  s_cmp_ge_u32 s38, 8
  s_cbranch_scc1 L_r3_go
  s_sub_u32 s36, s36, 1
  s_cbranch_scc0 L_r3_s
L_r3:
  buffer_load_dword v28, v223, s[16:19], s54 offen offset:512 sc1
  s_waitcnt vmcnt(0)
L_r3_chk:
  v_readfirstlane_b32 s38, v28
  s_cmp_ge_u32 s38, 8
  s_cbranch_scc1 L_r3_go
  s_sub_u32 s100, s100, 1
  s_cmp_lt_i32 s100, 0
  s_cbranch_scc0 L_r3
L_r3_go:
  s_add_u32 s36, s40, 16384
  buffer_load_dwordx2 v[82:83], v140, s[16:19], s36 offen sc1
  s_add_u32 s36, s41, 16384
  buffer_load_dwordx2 v[84:85], v140, s[16:19], s36 offen sc1
  s_add_u32 s36, s42, 16384
  buffer_load_dwordx2 v[86:87], v140, s[16:19], s36 offen sc1
  s_add_u32 s36, s43, 16384
  buffer_load_dwordx2 v[88:89], v140, s[16:19], s36 offen sc1
  s_add_u32 s36, s44, 16384
  buffer_load_dwordx2 v[90:91], v140, s[16:19], s36 offen sc1
  s_add_u32 s36, s56, 16384
  buffer_load_dwordx2 v[92:93], v140, s[16:19], s36 offen sc1
  s_add_u32 s36, s57, 16384
  buffer_load_dwordx2 v[94:95], v140, s[16:19], s36 offen sc1
  s_mov_b32 s36, 40
L_r4_s:
  s_buffer_load_dword s38, s[16:19], s54 offset:1024 glc
  s_waitcnt lgkmcnt(0)
  s_cmp_ge_u32 s38, 8
  s_cbranch_scc1 L_r4_go
  s_sub_u32 s36, s36, 1
  s_cbranch_scc0 L_r4_s
L_r4:
  buffer_load_dword v28, v223, s[16:19], s54 offen offset:1024 sc1
  s_waitcnt vmcnt(0)
L_r4_chk:
  v_readfirstlane_b32 s38, v28
  s_cmp_ge_u32 s38, 8
  s_cbranch_scc1 L_r4_go
  s_sub_u32 s100, s100, 1
  s_cmp_lt_i32 s100, 0
  s_cbranch_scc0 L_r4
L_r4_go:
  s_add_u32 s36, s40, 24576
  buffer_load_dwordx2 v[34:35], v140, s[16:19], s36 offen sc1
  s_add_u32 s36, s41, 24576
  buffer_load_dwordx2 v[36:37], v140, s[16:19], s36 offen sc1
  s_add_u32 s36, s42, 24576
  buffer_load_dwordx2 v[38:39], v140, s[16:19], s36 offen sc1
  s_add_u32 s36, s43, 24576
  buffer_load_dwordx2 v[40:41], v140, s[16:19], s36 offen sc1
  s_add_u32 s36, s44, 24576
  buffer_load_dwordx2 v[42:43], v140, s[16:19], s36 offen sc1
  s_add_u32 s36, s56, 24576
  buffer_load_dwordx2 v[44:45], v140, s[16:19], s36 offen sc1
  s_add_u32 s36, s57, 24576
  buffer_load_dwordx2 v[46:47], v140, s[16:19], s36 offen sc1
  s_add_u32 s36, s40, 0
  buffer_load_dword v49, v141, s[16:19], s36 offen sc1
  s_add_u32 s36, s41, 0
  buffer_load_dword v50, v141, s[16:19], s36 offen sc1
  s_add_u32 s36, s42, 0
  buffer_load_dword v51, v141, s[16:19], s36 offen sc1
  s_add_u32 s36, s43, 0
  buffer_load_dword v52, v141, s[16:19], s36 offen sc1
  s_add_u32 s36, s44, 0
  buffer_load_dword v53, v141, s[16:19], s36 offen sc1
  s_add_u32 s36, s56, 0
  buffer_load_dword v54, v141, s[16:19], s36 offen sc1
  s_add_u32 s36, s57, 0
  buffer_load_dword v55, v141, s[16:19], s36 offen sc1
  s_waitcnt vmcnt(28)
  v_lshlrev_b32 v196, 16, v96
  v_and_b32 v197, s35, v96
  v_lshlrev_b32 v198, 16, v97
  v_and_b32 v199, s35, v97
  v_lshlrev_b32 v200, 16, v98
  v_and_b32 v201, s35, v98
  v_pk_add_f32 v[196:197], v[196:197], v[200:201]
  v_lshlrev_b32 v202, 16, v99
  v_and_b32 v203, s35, v99
  v_pk_add_f32 v[198:199], v[198:199], v[202:203]
  v_lshlrev_b32 v200, 16, v100
  v_and_b32 v201, s35, v100
  v_pk_add_f32 v[196:197], v[196:197], v[200:201]
  v_lshlrev_b32 v202, 16, v101
  v_and_b32 v203, s35, v101
  v_pk_add_f32 v[198:199], v[198:199], v[202:203]
  v_lshlrev_b32 v200, 16, v102
  v_and_b32 v201, s35, v102
  v_pk_add_f32 v[196:197], v[196:197], v[200:201]
  v_lshlrev_b32 v202, 16, v103
  v_and_b32 v203, s35, v103
  v_pk_add_f32 v[198:199], v[198:199], v[202:203]
  v_lshlrev_b32 v200, 16, v104
  v_and_b32 v201, s35, v104
  v_pk_add_f32 v[196:197], v[196:197], v[200:201]
  v_lshlrev_b32 v202, 16, v105
  v_and_b32 v203, s35, v105
  v_pk_add_f32 v[198:199], v[198:199], v[202:203]
  v_lshlrev_b32 v200, 16, v106
  v_and_b32 v201, s35, v106
  v_pk_add_f32 v[196:197], v[196:197], v[200:201]
  v_lshlrev_b32 v202, 16, v107
  v_and_b32 v203, s35, v107
  v_pk_add_f32 v[198:199], v[198:199], v[202:203]
  v_lshlrev_b32 v200, 16, v108
  v_and_b32 v201, s35, v108
  v_pk_add_f32 v[196:197], v[196:197], v[200:201]
  v_lshlrev_b32 v202, 16, v109
  v_and_b32 v203, s35, v109
  v_pk_add_f32 v[198:199], v[198:199], v[202:203]
  v_lshlrev_b32 v200, 16, v110
  v_and_b32 v201, s35, v110
  v_pk_add_f32 v[196:197], v[196:197], v[200:201]
  v_lshlrev_b32 v202, 16, v111
  v_and_b32 v203, s35, v111
  v_pk_add_f32 v[198:199], v[198:199], v[202:203]
  v_mul_f32 v196, v196, v144
  v_mul_f32 v197, v197, v144
  v_cvt_pk_bf16_f32 v196, v196, v197
  v_lshlrev_b32 v200, 16, v128
  v_and_b32 v201, s35, v128
  v_and_b32 v197, s35, v196
  v_lshlrev_b32 v196, 16, v196
  v_pk_add_f32 v[200:201], v[200:201], v[196:197]
  v_cvt_pk_bf16_f32 v160, v200, v201
  v_mul_f32 v198, v198, v144
  v_mul_f32 v199, v199, v144
  v_cvt_pk_bf16_f32 v198, v198, v199
  v_lshlrev_b32 v200, 16, v129
  v_and_b32 v201, s35, v129
  v_and_b32 v199, s35, v198
  v_lshlrev_b32 v198, 16, v198
  v_pk_add_f32 v[200:201], v[200:201], v[198:199]
  v_cvt_pk_bf16_f32 v161, v200, v201
  buffer_store_dwordx2 v[160:161], v142, s[20:23], 0 offen offset:0
  s_waitcnt vmcnt(22)
  v_lshlrev_b32 v196, 16, v112
  v_and_b32 v197, s35, v112
  v_lshlrev_b32 v198, 16, v113
  v_and_b32 v199, s35, v113
  v_lshlrev_b32 v200, 16, v114
  v_and_b32 v201, s35, v114
  v_pk_add_f32 v[196:197], v[196:197], v[200:201]
  v_lshlrev_b32 v202, 16, v115
  v_and_b32 v203, s35, v115
  v_pk_add_f32 v[198:199], v[198:199], v[202:203]
  v_lshlrev_b32 v200, 16, v116
  v_and_b32 v201, s35, v116
  v_pk_add_f32 v[196:197], v[196:197], v[200:201]
  v_lshlrev_b32 v202, 16, v117
  v_and_b32 v203, s35, v117
  v_pk_add_f32 v[198:199], v[198:199], v[202:203]
  v_lshlrev_b32 v200, 16, v118
  v_and_b32 v201, s35, v118
  v_pk_add_f32 v[196:197], v[196:197], v[200:201]
  v_lshlrev_b32 v202, 16, v119
  v_and_b32 v203, s35, v119
  v_pk_add_f32 v[198:199], v[198:199], v[202:203]
  v_lshlrev_b32 v200, 16, v120
  v_and_b32 v201, s35, v120
  v_pk_add_f32 v[196:197], v[196:197], v[200:201]
  v_lshlrev_b32 v202, 16, v121
  v_and_b32 v203, s35, v121
  v_pk_add_f32 v[198:199], v[198:199], v[202:203]
  v_lshlrev_b32 v200, 16, v122
  v_and_b32 v201, s35, v122
  v_pk_add_f32 v[196:197], v[196:197], v[200:201]
  v_lshlrev_b32 v202, 16, v123
  v_and_b32 v203, s35, v123
  v_pk_add_f32 v[198:199], v[198:199], v[202:203]
  v_lshlrev_b32 v200, 16, v124
  v_and_b32 v201, s35, v124
  v_pk_add_f32 v[196:197], v[196:197], v[200:201]
  v_lshlrev_b32 v202, 16, v125
  v_and_b32 v203, s35, v125
  v_pk_add_f32 v[198:199], v[198:199], v[202:203]
  v_lshlrev_b32 v200, 16, v126
  v_and_b32 v201, s35, v126
  v_pk_add_f32 v[196:197], v[196:197], v[200:201]
  v_lshlrev_b32 v202, 16, v127
  v_and_b32 v203, s35, v127
  v_pk_add_f32 v[198:199], v[198:199], v[202:203]
  v_mul_f32 v196, v196, v144
  v_mul_f32 v197, v197, v144
  v_cvt_pk_bf16_f32 v196, v196, v197
  v_lshlrev_b32 v200, 16, v130
  v_and_b32 v201, s35, v130
  v_and_b32 v197, s35, v196
  v_lshlrev_b32 v196, 16, v196
  v_pk_add_f32 v[200:201], v[200:201], v[196:197]
  v_cvt_pk_bf16_f32 v162, v200, v201
  v_mul_f32 v198, v198, v144
  v_mul_f32 v199, v199, v144
  v_cvt_pk_bf16_f32 v198, v198, v199
  v_lshlrev_b32 v200, 16, v131
  v_and_b32 v201, s35, v131
  v_and_b32 v199, s35, v198
  v_lshlrev_b32 v198, 16, v198
  v_pk_add_f32 v[200:201], v[200:201], v[198:199]
  v_cvt_pk_bf16_f32 v163, v200, v201
  buffer_store_dwordx2 v[162:163], v142, s[20:23], 0 offen offset:128
  s_waitcnt vmcnt(16)
  v_lshlrev_b32 v196, 16, v80
  v_and_b32 v197, s35, v80
  v_lshlrev_b32 v198, 16, v81
  v_and_b32 v199, s35, v81
  v_lshlrev_b32 v200, 16, v82
  v_and_b32 v201, s35, v82
  v_pk_add_f32 v[196:197], v[196:197], v[200:201]
  v_lshlrev_b32 v202, 16, v83
  v_and_b32 v203, s35, v83
  v_pk_add_f32 v[198:199], v[198:199], v[202:203]
  v_lshlrev_b32 v200, 16, v84
  v_and_b32 v201, s35, v84
  v_pk_add_f32 v[196:197], v[196:197], v[200:201]
  v_lshlrev_b32 v202, 16, v85
  v_and_b32 v203, s35, v85
  v_pk_add_f32 v[198:199], v[198:199], v[202:203]
  v_lshlrev_b32 v200, 16, v86
  v_and_b32 v201, s35, v86
  v_pk_add_f32 v[196:197], v[196:197], v[200:201]
  v_lshlrev_b32 v202, 16, v87
  v_and_b32 v203, s35, v87
  v_pk_add_f32 v[198:199], v[198:199], v[202:203]
  v_lshlrev_b32 v200, 16, v88
  v_and_b32 v201, s35, v88
  v_pk_add_f32 v[196:197], v[196:197], v[200:201]
  v_lshlrev_b32 v202, 16, v89
  v_and_b32 v203, s35, v89
  v_pk_add_f32 v[198:199], v[198:199], v[202:203]
  v_lshlrev_b32 v200, 16, v90
  v_and_b32 v201, s35, v90
  v_pk_add_f32 v[196:197], v[196:197], v[200:201]
  v_lshlrev_b32 v202, 16, v91
  v_and_b32 v203, s35, v91
  v_pk_add_f32 v[198:199], v[198:199], v[202:203]
  v_lshlrev_b32 v200, 16, v92
  v_and_b32 v201, s35, v92
  v_pk_add_f32 v[196:197], v[196:197], v[200:201]
  v_lshlrev_b32 v202, 16, v93
  v_and_b32 v203, s35, v93
  v_pk_add_f32 v[198:199], v[198:199], v[202:203]
  v_lshlrev_b32 v200, 16, v94
  v_and_b32 v201, s35, v94
  v_pk_add_f32 v[196:197], v[196:197], v[200:201]
  v_lshlrev_b32 v202, 16, v95
  v_and_b32 v203, s35, v95
  v_pk_add_f32 v[198:199], v[198:199], v[202:203]
  v_mul_f32 v196, v196, v144
  v_mul_f32 v197, v197, v144
  v_cvt_pk_bf16_f32 v196, v196, v197
  v_lshlrev_b32 v200, 16, v132
  v_and_b32 v201, s35, v132
  v_and_b32 v197, s35, v196
  v_lshlrev_b32 v196, 16, v196
  v_pk_add_f32 v[200:201], v[200:201], v[196:197]
  v_cvt_pk_bf16_f32 v164, v200, v201
  v_mul_f32 v198, v198, v144
  v_mul_f32 v199, v199, v144
  v_cvt_pk_bf16_f32 v198, v198, v199
  v_lshlrev_b32 v200, 16, v133
  v_and_b32 v201, s35, v133
  v_and_b32 v199, s35, v198
  v_lshlrev_b32 v198, 16, v198
  v_pk_add_f32 v[200:201], v[200:201], v[198:199]
  v_cvt_pk_bf16_f32 v165, v200, v201
  buffer_store_dwordx2 v[164:165], v142, s[20:23], 0 offen offset:256
  s_waitcnt vmcnt(10)
  v_lshlrev_b32 v196, 16, v32
  v_and_b32 v197, s35, v32
  v_lshlrev_b32 v198, 16, v33
  v_and_b32 v199, s35, v33
  v_lshlrev_b32 v200, 16, v34
  v_and_b32 v201, s35, v34
  v_pk_add_f32 v[196:197], v[196:197], v[200:201]
  v_lshlrev_b32 v202, 16, v35
  v_and_b32 v203, s35, v35
  v_pk_add_f32 v[198:199], v[198:199], v[202:203]
  v_lshlrev_b32 v200, 16, v36
  v_and_b32 v201, s35, v36
  v_pk_add_f32 v[196:197], v[196:197], v[200:201]
  v_lshlrev_b32 v202, 16, v37
  v_and_b32 v203, s35, v37
  v_pk_add_f32 v[198:199], v[198:199], v[202:203]
  v_lshlrev_b32 v200, 16, v38
  v_and_b32 v201, s35, v38
  v_pk_add_f32 v[196:197], v[196:197], v[200:201]
  v_lshlrev_b32 v202, 16, v39
  v_and_b32 v203, s35, v39
  v_pk_add_f32 v[198:199], v[198:199], v[202:203]
  v_lshlrev_b32 v200, 16, v40
  v_and_b32 v201, s35, v40
  v_pk_add_f32 v[196:197], v[196:197], v[200:201]
  v_lshlrev_b32 v202, 16, v41
  v_and_b32 v203, s35, v41
  v_pk_add_f32 v[198:199], v[198:199], v[202:203]
  v_lshlrev_b32 v200, 16, v42
  v_and_b32 v201, s35, v42
  v_pk_add_f32 v[196:197], v[196:197], v[200:201]
  v_lshlrev_b32 v202, 16, v43
  v_and_b32 v203, s35, v43
  v_pk_add_f32 v[198:199], v[198:199], v[202:203]
  v_lshlrev_b32 v200, 16, v44
  v_and_b32 v201, s35, v44
  v_pk_add_f32 v[196:197], v[196:197], v[200:201]
  v_lshlrev_b32 v202, 16, v45
  v_and_b32 v203, s35, v45
  v_pk_add_f32 v[198:199], v[198:199], v[202:203]
  v_lshlrev_b32 v200, 16, v46
  v_and_b32 v201, s35, v46
  v_pk_add_f32 v[196:197], v[196:197], v[200:201]
  v_lshlrev_b32 v202, 16, v47
  v_and_b32 v203, s35, v47
  v_pk_add_f32 v[198:199], v[198:199], v[202:203]
  v_mul_f32 v196, v196, v144
  v_mul_f32 v197, v197, v144
  v_cvt_pk_bf16_f32 v196, v196, v197
  v_lshlrev_b32 v200, 16, v134
  v_and_b32 v201, s35, v134
  v_and_b32 v197, s35, v196
  v_lshlrev_b32 v196, 16, v196
  v_pk_add_f32 v[200:201], v[200:201], v[196:197]
  v_cvt_pk_bf16_f32 v166, v200, v201
  v_mul_f32 v198, v198, v144
  v_mul_f32 v199, v199, v144
  v_cvt_pk_bf16_f32 v198, v198, v199
  v_lshlrev_b32 v200, 16, v135
  v_and_b32 v201, s35, v135
  v_and_b32 v199, s35, v198
  v_lshlrev_b32 v198, 16, v198
  v_pk_add_f32 v[200:201], v[200:201], v[198:199]
  v_cvt_pk_bf16_f32 v167, v200, v201
  buffer_store_dwordx2 v[166:167], v142, s[20:23], 0 offen offset:384
  s_waitcnt vmcnt(4)
  v_lshlrev_b32 v196, 16, v48
  v_and_b32 v197, s35, v48
  v_lshlrev_b32 v200, 16, v49
  v_and_b32 v201, s35, v49
  v_pk_add_f32 v[196:197], v[196:197], v[200:201]
  v_lshlrev_b32 v200, 16, v50
  v_and_b32 v201, s35, v50
  v_pk_add_f32 v[196:197], v[196:197], v[200:201]
  v_lshlrev_b32 v200, 16, v51
  v_and_b32 v201, s35, v51
  v_pk_add_f32 v[196:197], v[196:197], v[200:201]
  v_lshlrev_b32 v200, 16, v52
  v_and_b32 v201, s35, v52
  v_pk_add_f32 v[196:197], v[196:197], v[200:201]
  v_lshlrev_b32 v200, 16, v53
  v_and_b32 v201, s35, v53
  v_pk_add_f32 v[196:197], v[196:197], v[200:201]
  v_lshlrev_b32 v200, 16, v54
  v_and_b32 v201, s35, v54
  v_pk_add_f32 v[196:197], v[196:197], v[200:201]
  v_lshlrev_b32 v200, 16, v55
  v_and_b32 v201, s35, v55
  v_pk_add_f32 v[196:197], v[196:197], v[200:201]
  v_mul_f32 v196, v196, v144
  v_mul_f32 v197, v197, v144
  v_cvt_pk_bf16_f32 v196, v196, v197
  v_lshlrev_b32 v200, 16, v136
  v_and_b32 v201, s35, v136
  v_and_b32 v197, s35, v196
  v_lshlrev_b32 v196, 16, v196
  v_pk_add_f32 v[200:201], v[200:201], v[196:197]
  v_cvt_pk_bf16_f32 v168, v200, v201
  buffer_store_dword v168, v143, s[20:23], 0 offen
L_end:
  s_endpgm
L_slow0:
  buffer_load_dword v220, v223, s[16:19], s45 offen offset:0 sc1
  s_waitcnt vmcnt(0)
  v_readfirstlane_b32 s38, v220
  s_cmp_ge_u32 s38, 4
  s_cbranch_scc1 L_ppx0
  s_sub_u32 s100, s100, 1
  s_cmp_lt_i32 s100, 0
  s_cbranch_scc0 L_slow0
  s_branch L_ppx0
L_slow1:
  buffer_load_dword v220, v223, s[16:19], s45 offen offset:128 sc1
  s_waitcnt vmcnt(0)
  v_readfirstlane_b32 s38, v220
  s_cmp_ge_u32 s38, 4
  s_cbranch_scc1 L_ppx1
  s_sub_u32 s100, s100, 1
  s_cmp_lt_i32 s100, 0
  s_cbranch_scc0 L_slow1
  s_branch L_ppx1
L_slow2:
  buffer_load_dword v28, v223, s[16:19], s45 offen offset:256 sc1
  s_waitcnt vmcnt(0)
  v_readfirstlane_b32 s38, v28
  s_cmp_ge_u32 s38, 4
  s_cbranch_scc1 L_ppx2
  s_sub_u32 s100, s100, 1
  s_cmp_lt_i32 s100, 0
  s_cbranch_scc0 L_slow2
  s_branch L_ppx2
L_own0_0:
  ds_write_b128 v29, v[204:207] offset:0
  buffer_store_dwordx4 v[204:207], v31, s[16:19], s3 offen offset:0 sc1
  s_branch L_ownb0_0
L_own0_1:
  ds_write_b128 v29, v[208:211] offset:0
  buffer_store_dwordx4 v[208:211], v31, s[16:19], s3 offen offset:1024 sc1
  s_branch L_ownb0_1
L_own0_2:
  ds_write_b128 v29, v[212:215] offset:0
  buffer_store_dwordx4 v[212:215], v31, s[16:19], s3 offen offset:2048 sc1
  s_branch L_ownb0_2
L_own0_3:
  ds_write_b128 v29, v[216:219] offset:0
  buffer_store_dwordx4 v[216:219], v31, s[16:19], s3 offen offset:3072 sc1
  s_branch L_ownb0_3
L_own1_0:
  ds_write_b128 v29, v[204:207] offset:2048
  buffer_store_dwordx4 v[204:207], v31, s[16:19], s3 offen offset:0 sc1
  s_branch L_ownb1_0
L_own1_1:
  ds_write_b128 v29, v[208:211] offset:2048
  buffer_store_dwordx4 v[208:211], v31, s[16:19], s3 offen offset:1024 sc1
  s_branch L_ownb1_1
L_own1_2:
  ds_write_b128 v29, v[212:215] offset:2048
  buffer_store_dwordx4 v[212:215], v31, s[16:19], s3 offen offset:2048 sc1
  s_branch L_ownb1_2
L_own1_3:
  ds_write_b128 v29, v[216:219] offset:2048
  buffer_store_dwordx4 v[216:219], v31, s[16:19], s3 offen offset:3072 sc1
  s_branch L_ownb1_3
L_own2_0:
  ds_write_b128 v29, v[204:207] offset:4096
  buffer_store_dwordx4 v[204:207], v31, s[16:19], s3 offen offset:0 sc1
  s_branch L_ownb2_0
L_own2_1:
  ds_write_b128 v29, v[208:211] offset:4096
  buffer_store_dwordx4 v[208:211], v31, s[16:19], s3 offen offset:1024 sc1
  s_branch L_ownb2_1
L_own2_2:
  ds_write_b128 v29, v[212:215] offset:4096
  buffer_store_dwordx4 v[212:215], v31, s[16:19], s3 offen offset:2048 sc1
  s_branch L_ownb2_2
L_own2_3:
  ds_write_b128 v29, v[216:219] offset:4096
  buffer_store_dwordx4 v[216:219], v31, s[16:19], s3 offen offset:3072 sc1
  s_branch L_ownb2_3
L_own3_0:
  ds_write_b128 v29, v[204:207] offset:6144
  buffer_store_dwordx4 v[204:207], v31, s[16:19], s3 offen offset:0 sc1
  s_branch L_ownb3_0
L_own3_1:
  ds_write_b128 v29, v[208:211] offset:6144
  buffer_store_dwordx4 v[208:211], v31, s[16:19], s3 offen offset:1024 sc1
  s_branch L_ownb3_1
L_own3_2:
  ds_write_b128 v29, v[212:215] offset:6144
  buffer_store_dwordx4 v[212:215], v31, s[16:19], s3 offen offset:2048 sc1
  s_branch L_ownb3_2
L_own3_3:
  ds_write_b128 v29, v[216:219] offset:6144
  buffer_store_dwordx4 v[216:219], v31, s[16:19], s3 offen offset:3072 sc1
  s_branch L_ownb3_3
L_own4_0:
  ds_write_b64 v30, v[204:205]
  buffer_store_dwordx2 v[204:205], v31, s[16:19], s3 offen offset:0 sc1
  s_branch L_ownb4_0
L_own4_1:
  ds_write_b64 v30, v[208:209]
  buffer_store_dwordx2 v[208:209], v31, s[16:19], s3 offen offset:1024 sc1
  s_branch L_ownb4_1
L_own4_2:
  ds_write_b64 v30, v[212:213]
  buffer_store_dwordx2 v[212:213], v31, s[16:19], s3 offen offset:2048 sc1
  s_branch L_ownb4_2
L_own4_3:
  ds_write_b64 v30, v[216:217]
  buffer_store_dwordx2 v[216:217], v31, s[16:19], s3 offen offset:3072 sc1
  s_branch L_ownb4_3
.section .rodata,"a"
.p2align 6
.amdhsa_kernel sequential_preLN__linear_attn_block__geglu_ffn__prompt_kernel
  .amdhsa_next_free_vgpr 512
  .amdhsa_next_free_sgpr 102
  .amdhsa_accum_offset 256
  .amdhsa_group_segment_fixed_size 0
  .amdhsa_kernarg_size 80
  .amdhsa_user_sgpr_count 2
  .amdhsa_user_sgpr_kernarg_segment_ptr 1
  .amdhsa_system_sgpr_workgroup_id_x 1
  .amdhsa_float_denorm_mode_32 3
.end_amdhsa_kernel
```
